```python
import torch

def _softmax(x, axis=-1):
    return torch.softmax(x, dim=axis)
def _gelu(x):
    return torch.nn.functional.gelu(x, approximate="tanh")
def _silu(x):
    return torch.nn.functional.silu(x)
def _sigmoid(x):
    return torch.sigmoid(x)
def _layernorm(x, axis=-1, eps=1e-5):
    m = x.mean(dim=axis, keepdim=True)
    v = x.var(dim=axis, keepdim=True, unbiased=False)
    return (x - m) / torch.sqrt(v + eps)
def _scatter_add(tgt, idx, src, axis=0):
    return tgt.clone().index_add_(axis, idx, src)
def _segment_sum(src, seg, n):
    out = torch.zeros((n,) + src.shape[1:], dtype=src.dtype)
    return out.index_add_(0, seg, src)
def _pad(x, pw):
    flat = tuple(v for pair in reversed(pw) for v in pair)
    return torch.nn.functional.pad(x, flat)

kernel_name = 'interleave_layers__mha_block__glu_gated_reglu__prompt'

def setup_inputs():

    _w = (lambda a: (lambda t: t.to(torch.bfloat16) if t.is_floating_point() else t)(torch.as_tensor(a)))
    def _A_setup():
        B, S, D, H = 1, 2048, 640, 32
        return {
            "x": _w((lambda *s: torch.randn(*s, dtype=torch.bfloat16) * 0.05)(B, S, D)),
            "wqkv": _w((lambda *s: torch.randn(*s, dtype=torch.bfloat16) * 0.05)(D, 3 * D)),
            "wo": _w((lambda *s: torch.randn(*s, dtype=torch.bfloat16) * 0.05)(D, D)),
        }
    _A_in = _A_setup()

    def _B_setup():
        B, S, D, F = 1, 2048, 640, 1536
        return {
            "x": _w((lambda *s: torch.randn(*s, dtype=torch.bfloat16) * 0.05)(B, S, D)),
            "W_gate": _w((lambda *s: torch.randn(*s, dtype=torch.bfloat16) * 0.8)(D, F) * (2.0 / D) ** 0.5),
            "W_up": _w((lambda *s: torch.randn(*s, dtype=torch.bfloat16) * 0.8)(D, F) * (2.0 / D) ** 0.5),
            "W_down": _w((lambda *s: torch.randn(*s, dtype=torch.bfloat16) * 0.8)(F, D) * (1.0 / F) ** 0.5),
        }
    _B_in = _B_setup()

    return {
        "A_x": _A_in["x"],
        "A_wqkv": _A_in["wqkv"],
        "A_wo": _A_in["wo"],
        "B_x": _B_in["x"],
        "B_W_gate": _B_in["W_gate"],
        "B_W_up": _B_in["W_up"],
        "B_W_down": _B_in["W_down"],
    }

def reference(A_x, A_wqkv, A_wo, B_x, B_W_gate, B_W_up, B_W_down):
    def _A_ref(x, wqkv, wo):
        B, S, D = x.shape
        H = 32
        Dh = D // H
        qkv = (lambda x, *d: x.permute(*d))((x @ wqkv).reshape(B, S, 3, H, Dh), 2, 0, 3, 1, 4)
        q, k, v = qkv[0], qkv[1], qkv[2]
        scores = torch.einsum("bhqd,bhkd->bhqk", q, k) * (Dh ** -0.5)
        p = _softmax(scores, axis=-1)
        o = torch.einsum("bhqk,bhkd->bhqd", p, v)
        return (lambda x, *d: x.permute(*d))(o, 0, 2, 1, 3).reshape(B, S, D) @ wo

    def _B_ref(x, W_gate, W_up, W_down):
        gate = torch.einsum("bsd,df->bsf", x, W_gate)
        up = torch.einsum("bsd,df->bsf", x, W_up)
        gate = gate * (lambda x, dt: x.to(dt))(gate > 0, gate.dtype)
        h = gate * up
        return torch.einsum("bsf,fd->bsd", h, W_down)

    x = A_x
    x = x + _A_ref(_layernorm(x, axis=-1), A_wqkv, A_wo)
    x = x + _B_ref(_layernorm(x, axis=-1), B_W_gate, B_W_up, B_W_down)
    x = x + _A_ref(_layernorm(x, axis=-1), A_wqkv, A_wo)
    x = x + _B_ref(_layernorm(x, axis=-1), B_W_gate, B_W_up, B_W_down)
    return x
```

```asm
; @launch kernel=g1a_kernel grid=(256,1,1) block=(768,1,1) lds=135168
; @launch kernel=atta_kernel grid=(256,1,1) block=(1024,1,1) lds=151616
; @launch kernel=cha_kernel grid=(256,1,1) block=(512,1,1) lds=163840
.amdgcn_target "amdgcn-amd-amdhsa--gfx950"
.text
.globl g1a_kernel
.p2align 8
.type g1a_kernel,@function
g1a_kernel:
    s_cmp_ge_u32 s2, 256
    s_cbranch_scc1 L_g1a_exit
    s_load_dwordx16 s[16:31], s[0:1], 0
    s_load_dwordx4 s[32:35], s[0:1], 64
    s_and_b32 s3, s2, 7
    s_lshr_b32 s4, s2, 3
    s_and_b32 s5, s3, 3
    s_lshl_b32 s5, s5, 2
    s_and_b32 s8, s4, 3
    s_add_u32 s5, s5, s8
    s_lshr_b32 s6, s3, 2
    s_lshl_b32 s6, s6, 3
    s_lshr_b32 s8, s4, 2
    s_add_u32 s6, s6, s8
    v_lshrrev_b32 v1, 6, v0
    v_and_b32 v2, 63, v0
    s_nop 0
    v_readfirstlane_b32 s7, v1

    s_waitcnt lgkmcnt(0)
    s_cmp_lt_u32 s7, 4
    s_cbranch_scc1 L_g1a_compute
    s_cmp_ge_u32 s7, 8
    s_cbranch_scc1 L_g1a_stats
    s_sub_u32 s9, s7, 4
    s_cmp_ge_u32 s9, 2
    s_cbranch_scc1 L_g1a_wl
    s_mov_b32 s52, s16
    s_mov_b32 s53, s17
    s_mov_b32 s54, 2621440
    s_mov_b32 s55, 0x00020000
    v_lshrrev_b32 v3, 3, v2
    v_and_b32 v4, 7, v2
    v_lshrrev_b32 v5, 4, v2
    v_xor_b32 v4, v4, v5
    v_mul_u32_u24 v6, 1280, v3
    v_lshl_add_u32 v6, v4, 4, v6
    v_xor_b32 v7, 64, v6
    s_lshl_b32 s10, s5, 7
    s_lshl_b32 s11, s9, 6
    s_add_u32 s10, s10, s11
    s_mul_i32 s10, s10, 1280
    s_mov_b32 s56, 128
    s_lshl_b32 s57, s9, 13
    s_mov_b64 s[62:63], -1

    s_add_u32 s11, s10, 0
    v_add_u32 v8, s11, v6
    s_add_u32 s11, s10, 10240
    v_add_u32 v9, s11, v7
    s_add_u32 s11, s10, 20480
    v_add_u32 v10, s11, v6
    s_add_u32 s11, s10, 30720
    v_add_u32 v11, s11, v7
    s_add_u32 s11, s10, 40960
    v_add_u32 v12, s11, v6
    s_add_u32 s11, s10, 51200
    v_add_u32 v13, s11, v7
    s_add_u32 s11, s10, 61440
    v_add_u32 v14, s11, v6
    s_add_u32 s11, s10, 71680
    v_add_u32 v15, s11, v7
    s_branch L_g1a_load
L_g1a_wl:
    s_mov_b32 s52, s18
    s_mov_b32 s53, s19
    s_mov_b32 s54, 2457600
    s_mov_b32 s55, 0x00020000
    s_sub_u32 s12, s9, 2
    v_lshrrev_b32 v5, 4, v2
    v_and_b32 v4, 15, v2
    v_lshlrev_b32 v6, 2, v5
    v_sub_u32 v4, v4, v6
    v_and_b32 v4, 15, v4
    v_mul_u32_u24 v6, 3840, v5
    v_lshl_add_u32 v6, v4, 4, v6
    s_mul_i32 s10, s12, 122880
    s_mul_i32 s11, s6, 240
    s_add_u32 s10, s10, s11
    s_mov_b32 s56, 245760
    s_lshl_b32 s57, s12, 13
    s_add_u32 s57, s57, 16384
    s_mov_b32 s62, 0xfff77fff
    s_mov_b32 s63, 0xf7ffff7f

    s_add_u32 s11, s10, 0
    v_add_u32 v8, s11, v6
    s_add_u32 s11, s10, 15360
    v_add_u32 v9, s11, v6
    s_add_u32 s11, s10, 30720
    v_add_u32 v10, s11, v6
    s_add_u32 s11, s10, 46080
    v_add_u32 v11, s11, v6
    s_add_u32 s11, s10, 61440
    v_add_u32 v12, s11, v6
    s_add_u32 s11, s10, 76800
    v_add_u32 v13, s11, v6
    s_add_u32 s11, s10, 92160
    v_add_u32 v14, s11, v6
    s_add_u32 s11, s10, 107520
    v_add_u32 v15, s11, v6
L_g1a_load:
    s_mov_b32 s58, 0
    s_mov_b64 exec, s[62:63]
    s_add_u32 m0, s57, 0
    s_nop 0
    buffer_load_dwordx4 v8, s[52:55], s58 offen lds
    s_add_u32 m0, s57, 1024
    s_nop 0
    buffer_load_dwordx4 v9, s[52:55], s58 offen lds
    s_add_u32 m0, s57, 2048
    s_nop 0
    buffer_load_dwordx4 v10, s[52:55], s58 offen lds
    s_add_u32 m0, s57, 3072
    s_nop 0
    buffer_load_dwordx4 v11, s[52:55], s58 offen lds
    s_add_u32 m0, s57, 4096
    s_nop 0
    buffer_load_dwordx4 v12, s[52:55], s58 offen lds
    s_add_u32 m0, s57, 5120
    s_nop 0
    buffer_load_dwordx4 v13, s[52:55], s58 offen lds
    s_add_u32 m0, s57, 6144
    s_nop 0
    buffer_load_dwordx4 v14, s[52:55], s58 offen lds
    s_add_u32 m0, s57, 7168
    s_nop 0
    buffer_load_dwordx4 v15, s[52:55], s58 offen lds
    s_add_u32 s58, s58, s56
    s_add_u32 m0, s57, 32768
    s_nop 0
    buffer_load_dwordx4 v8, s[52:55], s58 offen lds
    s_add_u32 m0, s57, 33792
    s_nop 0
    buffer_load_dwordx4 v9, s[52:55], s58 offen lds
    s_add_u32 m0, s57, 34816
    s_nop 0
    buffer_load_dwordx4 v10, s[52:55], s58 offen lds
    s_add_u32 m0, s57, 35840
    s_nop 0
    buffer_load_dwordx4 v11, s[52:55], s58 offen lds
    s_add_u32 m0, s57, 36864
    s_nop 0
    buffer_load_dwordx4 v12, s[52:55], s58 offen lds
    s_add_u32 m0, s57, 37888
    s_nop 0
    buffer_load_dwordx4 v13, s[52:55], s58 offen lds
    s_add_u32 m0, s57, 38912
    s_nop 0
    buffer_load_dwordx4 v14, s[52:55], s58 offen lds
    s_add_u32 m0, s57, 39936
    s_nop 0
    buffer_load_dwordx4 v15, s[52:55], s58 offen lds
    s_add_u32 s58, s58, s56
    s_waitcnt vmcnt(8)
    s_barrier
    s_add_u32 m0, s57, 65536
    s_nop 0
    buffer_load_dwordx4 v8, s[52:55], s58 offen lds
    s_add_u32 m0, s57, 66560
    s_nop 0
    buffer_load_dwordx4 v9, s[52:55], s58 offen lds
    s_add_u32 m0, s57, 67584
    s_nop 0
    buffer_load_dwordx4 v10, s[52:55], s58 offen lds
    s_add_u32 m0, s57, 68608
    s_nop 0
    buffer_load_dwordx4 v11, s[52:55], s58 offen lds
    s_add_u32 m0, s57, 69632
    s_nop 0
    buffer_load_dwordx4 v12, s[52:55], s58 offen lds
    s_add_u32 m0, s57, 70656
    s_nop 0
    buffer_load_dwordx4 v13, s[52:55], s58 offen lds
    s_add_u32 m0, s57, 71680
    s_nop 0
    buffer_load_dwordx4 v14, s[52:55], s58 offen lds
    s_add_u32 m0, s57, 72704
    s_nop 0
    buffer_load_dwordx4 v15, s[52:55], s58 offen lds
    s_add_u32 s58, s58, s56
    s_waitcnt vmcnt(8)
    s_barrier
    s_add_u32 m0, s57, 98304
    s_nop 0
    buffer_load_dwordx4 v8, s[52:55], s58 offen lds
    s_add_u32 m0, s57, 99328
    s_nop 0
    buffer_load_dwordx4 v9, s[52:55], s58 offen lds
    s_add_u32 m0, s57, 100352
    s_nop 0
    buffer_load_dwordx4 v10, s[52:55], s58 offen lds
    s_add_u32 m0, s57, 101376
    s_nop 0
    buffer_load_dwordx4 v11, s[52:55], s58 offen lds
    s_add_u32 m0, s57, 102400
    s_nop 0
    buffer_load_dwordx4 v12, s[52:55], s58 offen lds
    s_add_u32 m0, s57, 103424
    s_nop 0
    buffer_load_dwordx4 v13, s[52:55], s58 offen lds
    s_add_u32 m0, s57, 104448
    s_nop 0
    buffer_load_dwordx4 v14, s[52:55], s58 offen lds
    s_add_u32 m0, s57, 105472
    s_nop 0
    buffer_load_dwordx4 v15, s[52:55], s58 offen lds
    s_add_u32 s58, s58, s56
    s_waitcnt vmcnt(8)
    s_barrier
    s_add_u32 m0, s57, 0
    s_nop 0
    buffer_load_dwordx4 v8, s[52:55], s58 offen lds
    s_add_u32 m0, s57, 1024
    s_nop 0
    buffer_load_dwordx4 v9, s[52:55], s58 offen lds
    s_add_u32 m0, s57, 2048
    s_nop 0
    buffer_load_dwordx4 v10, s[52:55], s58 offen lds
    s_add_u32 m0, s57, 3072
    s_nop 0
    buffer_load_dwordx4 v11, s[52:55], s58 offen lds
    s_add_u32 m0, s57, 4096
    s_nop 0
    buffer_load_dwordx4 v12, s[52:55], s58 offen lds
    s_add_u32 m0, s57, 5120
    s_nop 0
    buffer_load_dwordx4 v13, s[52:55], s58 offen lds
    s_add_u32 m0, s57, 6144
    s_nop 0
    buffer_load_dwordx4 v14, s[52:55], s58 offen lds
    s_add_u32 m0, s57, 7168
    s_nop 0
    buffer_load_dwordx4 v15, s[52:55], s58 offen lds
    s_add_u32 s58, s58, s56
    s_waitcnt vmcnt(8)
    s_barrier
    s_add_u32 m0, s57, 32768
    s_nop 0
    buffer_load_dwordx4 v8, s[52:55], s58 offen lds
    s_add_u32 m0, s57, 33792
    s_nop 0
    buffer_load_dwordx4 v9, s[52:55], s58 offen lds
    s_add_u32 m0, s57, 34816
    s_nop 0
    buffer_load_dwordx4 v10, s[52:55], s58 offen lds
    s_add_u32 m0, s57, 35840
    s_nop 0
    buffer_load_dwordx4 v11, s[52:55], s58 offen lds
    s_add_u32 m0, s57, 36864
    s_nop 0
    buffer_load_dwordx4 v12, s[52:55], s58 offen lds
    s_add_u32 m0, s57, 37888
    s_nop 0
    buffer_load_dwordx4 v13, s[52:55], s58 offen lds
    s_add_u32 m0, s57, 38912
    s_nop 0
    buffer_load_dwordx4 v14, s[52:55], s58 offen lds
    s_add_u32 m0, s57, 39936
    s_nop 0
    buffer_load_dwordx4 v15, s[52:55], s58 offen lds
    s_add_u32 s58, s58, s56
    s_waitcnt vmcnt(8)
    s_barrier
    s_add_u32 m0, s57, 65536
    s_nop 0
    buffer_load_dwordx4 v8, s[52:55], s58 offen lds
    s_add_u32 m0, s57, 66560
    s_nop 0
    buffer_load_dwordx4 v9, s[52:55], s58 offen lds
    s_add_u32 m0, s57, 67584
    s_nop 0
    buffer_load_dwordx4 v10, s[52:55], s58 offen lds
    s_add_u32 m0, s57, 68608
    s_nop 0
    buffer_load_dwordx4 v11, s[52:55], s58 offen lds
    s_add_u32 m0, s57, 69632
    s_nop 0
    buffer_load_dwordx4 v12, s[52:55], s58 offen lds
    s_add_u32 m0, s57, 70656
    s_nop 0
    buffer_load_dwordx4 v13, s[52:55], s58 offen lds
    s_add_u32 m0, s57, 71680
    s_nop 0
    buffer_load_dwordx4 v14, s[52:55], s58 offen lds
    s_add_u32 m0, s57, 72704
    s_nop 0
    buffer_load_dwordx4 v15, s[52:55], s58 offen lds
    s_add_u32 s58, s58, s56
    s_waitcnt vmcnt(8)
    s_barrier
    s_add_u32 m0, s57, 98304
    s_nop 0
    buffer_load_dwordx4 v8, s[52:55], s58 offen lds
    s_add_u32 m0, s57, 99328
    s_nop 0
    buffer_load_dwordx4 v9, s[52:55], s58 offen lds
    s_add_u32 m0, s57, 100352
    s_nop 0
    buffer_load_dwordx4 v10, s[52:55], s58 offen lds
    s_add_u32 m0, s57, 101376
    s_nop 0
    buffer_load_dwordx4 v11, s[52:55], s58 offen lds
    s_add_u32 m0, s57, 102400
    s_nop 0
    buffer_load_dwordx4 v12, s[52:55], s58 offen lds
    s_add_u32 m0, s57, 103424
    s_nop 0
    buffer_load_dwordx4 v13, s[52:55], s58 offen lds
    s_add_u32 m0, s57, 104448
    s_nop 0
    buffer_load_dwordx4 v14, s[52:55], s58 offen lds
    s_add_u32 m0, s57, 105472
    s_nop 0
    buffer_load_dwordx4 v15, s[52:55], s58 offen lds
    s_add_u32 s58, s58, s56
    s_waitcnt vmcnt(8)
    s_barrier
    s_add_u32 m0, s57, 0
    s_nop 0
    buffer_load_dwordx4 v8, s[52:55], s58 offen lds
    s_add_u32 m0, s57, 1024
    s_nop 0
    buffer_load_dwordx4 v9, s[52:55], s58 offen lds
    s_add_u32 m0, s57, 2048
    s_nop 0
    buffer_load_dwordx4 v10, s[52:55], s58 offen lds
    s_add_u32 m0, s57, 3072
    s_nop 0
    buffer_load_dwordx4 v11, s[52:55], s58 offen lds
    s_add_u32 m0, s57, 4096
    s_nop 0
    buffer_load_dwordx4 v12, s[52:55], s58 offen lds
    s_add_u32 m0, s57, 5120
    s_nop 0
    buffer_load_dwordx4 v13, s[52:55], s58 offen lds
    s_add_u32 m0, s57, 6144
    s_nop 0
    buffer_load_dwordx4 v14, s[52:55], s58 offen lds
    s_add_u32 m0, s57, 7168
    s_nop 0
    buffer_load_dwordx4 v15, s[52:55], s58 offen lds
    s_add_u32 s58, s58, s56
    s_waitcnt vmcnt(8)
    s_barrier
    s_add_u32 m0, s57, 32768
    s_nop 0
    buffer_load_dwordx4 v8, s[52:55], s58 offen lds
    s_add_u32 m0, s57, 33792
    s_nop 0
    buffer_load_dwordx4 v9, s[52:55], s58 offen lds
    s_add_u32 m0, s57, 34816
    s_nop 0
    buffer_load_dwordx4 v10, s[52:55], s58 offen lds
    s_add_u32 m0, s57, 35840
    s_nop 0
    buffer_load_dwordx4 v11, s[52:55], s58 offen lds
    s_add_u32 m0, s57, 36864
    s_nop 0
    buffer_load_dwordx4 v12, s[52:55], s58 offen lds
    s_add_u32 m0, s57, 37888
    s_nop 0
    buffer_load_dwordx4 v13, s[52:55], s58 offen lds
    s_add_u32 m0, s57, 38912
    s_nop 0
    buffer_load_dwordx4 v14, s[52:55], s58 offen lds
    s_add_u32 m0, s57, 39936
    s_nop 0
    buffer_load_dwordx4 v15, s[52:55], s58 offen lds
    s_add_u32 s58, s58, s56
    s_waitcnt vmcnt(8)
    s_barrier
    s_waitcnt vmcnt(0)
    s_barrier
    s_endpgm
L_g1a_stats:
    s_sub_u32 s9, s7, 8
    s_cmp_lg_u32 s9, 0
    s_cbranch_scc1 L_g1a_nocpf
L_g1a_nocpf:
    s_add_u32 s44, s34, 44564480
    s_addc_u32 s45, s35, 0
    s_mov_b32 s46, 46080
    s_mov_b32 s47, 0x00020000
    s_cmp_lg_u32 s9, 3
    s_cbranch_scc1 L_g1a_nofl
    s_lshl_b32 s10, s2, 8
    v_lshlrev_b32 v82, 2, v2
    v_mov_b32 v83, 0
    buffer_store_dword v83, v82, s[44:47], s10 offen

L_g1a_nofl:
    s_mov_b32 s44, s16
    s_mov_b32 s45, s17
    s_mov_b32 s46, 2621440
    s_mov_b32 s47, 0x00020000
    s_mov_b64 s[62:63], 0
    s_cmp_eq_u32 s9, 1
    s_cbranch_scc0 L_g1a_tw
    s_mov_b64 s[62:63], 0xffff
    s_and_b32 s10, s6, 7
    s_lshl_b32 s10, s10, 4
    s_lshl_b32 s11, s5, 7
    s_add_u32 s10, s10, s11
    v_add_u32 v82, s10, v2
    v_mul_u32_u24 v82, 1280, v82
    s_movk_i32 s56, 128
    s_branch L_g1a_tgo

L_g1a_tw:
    v_mov_b32 v82, 0
    s_mov_b32 s56, 0
    s_cmp_eq_u32 s9, 2
    s_cbranch_scc0 L_g1a_tgo
    s_mov_b32 s62, -1
    s_movk_i32 s63, 0x7fff
    s_or_b32 s63, s63, 0x8000

    s_mov_b32 s44, s18
    s_mov_b32 s45, s19
    s_mov_b32 s46, 2457600
    s_mov_b32 s47, 0x00020000
    v_mul_u32_u24 v83, 21846, v2
    v_lshrrev_b32 v83, 16, v83
    v_mul_u32_u24 v84, 3, v83
    v_sub_u32 v84, v2, v84
    v_mul_u32_u24 v84, 118, v84
    s_and_b32 s10, s5, 3
    s_lshl_b32 s10, s10, 4
    v_add_u32 v83, s10, v83
    v_mul_u32_u24 v83, 3840, v83
    v_add_u32 v82, v83, v84
    s_mul_i32 s11, s6, 240
    v_add_u32 v82, s11, v82
    v_and_b32 v82, -4, v82
    s_mov_b32 s56, 245760

L_g1a_tgo:
    s_lshl_b32 s58, s56, 1
    s_cmp_eq_u32 s56, 0
    s_cbranch_scc1 L_nt_1
    s_mov_b64 exec, s[62:63]
    buffer_load_dword v85, v82, s[44:47], s58 offen
    s_mov_b64 exec, -1
    s_add_u32 s58, s58, s56

L_nt_1:
    s_cmp_eq_u32 s56, 0
    s_cbranch_scc1 L_nt_2
    s_mov_b64 exec, s[62:63]
    buffer_load_dword v85, v82, s[44:47], s58 offen
    s_mov_b64 exec, -1
    s_add_u32 s58, s58, s56

L_nt_2:
    s_cmp_eq_u32 s56, 0
    s_cbranch_scc1 L_nt_3
    s_mov_b64 exec, s[62:63]
    buffer_load_dword v85, v82, s[44:47], s58 offen
    s_mov_b64 exec, -1
    s_add_u32 s58, s58, s56

L_nt_3:
    s_cmp_eq_u32 s56, 0
    s_cbranch_scc1 L_nt_4
    s_mov_b64 exec, s[62:63]
    buffer_load_dword v85, v82, s[44:47], s58 offen
    s_mov_b64 exec, -1
    s_add_u32 s58, s58, s56

L_nt_4:
    v_and_b32 v3, 31, v2
    v_lshrrev_b32 v4, 5, v2
    s_lshl_b32 s10, s9, 5
    v_add_u32 v5, s10, v3
    v_lshlrev_b32 v5, 7, v5
    v_lshrrev_b32 v6, 1, v3
    v_and_b32 v6, 7, v6
    v_lshlrev_b32 v7, 2, v4
    v_xor_b32 v6, v6, v7
    v_and_b32 v20, 3, v6
    v_and_b32 v6, 4, v6
    v_lshl_add_u32 v5, v6, 4, v5

    v_xor_b32 v6, 0, v20
    v_lshl_add_u32 v72, v6, 4, v5
    v_add_u32 v76, 65536, v72
    v_xor_b32 v6, 1, v20
    v_lshl_add_u32 v73, v6, 4, v5
    v_add_u32 v77, 65536, v73
    v_xor_b32 v6, 2, v20
    v_lshl_add_u32 v74, v6, 4, v5
    v_add_u32 v78, 65536, v74
    v_xor_b32 v6, 3, v20
    v_lshl_add_u32 v75, v6, 4, v5
    v_add_u32 v79, 65536, v75
    v_mov_b32 v56, 0
    v_mov_b32 v57, 0
    v_mov_b32 v58, 0
    v_mov_b32 v59, 0
    v_mov_b32 v60, 0
    v_mov_b32 v61, 0
    v_mov_b32 v62, 0
    v_mov_b32 v63, 0
    v_mov_b32 v64, 0
    v_mov_b32 v65, 0
    v_mov_b32 v66, 0
    v_mov_b32 v67, 0
    s_barrier
    s_cmp_eq_u32 s56, 0
    s_cbranch_scc1 L_nt_5
    s_mov_b64 exec, s[62:63]
    buffer_load_dword v85, v82, s[44:47], s58 offen
    s_mov_b64 exec, -1
    s_add_u32 s58, s58, s56

L_nt_5:
    ds_read_b128 v[24:27], v72 offset:0
    ds_read_b128 v[28:31], v73 offset:0
    ds_read_b128 v[32:35], v74 offset:0
    ds_read_b128 v[36:39], v75 offset:0
    s_waitcnt lgkmcnt(3)
    v_lshlrev_b32 v68, 16, v24
    v_and_b32 v69, 0xffff0000, v24
    v_add_f32 v56, v56, v68
    v_add_f32 v57, v57, v69
    v_fmac_f32 v58, v68, v68
    v_fmac_f32 v59, v69, v69
    v_lshlrev_b32 v70, 16, v25
    v_and_b32 v71, 0xffff0000, v25
    v_add_f32 v56, v56, v70
    v_add_f32 v57, v57, v71
    v_fmac_f32 v58, v70, v70
    v_fmac_f32 v59, v71, v71
    v_lshlrev_b32 v68, 16, v26
    v_and_b32 v69, 0xffff0000, v26
    v_add_f32 v56, v56, v68
    v_add_f32 v57, v57, v69
    v_fmac_f32 v58, v68, v68
    v_fmac_f32 v59, v69, v69
    v_lshlrev_b32 v70, 16, v27
    v_and_b32 v71, 0xffff0000, v27
    v_add_f32 v56, v56, v70
    v_add_f32 v57, v57, v71
    v_fmac_f32 v58, v70, v70
    v_fmac_f32 v59, v71, v71
    s_waitcnt lgkmcnt(2)
    v_lshlrev_b32 v68, 16, v28
    v_and_b32 v69, 0xffff0000, v28
    v_add_f32 v56, v56, v68
    v_add_f32 v57, v57, v69
    v_fmac_f32 v58, v68, v68
    v_fmac_f32 v59, v69, v69
    v_lshlrev_b32 v70, 16, v29
    v_and_b32 v71, 0xffff0000, v29
    v_add_f32 v56, v56, v70
    v_add_f32 v57, v57, v71
    v_fmac_f32 v58, v70, v70
    v_fmac_f32 v59, v71, v71
    v_lshlrev_b32 v68, 16, v30
    v_and_b32 v69, 0xffff0000, v30
    v_add_f32 v56, v56, v68
    v_add_f32 v57, v57, v69
    v_fmac_f32 v58, v68, v68
    v_fmac_f32 v59, v69, v69
    v_lshlrev_b32 v70, 16, v31
    v_and_b32 v71, 0xffff0000, v31
    v_add_f32 v56, v56, v70
    v_add_f32 v57, v57, v71
    v_fmac_f32 v58, v70, v70
    v_fmac_f32 v59, v71, v71
    s_waitcnt lgkmcnt(1)
    v_lshlrev_b32 v68, 16, v32
    v_and_b32 v69, 0xffff0000, v32
    v_add_f32 v56, v56, v68
    v_add_f32 v57, v57, v69
    v_fmac_f32 v58, v68, v68
    v_fmac_f32 v59, v69, v69
    v_lshlrev_b32 v70, 16, v33
    v_and_b32 v71, 0xffff0000, v33
    v_add_f32 v56, v56, v70
    v_add_f32 v57, v57, v71
    v_fmac_f32 v58, v70, v70
    v_fmac_f32 v59, v71, v71
    v_lshlrev_b32 v68, 16, v34
    v_and_b32 v69, 0xffff0000, v34
    v_add_f32 v56, v56, v68
    v_add_f32 v57, v57, v69
    v_fmac_f32 v58, v68, v68
    v_fmac_f32 v59, v69, v69
    v_lshlrev_b32 v70, 16, v35
    v_and_b32 v71, 0xffff0000, v35
    v_add_f32 v56, v56, v70
    v_add_f32 v57, v57, v71
    v_fmac_f32 v58, v70, v70
    v_fmac_f32 v59, v71, v71
    s_waitcnt lgkmcnt(0)
    v_lshlrev_b32 v68, 16, v36
    v_and_b32 v69, 0xffff0000, v36
    v_add_f32 v56, v56, v68
    v_add_f32 v57, v57, v69
    v_fmac_f32 v58, v68, v68
    v_fmac_f32 v59, v69, v69
    v_lshlrev_b32 v70, 16, v37
    v_and_b32 v71, 0xffff0000, v37
    v_add_f32 v56, v56, v70
    v_add_f32 v57, v57, v71
    v_fmac_f32 v58, v70, v70
    v_fmac_f32 v59, v71, v71
    v_lshlrev_b32 v68, 16, v38
    v_and_b32 v69, 0xffff0000, v38
    v_add_f32 v56, v56, v68
    v_add_f32 v57, v57, v69
    v_fmac_f32 v58, v68, v68
    v_fmac_f32 v59, v69, v69
    v_lshlrev_b32 v70, 16, v39
    v_and_b32 v71, 0xffff0000, v39
    v_add_f32 v56, v56, v70
    v_add_f32 v57, v57, v71
    v_fmac_f32 v58, v70, v70
    v_fmac_f32 v59, v71, v71
    s_barrier
    s_cmp_eq_u32 s56, 0
    s_cbranch_scc1 L_nt_6
    s_mov_b64 exec, s[62:63]
    buffer_load_dword v85, v82, s[44:47], s58 offen
    s_mov_b64 exec, -1
    s_add_u32 s58, s58, s56

L_nt_6:
    ds_read_b128 v[24:27], v72 offset:32768
    ds_read_b128 v[28:31], v73 offset:32768
    ds_read_b128 v[32:35], v74 offset:32768
    ds_read_b128 v[36:39], v75 offset:32768
    s_waitcnt lgkmcnt(3)
    v_lshlrev_b32 v68, 16, v24
    v_and_b32 v69, 0xffff0000, v24
    v_add_f32 v56, v56, v68
    v_add_f32 v57, v57, v69
    v_fmac_f32 v58, v68, v68
    v_fmac_f32 v59, v69, v69
    v_lshlrev_b32 v70, 16, v25
    v_and_b32 v71, 0xffff0000, v25
    v_add_f32 v56, v56, v70
    v_add_f32 v57, v57, v71
    v_fmac_f32 v58, v70, v70
    v_fmac_f32 v59, v71, v71
    v_lshlrev_b32 v68, 16, v26
    v_and_b32 v69, 0xffff0000, v26
    v_add_f32 v56, v56, v68
    v_add_f32 v57, v57, v69
    v_fmac_f32 v58, v68, v68
    v_fmac_f32 v59, v69, v69
    v_lshlrev_b32 v70, 16, v27
    v_and_b32 v71, 0xffff0000, v27
    v_add_f32 v56, v56, v70
    v_add_f32 v57, v57, v71
    v_fmac_f32 v58, v70, v70
    v_fmac_f32 v59, v71, v71
    s_waitcnt lgkmcnt(2)
    v_lshlrev_b32 v68, 16, v28
    v_and_b32 v69, 0xffff0000, v28
    v_add_f32 v56, v56, v68
    v_add_f32 v57, v57, v69
    v_fmac_f32 v58, v68, v68
    v_fmac_f32 v59, v69, v69
    v_lshlrev_b32 v70, 16, v29
    v_and_b32 v71, 0xffff0000, v29
    v_add_f32 v56, v56, v70
    v_add_f32 v57, v57, v71
    v_fmac_f32 v58, v70, v70
    v_fmac_f32 v59, v71, v71
    v_lshlrev_b32 v68, 16, v30
    v_and_b32 v69, 0xffff0000, v30
    v_add_f32 v56, v56, v68
    v_add_f32 v57, v57, v69
    v_fmac_f32 v58, v68, v68
    v_fmac_f32 v59, v69, v69
    v_lshlrev_b32 v70, 16, v31
    v_and_b32 v71, 0xffff0000, v31
    v_add_f32 v56, v56, v70
    v_add_f32 v57, v57, v71
    v_fmac_f32 v58, v70, v70
    v_fmac_f32 v59, v71, v71
    s_waitcnt lgkmcnt(1)
    v_lshlrev_b32 v68, 16, v32
    v_and_b32 v69, 0xffff0000, v32
    v_add_f32 v56, v56, v68
    v_add_f32 v57, v57, v69
    v_fmac_f32 v58, v68, v68
    v_fmac_f32 v59, v69, v69
    v_lshlrev_b32 v70, 16, v33
    v_and_b32 v71, 0xffff0000, v33
    v_add_f32 v56, v56, v70
    v_add_f32 v57, v57, v71
    v_fmac_f32 v58, v70, v70
    v_fmac_f32 v59, v71, v71
    v_lshlrev_b32 v68, 16, v34
    v_and_b32 v69, 0xffff0000, v34
    v_add_f32 v56, v56, v68
    v_add_f32 v57, v57, v69
    v_fmac_f32 v58, v68, v68
    v_fmac_f32 v59, v69, v69
    v_lshlrev_b32 v70, 16, v35
    v_and_b32 v71, 0xffff0000, v35
    v_add_f32 v56, v56, v70
    v_add_f32 v57, v57, v71
    v_fmac_f32 v58, v70, v70
    v_fmac_f32 v59, v71, v71
    s_waitcnt lgkmcnt(0)
    v_lshlrev_b32 v68, 16, v36
    v_and_b32 v69, 0xffff0000, v36
    v_add_f32 v56, v56, v68
    v_add_f32 v57, v57, v69
    v_fmac_f32 v58, v68, v68
    v_fmac_f32 v59, v69, v69
    v_lshlrev_b32 v70, 16, v37
    v_and_b32 v71, 0xffff0000, v37
    v_add_f32 v56, v56, v70
    v_add_f32 v57, v57, v71
    v_fmac_f32 v58, v70, v70
    v_fmac_f32 v59, v71, v71
    v_lshlrev_b32 v68, 16, v38
    v_and_b32 v69, 0xffff0000, v38
    v_add_f32 v56, v56, v68
    v_add_f32 v57, v57, v69
    v_fmac_f32 v58, v68, v68
    v_fmac_f32 v59, v69, v69
    v_lshlrev_b32 v70, 16, v39
    v_and_b32 v71, 0xffff0000, v39
    v_add_f32 v56, v56, v70
    v_add_f32 v57, v57, v71
    v_fmac_f32 v58, v70, v70
    v_fmac_f32 v59, v71, v71
    s_barrier
    s_cmp_eq_u32 s56, 0
    s_cbranch_scc1 L_nt_7
    s_mov_b64 exec, s[62:63]
    buffer_load_dword v85, v82, s[44:47], s58 offen
    s_mov_b64 exec, -1
    s_add_u32 s58, s58, s56

L_nt_7:
    ds_read_b128 v[24:27], v76 offset:0
    ds_read_b128 v[28:31], v77 offset:0
    ds_read_b128 v[32:35], v78 offset:0
    ds_read_b128 v[36:39], v79 offset:0
    s_waitcnt lgkmcnt(3)
    v_lshlrev_b32 v68, 16, v24
    v_and_b32 v69, 0xffff0000, v24
    v_add_f32 v56, v56, v68
    v_add_f32 v57, v57, v69
    v_fmac_f32 v58, v68, v68
    v_fmac_f32 v59, v69, v69
    v_lshlrev_b32 v70, 16, v25
    v_and_b32 v71, 0xffff0000, v25
    v_add_f32 v56, v56, v70
    v_add_f32 v57, v57, v71
    v_fmac_f32 v58, v70, v70
    v_fmac_f32 v59, v71, v71
    v_lshlrev_b32 v68, 16, v26
    v_and_b32 v69, 0xffff0000, v26
    v_add_f32 v56, v56, v68
    v_add_f32 v57, v57, v69
    v_fmac_f32 v58, v68, v68
    v_fmac_f32 v59, v69, v69
    v_lshlrev_b32 v70, 16, v27
    v_and_b32 v71, 0xffff0000, v27
    v_add_f32 v56, v56, v70
    v_add_f32 v57, v57, v71
    v_fmac_f32 v58, v70, v70
    v_fmac_f32 v59, v71, v71
    s_waitcnt lgkmcnt(2)
    v_lshlrev_b32 v68, 16, v28
    v_and_b32 v69, 0xffff0000, v28
    v_add_f32 v56, v56, v68
    v_add_f32 v57, v57, v69
    v_fmac_f32 v58, v68, v68
    v_fmac_f32 v59, v69, v69
    v_lshlrev_b32 v70, 16, v29
    v_and_b32 v71, 0xffff0000, v29
    v_add_f32 v56, v56, v70
    v_add_f32 v57, v57, v71
    v_fmac_f32 v58, v70, v70
    v_fmac_f32 v59, v71, v71
    v_lshlrev_b32 v68, 16, v30
    v_and_b32 v69, 0xffff0000, v30
    v_add_f32 v56, v56, v68
    v_add_f32 v57, v57, v69
    v_fmac_f32 v58, v68, v68
    v_fmac_f32 v59, v69, v69
    v_lshlrev_b32 v70, 16, v31
    v_and_b32 v71, 0xffff0000, v31
    v_add_f32 v56, v56, v70
    v_add_f32 v57, v57, v71
    v_fmac_f32 v58, v70, v70
    v_fmac_f32 v59, v71, v71
    s_waitcnt lgkmcnt(1)
    v_lshlrev_b32 v68, 16, v32
    v_and_b32 v69, 0xffff0000, v32
    v_add_f32 v56, v56, v68
    v_add_f32 v57, v57, v69
    v_fmac_f32 v58, v68, v68
    v_fmac_f32 v59, v69, v69
    v_lshlrev_b32 v70, 16, v33
    v_and_b32 v71, 0xffff0000, v33
    v_add_f32 v56, v56, v70
    v_add_f32 v57, v57, v71
    v_fmac_f32 v58, v70, v70
    v_fmac_f32 v59, v71, v71
    v_lshlrev_b32 v68, 16, v34
    v_and_b32 v69, 0xffff0000, v34
    v_add_f32 v56, v56, v68
    v_add_f32 v57, v57, v69
    v_fmac_f32 v58, v68, v68
    v_fmac_f32 v59, v69, v69
    v_lshlrev_b32 v70, 16, v35
    v_and_b32 v71, 0xffff0000, v35
    v_add_f32 v56, v56, v70
    v_add_f32 v57, v57, v71
    v_fmac_f32 v58, v70, v70
    v_fmac_f32 v59, v71, v71
    s_waitcnt lgkmcnt(0)
    v_lshlrev_b32 v68, 16, v36
    v_and_b32 v69, 0xffff0000, v36
    v_add_f32 v56, v56, v68
    v_add_f32 v57, v57, v69
    v_fmac_f32 v58, v68, v68
    v_fmac_f32 v59, v69, v69
    v_lshlrev_b32 v70, 16, v37
    v_and_b32 v71, 0xffff0000, v37
    v_add_f32 v56, v56, v70
    v_add_f32 v57, v57, v71
    v_fmac_f32 v58, v70, v70
    v_fmac_f32 v59, v71, v71
    v_lshlrev_b32 v68, 16, v38
    v_and_b32 v69, 0xffff0000, v38
    v_add_f32 v56, v56, v68
    v_add_f32 v57, v57, v69
    v_fmac_f32 v58, v68, v68
    v_fmac_f32 v59, v69, v69
    v_lshlrev_b32 v70, 16, v39
    v_and_b32 v71, 0xffff0000, v39
    v_add_f32 v56, v56, v70
    v_add_f32 v57, v57, v71
    v_fmac_f32 v58, v70, v70
    v_fmac_f32 v59, v71, v71
    s_barrier
    s_cmp_eq_u32 s56, 0
    s_cbranch_scc1 L_nt_8
    s_mov_b64 exec, s[62:63]
    buffer_load_dword v85, v82, s[44:47], s58 offen
    s_mov_b64 exec, -1
    s_add_u32 s58, s58, s56

L_nt_8:
    ds_read_b128 v[24:27], v76 offset:32768
    ds_read_b128 v[28:31], v77 offset:32768
    ds_read_b128 v[32:35], v78 offset:32768
    ds_read_b128 v[36:39], v79 offset:32768
    s_waitcnt lgkmcnt(3)
    v_lshlrev_b32 v68, 16, v24
    v_and_b32 v69, 0xffff0000, v24
    v_add_f32 v56, v56, v68
    v_add_f32 v57, v57, v69
    v_fmac_f32 v58, v68, v68
    v_fmac_f32 v59, v69, v69
    v_lshlrev_b32 v70, 16, v25
    v_and_b32 v71, 0xffff0000, v25
    v_add_f32 v56, v56, v70
    v_add_f32 v57, v57, v71
    v_fmac_f32 v58, v70, v70
    v_fmac_f32 v59, v71, v71
    v_lshlrev_b32 v68, 16, v26
    v_and_b32 v69, 0xffff0000, v26
    v_add_f32 v56, v56, v68
    v_add_f32 v57, v57, v69
    v_fmac_f32 v58, v68, v68
    v_fmac_f32 v59, v69, v69
    v_lshlrev_b32 v70, 16, v27
    v_and_b32 v71, 0xffff0000, v27
    v_add_f32 v56, v56, v70
    v_add_f32 v57, v57, v71
    v_fmac_f32 v58, v70, v70
    v_fmac_f32 v59, v71, v71
    s_waitcnt lgkmcnt(2)
    v_lshlrev_b32 v68, 16, v28
    v_and_b32 v69, 0xffff0000, v28
    v_add_f32 v56, v56, v68
    v_add_f32 v57, v57, v69
    v_fmac_f32 v58, v68, v68
    v_fmac_f32 v59, v69, v69
    v_lshlrev_b32 v70, 16, v29
    v_and_b32 v71, 0xffff0000, v29
    v_add_f32 v56, v56, v70
    v_add_f32 v57, v57, v71
    v_fmac_f32 v58, v70, v70
    v_fmac_f32 v59, v71, v71
    v_lshlrev_b32 v68, 16, v30
    v_and_b32 v69, 0xffff0000, v30
    v_add_f32 v56, v56, v68
    v_add_f32 v57, v57, v69
    v_fmac_f32 v58, v68, v68
    v_fmac_f32 v59, v69, v69
    v_lshlrev_b32 v70, 16, v31
    v_and_b32 v71, 0xffff0000, v31
    v_add_f32 v56, v56, v70
    v_add_f32 v57, v57, v71
    v_fmac_f32 v58, v70, v70
    v_fmac_f32 v59, v71, v71
    s_waitcnt lgkmcnt(1)
    v_lshlrev_b32 v68, 16, v32
    v_and_b32 v69, 0xffff0000, v32
    v_add_f32 v56, v56, v68
    v_add_f32 v57, v57, v69
    v_fmac_f32 v58, v68, v68
    v_fmac_f32 v59, v69, v69
    v_lshlrev_b32 v70, 16, v33
    v_and_b32 v71, 0xffff0000, v33
    v_add_f32 v56, v56, v70
    v_add_f32 v57, v57, v71
    v_fmac_f32 v58, v70, v70
    v_fmac_f32 v59, v71, v71
    v_lshlrev_b32 v68, 16, v34
    v_and_b32 v69, 0xffff0000, v34
    v_add_f32 v56, v56, v68
    v_add_f32 v57, v57, v69
    v_fmac_f32 v58, v68, v68
    v_fmac_f32 v59, v69, v69
    v_lshlrev_b32 v70, 16, v35
    v_and_b32 v71, 0xffff0000, v35
    v_add_f32 v56, v56, v70
    v_add_f32 v57, v57, v71
    v_fmac_f32 v58, v70, v70
    v_fmac_f32 v59, v71, v71
    s_waitcnt lgkmcnt(0)
    v_lshlrev_b32 v68, 16, v36
    v_and_b32 v69, 0xffff0000, v36
    v_add_f32 v56, v56, v68
    v_add_f32 v57, v57, v69
    v_fmac_f32 v58, v68, v68
    v_fmac_f32 v59, v69, v69
    v_lshlrev_b32 v70, 16, v37
    v_and_b32 v71, 0xffff0000, v37
    v_add_f32 v56, v56, v70
    v_add_f32 v57, v57, v71
    v_fmac_f32 v58, v70, v70
    v_fmac_f32 v59, v71, v71
    v_lshlrev_b32 v68, 16, v38
    v_and_b32 v69, 0xffff0000, v38
    v_add_f32 v56, v56, v68
    v_add_f32 v57, v57, v69
    v_fmac_f32 v58, v68, v68
    v_fmac_f32 v59, v69, v69
    v_lshlrev_b32 v70, 16, v39
    v_and_b32 v71, 0xffff0000, v39
    v_add_f32 v56, v56, v70
    v_add_f32 v57, v57, v71
    v_fmac_f32 v58, v70, v70
    v_fmac_f32 v59, v71, v71
    s_barrier
    ds_read_b128 v[24:27], v72 offset:0
    ds_read_b128 v[28:31], v73 offset:0
    ds_read_b128 v[32:35], v74 offset:0
    ds_read_b128 v[36:39], v75 offset:0
    s_waitcnt lgkmcnt(3)
    v_lshlrev_b32 v68, 16, v24
    v_and_b32 v69, 0xffff0000, v24
    v_add_f32 v56, v56, v68
    v_add_f32 v57, v57, v69
    v_fmac_f32 v58, v68, v68
    v_fmac_f32 v59, v69, v69
    v_lshlrev_b32 v70, 16, v25
    v_and_b32 v71, 0xffff0000, v25
    v_add_f32 v56, v56, v70
    v_add_f32 v57, v57, v71
    v_fmac_f32 v58, v70, v70
    v_fmac_f32 v59, v71, v71
    v_lshlrev_b32 v68, 16, v26
    v_and_b32 v69, 0xffff0000, v26
    v_add_f32 v56, v56, v68
    v_add_f32 v57, v57, v69
    v_fmac_f32 v58, v68, v68
    v_fmac_f32 v59, v69, v69
    v_lshlrev_b32 v70, 16, v27
    v_and_b32 v71, 0xffff0000, v27
    v_add_f32 v56, v56, v70
    v_add_f32 v57, v57, v71
    v_fmac_f32 v58, v70, v70
    v_fmac_f32 v59, v71, v71
    s_waitcnt lgkmcnt(2)
    v_lshlrev_b32 v68, 16, v28
    v_and_b32 v69, 0xffff0000, v28
    v_add_f32 v56, v56, v68
    v_add_f32 v57, v57, v69
    v_fmac_f32 v58, v68, v68
    v_fmac_f32 v59, v69, v69
    v_lshlrev_b32 v70, 16, v29
    v_and_b32 v71, 0xffff0000, v29
    v_add_f32 v56, v56, v70
    v_add_f32 v57, v57, v71
    v_fmac_f32 v58, v70, v70
    v_fmac_f32 v59, v71, v71
    v_lshlrev_b32 v68, 16, v30
    v_and_b32 v69, 0xffff0000, v30
    v_add_f32 v56, v56, v68
    v_add_f32 v57, v57, v69
    v_fmac_f32 v58, v68, v68
    v_fmac_f32 v59, v69, v69
    v_lshlrev_b32 v70, 16, v31
    v_and_b32 v71, 0xffff0000, v31
    v_add_f32 v56, v56, v70
    v_add_f32 v57, v57, v71
    v_fmac_f32 v58, v70, v70
    v_fmac_f32 v59, v71, v71
    s_waitcnt lgkmcnt(1)
    v_lshlrev_b32 v68, 16, v32
    v_and_b32 v69, 0xffff0000, v32
    v_add_f32 v56, v56, v68
    v_add_f32 v57, v57, v69
    v_fmac_f32 v58, v68, v68
    v_fmac_f32 v59, v69, v69
    v_lshlrev_b32 v70, 16, v33
    v_and_b32 v71, 0xffff0000, v33
    v_add_f32 v56, v56, v70
    v_add_f32 v57, v57, v71
    v_fmac_f32 v58, v70, v70
    v_fmac_f32 v59, v71, v71
    v_lshlrev_b32 v68, 16, v34
    v_and_b32 v69, 0xffff0000, v34
    v_add_f32 v56, v56, v68
    v_add_f32 v57, v57, v69
    v_fmac_f32 v58, v68, v68
    v_fmac_f32 v59, v69, v69
    v_lshlrev_b32 v70, 16, v35
    v_and_b32 v71, 0xffff0000, v35
    v_add_f32 v56, v56, v70
    v_add_f32 v57, v57, v71
    v_fmac_f32 v58, v70, v70
    v_fmac_f32 v59, v71, v71
    s_waitcnt lgkmcnt(0)
    v_lshlrev_b32 v68, 16, v36
    v_and_b32 v69, 0xffff0000, v36
    v_add_f32 v56, v56, v68
    v_add_f32 v57, v57, v69
    v_fmac_f32 v58, v68, v68
    v_fmac_f32 v59, v69, v69
    v_lshlrev_b32 v70, 16, v37
    v_and_b32 v71, 0xffff0000, v37
    v_add_f32 v56, v56, v70
    v_add_f32 v57, v57, v71
    v_fmac_f32 v58, v70, v70
    v_fmac_f32 v59, v71, v71
    v_lshlrev_b32 v68, 16, v38
    v_and_b32 v69, 0xffff0000, v38
    v_add_f32 v56, v56, v68
    v_add_f32 v57, v57, v69
    v_fmac_f32 v58, v68, v68
    v_fmac_f32 v59, v69, v69
    v_lshlrev_b32 v70, 16, v39
    v_and_b32 v71, 0xffff0000, v39
    v_add_f32 v56, v56, v70
    v_add_f32 v57, v57, v71
    v_fmac_f32 v58, v70, v70
    v_fmac_f32 v59, v71, v71
    s_barrier
    ds_read_b128 v[24:27], v72 offset:32768
    ds_read_b128 v[28:31], v73 offset:32768
    ds_read_b128 v[32:35], v74 offset:32768
    ds_read_b128 v[36:39], v75 offset:32768
    s_waitcnt lgkmcnt(3)
    v_lshlrev_b32 v68, 16, v24
    v_and_b32 v69, 0xffff0000, v24
    v_add_f32 v56, v56, v68
    v_add_f32 v57, v57, v69
    v_fmac_f32 v58, v68, v68
    v_fmac_f32 v59, v69, v69
    v_lshlrev_b32 v70, 16, v25
    v_and_b32 v71, 0xffff0000, v25
    v_add_f32 v56, v56, v70
    v_add_f32 v57, v57, v71
    v_fmac_f32 v58, v70, v70
    v_fmac_f32 v59, v71, v71
    v_lshlrev_b32 v68, 16, v26
    v_and_b32 v69, 0xffff0000, v26
    v_add_f32 v56, v56, v68
    v_add_f32 v57, v57, v69
    v_fmac_f32 v58, v68, v68
    v_fmac_f32 v59, v69, v69
    v_lshlrev_b32 v70, 16, v27
    v_and_b32 v71, 0xffff0000, v27
    v_add_f32 v56, v56, v70
    v_add_f32 v57, v57, v71
    v_fmac_f32 v58, v70, v70
    v_fmac_f32 v59, v71, v71
    s_waitcnt lgkmcnt(2)
    v_lshlrev_b32 v68, 16, v28
    v_and_b32 v69, 0xffff0000, v28
    v_add_f32 v56, v56, v68
    v_add_f32 v57, v57, v69
    v_fmac_f32 v58, v68, v68
    v_fmac_f32 v59, v69, v69
    v_lshlrev_b32 v70, 16, v29
    v_and_b32 v71, 0xffff0000, v29
    v_add_f32 v56, v56, v70
    v_add_f32 v57, v57, v71
    v_fmac_f32 v58, v70, v70
    v_fmac_f32 v59, v71, v71
    v_lshlrev_b32 v68, 16, v30
    v_and_b32 v69, 0xffff0000, v30
    v_add_f32 v56, v56, v68
    v_add_f32 v57, v57, v69
    v_fmac_f32 v58, v68, v68
    v_fmac_f32 v59, v69, v69
    v_lshlrev_b32 v70, 16, v31
    v_and_b32 v71, 0xffff0000, v31
    v_add_f32 v56, v56, v70
    v_add_f32 v57, v57, v71
    v_fmac_f32 v58, v70, v70
    v_fmac_f32 v59, v71, v71
    s_waitcnt lgkmcnt(1)
    v_lshlrev_b32 v68, 16, v32
    v_and_b32 v69, 0xffff0000, v32
    v_add_f32 v56, v56, v68
    v_add_f32 v57, v57, v69
    v_fmac_f32 v58, v68, v68
    v_fmac_f32 v59, v69, v69
    v_lshlrev_b32 v70, 16, v33
    v_and_b32 v71, 0xffff0000, v33
    v_add_f32 v56, v56, v70
    v_add_f32 v57, v57, v71
    v_fmac_f32 v58, v70, v70
    v_fmac_f32 v59, v71, v71
    v_lshlrev_b32 v68, 16, v34
    v_and_b32 v69, 0xffff0000, v34
    v_add_f32 v56, v56, v68
    v_add_f32 v57, v57, v69
    v_fmac_f32 v58, v68, v68
    v_fmac_f32 v59, v69, v69
    v_lshlrev_b32 v70, 16, v35
    v_and_b32 v71, 0xffff0000, v35
    v_add_f32 v56, v56, v70
    v_add_f32 v57, v57, v71
    v_fmac_f32 v58, v70, v70
    v_fmac_f32 v59, v71, v71
    s_waitcnt lgkmcnt(0)
    v_lshlrev_b32 v68, 16, v36
    v_and_b32 v69, 0xffff0000, v36
    v_add_f32 v56, v56, v68
    v_add_f32 v57, v57, v69
    v_fmac_f32 v58, v68, v68
    v_fmac_f32 v59, v69, v69
    v_lshlrev_b32 v70, 16, v37
    v_and_b32 v71, 0xffff0000, v37
    v_add_f32 v56, v56, v70
    v_add_f32 v57, v57, v71
    v_fmac_f32 v58, v70, v70
    v_fmac_f32 v59, v71, v71
    v_lshlrev_b32 v68, 16, v38
    v_and_b32 v69, 0xffff0000, v38
    v_add_f32 v56, v56, v68
    v_add_f32 v57, v57, v69
    v_fmac_f32 v58, v68, v68
    v_fmac_f32 v59, v69, v69
    v_lshlrev_b32 v70, 16, v39
    v_and_b32 v71, 0xffff0000, v39
    v_add_f32 v56, v56, v70
    v_add_f32 v57, v57, v71
    v_fmac_f32 v58, v70, v70
    v_fmac_f32 v59, v71, v71
    s_barrier
    ds_read_b128 v[24:27], v76 offset:0
    ds_read_b128 v[28:31], v77 offset:0
    ds_read_b128 v[32:35], v78 offset:0
    ds_read_b128 v[36:39], v79 offset:0
    s_waitcnt lgkmcnt(3)
    v_lshlrev_b32 v68, 16, v24
    v_and_b32 v69, 0xffff0000, v24
    v_add_f32 v56, v56, v68
    v_add_f32 v57, v57, v69
    v_fmac_f32 v58, v68, v68
    v_fmac_f32 v59, v69, v69
    v_lshlrev_b32 v70, 16, v25
    v_and_b32 v71, 0xffff0000, v25
    v_add_f32 v56, v56, v70
    v_add_f32 v57, v57, v71
    v_fmac_f32 v58, v70, v70
    v_fmac_f32 v59, v71, v71
    v_lshlrev_b32 v68, 16, v26
    v_and_b32 v69, 0xffff0000, v26
    v_add_f32 v56, v56, v68
    v_add_f32 v57, v57, v69
    v_fmac_f32 v58, v68, v68
    v_fmac_f32 v59, v69, v69
    v_lshlrev_b32 v70, 16, v27
    v_and_b32 v71, 0xffff0000, v27
    v_add_f32 v56, v56, v70
    v_add_f32 v57, v57, v71
    v_fmac_f32 v58, v70, v70
    v_fmac_f32 v59, v71, v71
    s_waitcnt lgkmcnt(2)
    v_lshlrev_b32 v68, 16, v28
    v_and_b32 v69, 0xffff0000, v28
    v_add_f32 v56, v56, v68
    v_add_f32 v57, v57, v69
    v_fmac_f32 v58, v68, v68
    v_fmac_f32 v59, v69, v69
    v_lshlrev_b32 v70, 16, v29
    v_and_b32 v71, 0xffff0000, v29
    v_add_f32 v56, v56, v70
    v_add_f32 v57, v57, v71
    v_fmac_f32 v58, v70, v70
    v_fmac_f32 v59, v71, v71
    v_lshlrev_b32 v68, 16, v30
    v_and_b32 v69, 0xffff0000, v30
    v_add_f32 v56, v56, v68
    v_add_f32 v57, v57, v69
    v_fmac_f32 v58, v68, v68
    v_fmac_f32 v59, v69, v69
    v_lshlrev_b32 v70, 16, v31
    v_and_b32 v71, 0xffff0000, v31
    v_add_f32 v56, v56, v70
    v_add_f32 v57, v57, v71
    v_fmac_f32 v58, v70, v70
    v_fmac_f32 v59, v71, v71
    s_waitcnt lgkmcnt(1)
    v_lshlrev_b32 v68, 16, v32
    v_and_b32 v69, 0xffff0000, v32
    v_add_f32 v56, v56, v68
    v_add_f32 v57, v57, v69
    v_fmac_f32 v58, v68, v68
    v_fmac_f32 v59, v69, v69
    v_lshlrev_b32 v70, 16, v33
    v_and_b32 v71, 0xffff0000, v33
    v_add_f32 v56, v56, v70
    v_add_f32 v57, v57, v71
    v_fmac_f32 v58, v70, v70
    v_fmac_f32 v59, v71, v71
    v_lshlrev_b32 v68, 16, v34
    v_and_b32 v69, 0xffff0000, v34
    v_add_f32 v56, v56, v68
    v_add_f32 v57, v57, v69
    v_fmac_f32 v58, v68, v68
    v_fmac_f32 v59, v69, v69
    v_lshlrev_b32 v70, 16, v35
    v_and_b32 v71, 0xffff0000, v35
    v_add_f32 v56, v56, v70
    v_add_f32 v57, v57, v71
    v_fmac_f32 v58, v70, v70
    v_fmac_f32 v59, v71, v71
    s_waitcnt lgkmcnt(0)
    v_lshlrev_b32 v68, 16, v36
    v_and_b32 v69, 0xffff0000, v36
    v_add_f32 v56, v56, v68
    v_add_f32 v57, v57, v69
    v_fmac_f32 v58, v68, v68
    v_fmac_f32 v59, v69, v69
    v_lshlrev_b32 v70, 16, v37
    v_and_b32 v71, 0xffff0000, v37
    v_add_f32 v56, v56, v70
    v_add_f32 v57, v57, v71
    v_fmac_f32 v58, v70, v70
    v_fmac_f32 v59, v71, v71
    v_lshlrev_b32 v68, 16, v38
    v_and_b32 v69, 0xffff0000, v38
    v_add_f32 v56, v56, v68
    v_add_f32 v57, v57, v69
    v_fmac_f32 v58, v68, v68
    v_fmac_f32 v59, v69, v69
    v_lshlrev_b32 v70, 16, v39
    v_and_b32 v71, 0xffff0000, v39
    v_add_f32 v56, v56, v70
    v_add_f32 v57, v57, v71
    v_fmac_f32 v58, v70, v70
    v_fmac_f32 v59, v71, v71
    s_barrier
    ds_read_b128 v[24:27], v76 offset:32768
    ds_read_b128 v[28:31], v77 offset:32768
    ds_read_b128 v[32:35], v78 offset:32768
    ds_read_b128 v[36:39], v79 offset:32768
    s_waitcnt lgkmcnt(3)
    v_lshlrev_b32 v68, 16, v24
    v_and_b32 v69, 0xffff0000, v24
    v_add_f32 v56, v56, v68
    v_add_f32 v57, v57, v69
    v_fmac_f32 v58, v68, v68
    v_fmac_f32 v59, v69, v69
    v_lshlrev_b32 v70, 16, v25
    v_and_b32 v71, 0xffff0000, v25
    v_add_f32 v56, v56, v70
    v_add_f32 v57, v57, v71
    v_fmac_f32 v58, v70, v70
    v_fmac_f32 v59, v71, v71
    v_lshlrev_b32 v68, 16, v26
    v_and_b32 v69, 0xffff0000, v26
    v_add_f32 v56, v56, v68
    v_add_f32 v57, v57, v69
    v_fmac_f32 v58, v68, v68
    v_fmac_f32 v59, v69, v69
    v_lshlrev_b32 v70, 16, v27
    v_and_b32 v71, 0xffff0000, v27
    v_add_f32 v56, v56, v70
    v_add_f32 v57, v57, v71
    v_fmac_f32 v58, v70, v70
    v_fmac_f32 v59, v71, v71
    s_waitcnt lgkmcnt(2)
    v_lshlrev_b32 v68, 16, v28
    v_and_b32 v69, 0xffff0000, v28
    v_add_f32 v56, v56, v68
    v_add_f32 v57, v57, v69
    v_fmac_f32 v58, v68, v68
    v_fmac_f32 v59, v69, v69
    v_lshlrev_b32 v70, 16, v29
    v_and_b32 v71, 0xffff0000, v29
    v_add_f32 v56, v56, v70
    v_add_f32 v57, v57, v71
    v_fmac_f32 v58, v70, v70
    v_fmac_f32 v59, v71, v71
    v_lshlrev_b32 v68, 16, v30
    v_and_b32 v69, 0xffff0000, v30
    v_add_f32 v56, v56, v68
    v_add_f32 v57, v57, v69
    v_fmac_f32 v58, v68, v68
    v_fmac_f32 v59, v69, v69
    v_lshlrev_b32 v70, 16, v31
    v_and_b32 v71, 0xffff0000, v31
    v_add_f32 v56, v56, v70
    v_add_f32 v57, v57, v71
    v_fmac_f32 v58, v70, v70
    v_fmac_f32 v59, v71, v71
    s_waitcnt lgkmcnt(1)
    v_lshlrev_b32 v68, 16, v32
    v_and_b32 v69, 0xffff0000, v32
    v_add_f32 v56, v56, v68
    v_add_f32 v57, v57, v69
    v_fmac_f32 v58, v68, v68
    v_fmac_f32 v59, v69, v69
    v_lshlrev_b32 v70, 16, v33
    v_and_b32 v71, 0xffff0000, v33
    v_add_f32 v56, v56, v70
    v_add_f32 v57, v57, v71
    v_fmac_f32 v58, v70, v70
    v_fmac_f32 v59, v71, v71
    v_lshlrev_b32 v68, 16, v34
    v_and_b32 v69, 0xffff0000, v34
    v_add_f32 v56, v56, v68
    v_add_f32 v57, v57, v69
    v_fmac_f32 v58, v68, v68
    v_fmac_f32 v59, v69, v69
    v_lshlrev_b32 v70, 16, v35
    v_and_b32 v71, 0xffff0000, v35
    v_add_f32 v56, v56, v70
    v_add_f32 v57, v57, v71
    v_fmac_f32 v58, v70, v70
    v_fmac_f32 v59, v71, v71
    s_waitcnt lgkmcnt(0)
    v_lshlrev_b32 v68, 16, v36
    v_and_b32 v69, 0xffff0000, v36
    v_add_f32 v56, v56, v68
    v_add_f32 v57, v57, v69
    v_fmac_f32 v58, v68, v68
    v_fmac_f32 v59, v69, v69
    v_lshlrev_b32 v70, 16, v37
    v_and_b32 v71, 0xffff0000, v37
    v_add_f32 v56, v56, v70
    v_add_f32 v57, v57, v71
    v_fmac_f32 v58, v70, v70
    v_fmac_f32 v59, v71, v71
    v_lshlrev_b32 v68, 16, v38
    v_and_b32 v69, 0xffff0000, v38
    v_add_f32 v56, v56, v68
    v_add_f32 v57, v57, v69
    v_fmac_f32 v58, v68, v68
    v_fmac_f32 v59, v69, v69
    v_lshlrev_b32 v70, 16, v39
    v_and_b32 v71, 0xffff0000, v39
    v_add_f32 v56, v56, v70
    v_add_f32 v57, v57, v71
    v_fmac_f32 v58, v70, v70
    v_fmac_f32 v59, v71, v71
    s_barrier
    ds_read_b128 v[24:27], v72 offset:0
    ds_read_b128 v[28:31], v73 offset:0
    ds_read_b128 v[32:35], v74 offset:0
    ds_read_b128 v[36:39], v75 offset:0
    s_waitcnt lgkmcnt(3)
    v_lshlrev_b32 v68, 16, v24
    v_and_b32 v69, 0xffff0000, v24
    v_add_f32 v56, v56, v68
    v_add_f32 v57, v57, v69
    v_fmac_f32 v58, v68, v68
    v_fmac_f32 v59, v69, v69
    v_lshlrev_b32 v70, 16, v25
    v_and_b32 v71, 0xffff0000, v25
    v_add_f32 v56, v56, v70
    v_add_f32 v57, v57, v71
    v_fmac_f32 v58, v70, v70
    v_fmac_f32 v59, v71, v71
    v_lshlrev_b32 v68, 16, v26
    v_and_b32 v69, 0xffff0000, v26
    v_add_f32 v56, v56, v68
    v_add_f32 v57, v57, v69
    v_fmac_f32 v58, v68, v68
    v_fmac_f32 v59, v69, v69
    v_lshlrev_b32 v70, 16, v27
    v_and_b32 v71, 0xffff0000, v27
    v_add_f32 v56, v56, v70
    v_add_f32 v57, v57, v71
    v_fmac_f32 v58, v70, v70
    v_fmac_f32 v59, v71, v71
    s_waitcnt lgkmcnt(2)
    v_lshlrev_b32 v68, 16, v28
    v_and_b32 v69, 0xffff0000, v28
    v_add_f32 v56, v56, v68
    v_add_f32 v57, v57, v69
    v_fmac_f32 v58, v68, v68
    v_fmac_f32 v59, v69, v69
    v_lshlrev_b32 v70, 16, v29
    v_and_b32 v71, 0xffff0000, v29
    v_add_f32 v56, v56, v70
    v_add_f32 v57, v57, v71
    v_fmac_f32 v58, v70, v70
    v_fmac_f32 v59, v71, v71
    v_lshlrev_b32 v68, 16, v30
    v_and_b32 v69, 0xffff0000, v30
    v_add_f32 v56, v56, v68
    v_add_f32 v57, v57, v69
    v_fmac_f32 v58, v68, v68
    v_fmac_f32 v59, v69, v69
    v_lshlrev_b32 v70, 16, v31
    v_and_b32 v71, 0xffff0000, v31
    v_add_f32 v56, v56, v70
    v_add_f32 v57, v57, v71
    v_fmac_f32 v58, v70, v70
    v_fmac_f32 v59, v71, v71
    s_waitcnt lgkmcnt(1)
    v_lshlrev_b32 v68, 16, v32
    v_and_b32 v69, 0xffff0000, v32
    v_add_f32 v56, v56, v68
    v_add_f32 v57, v57, v69
    v_fmac_f32 v58, v68, v68
    v_fmac_f32 v59, v69, v69
    v_lshlrev_b32 v70, 16, v33
    v_and_b32 v71, 0xffff0000, v33
    v_add_f32 v56, v56, v70
    v_add_f32 v57, v57, v71
    v_fmac_f32 v58, v70, v70
    v_fmac_f32 v59, v71, v71
    v_lshlrev_b32 v68, 16, v34
    v_and_b32 v69, 0xffff0000, v34
    v_add_f32 v56, v56, v68
    v_add_f32 v57, v57, v69
    v_fmac_f32 v58, v68, v68
    v_fmac_f32 v59, v69, v69
    v_lshlrev_b32 v70, 16, v35
    v_and_b32 v71, 0xffff0000, v35
    v_add_f32 v56, v56, v70
    v_add_f32 v57, v57, v71
    v_fmac_f32 v58, v70, v70
    v_fmac_f32 v59, v71, v71
    s_waitcnt lgkmcnt(0)
    v_lshlrev_b32 v68, 16, v36
    v_and_b32 v69, 0xffff0000, v36
    v_add_f32 v56, v56, v68
    v_add_f32 v57, v57, v69
    v_fmac_f32 v58, v68, v68
    v_fmac_f32 v59, v69, v69
    v_lshlrev_b32 v70, 16, v37
    v_and_b32 v71, 0xffff0000, v37
    v_add_f32 v56, v56, v70
    v_add_f32 v57, v57, v71
    v_fmac_f32 v58, v70, v70
    v_fmac_f32 v59, v71, v71
    v_lshlrev_b32 v68, 16, v38
    v_and_b32 v69, 0xffff0000, v38
    v_add_f32 v56, v56, v68
    v_add_f32 v57, v57, v69
    v_fmac_f32 v58, v68, v68
    v_fmac_f32 v59, v69, v69
    v_lshlrev_b32 v70, 16, v39
    v_and_b32 v71, 0xffff0000, v39
    v_add_f32 v56, v56, v70
    v_add_f32 v57, v57, v71
    v_fmac_f32 v58, v70, v70
    v_fmac_f32 v59, v71, v71
    s_barrier
    ds_read_b128 v[24:27], v72 offset:32768
    ds_read_b128 v[28:31], v73 offset:32768
    ds_read_b128 v[32:35], v74 offset:32768
    ds_read_b128 v[36:39], v75 offset:32768
    s_waitcnt lgkmcnt(3)
    v_lshlrev_b32 v68, 16, v24
    v_and_b32 v69, 0xffff0000, v24
    v_add_f32 v56, v56, v68
    v_add_f32 v57, v57, v69
    v_fmac_f32 v58, v68, v68
    v_fmac_f32 v59, v69, v69
    v_lshlrev_b32 v70, 16, v25
    v_and_b32 v71, 0xffff0000, v25
    v_add_f32 v56, v56, v70
    v_add_f32 v57, v57, v71
    v_fmac_f32 v58, v70, v70
    v_fmac_f32 v59, v71, v71
    v_lshlrev_b32 v68, 16, v26
    v_and_b32 v69, 0xffff0000, v26
    v_add_f32 v56, v56, v68
    v_add_f32 v57, v57, v69
    v_fmac_f32 v58, v68, v68
    v_fmac_f32 v59, v69, v69
    v_lshlrev_b32 v70, 16, v27
    v_and_b32 v71, 0xffff0000, v27
    v_add_f32 v56, v56, v70
    v_add_f32 v57, v57, v71
    v_fmac_f32 v58, v70, v70
    v_fmac_f32 v59, v71, v71
    s_waitcnt lgkmcnt(2)
    v_lshlrev_b32 v68, 16, v28
    v_and_b32 v69, 0xffff0000, v28
    v_add_f32 v56, v56, v68
    v_add_f32 v57, v57, v69
    v_fmac_f32 v58, v68, v68
    v_fmac_f32 v59, v69, v69
    v_lshlrev_b32 v70, 16, v29
    v_and_b32 v71, 0xffff0000, v29
    v_add_f32 v56, v56, v70
    v_add_f32 v57, v57, v71
    v_fmac_f32 v58, v70, v70
    v_fmac_f32 v59, v71, v71
    v_lshlrev_b32 v68, 16, v30
    v_and_b32 v69, 0xffff0000, v30
    v_add_f32 v56, v56, v68
    v_add_f32 v57, v57, v69
    v_fmac_f32 v58, v68, v68
    v_fmac_f32 v59, v69, v69
    v_lshlrev_b32 v70, 16, v31
    v_and_b32 v71, 0xffff0000, v31
    v_add_f32 v56, v56, v70
    v_add_f32 v57, v57, v71
    v_fmac_f32 v58, v70, v70
    v_fmac_f32 v59, v71, v71
    s_waitcnt lgkmcnt(1)
    v_lshlrev_b32 v68, 16, v32
    v_and_b32 v69, 0xffff0000, v32
    v_add_f32 v56, v56, v68
    v_add_f32 v57, v57, v69
    v_fmac_f32 v58, v68, v68
    v_fmac_f32 v59, v69, v69
    v_lshlrev_b32 v70, 16, v33
    v_and_b32 v71, 0xffff0000, v33
    v_add_f32 v56, v56, v70
    v_add_f32 v57, v57, v71
    v_fmac_f32 v58, v70, v70
    v_fmac_f32 v59, v71, v71
    v_lshlrev_b32 v68, 16, v34
    v_and_b32 v69, 0xffff0000, v34
    v_add_f32 v56, v56, v68
    v_add_f32 v57, v57, v69
    v_fmac_f32 v58, v68, v68
    v_fmac_f32 v59, v69, v69
    v_lshlrev_b32 v70, 16, v35
    v_and_b32 v71, 0xffff0000, v35
    v_add_f32 v56, v56, v70
    v_add_f32 v57, v57, v71
    v_fmac_f32 v58, v70, v70
    v_fmac_f32 v59, v71, v71
    s_waitcnt lgkmcnt(0)
    v_lshlrev_b32 v68, 16, v36
    v_and_b32 v69, 0xffff0000, v36
    v_add_f32 v56, v56, v68
    v_add_f32 v57, v57, v69
    v_fmac_f32 v58, v68, v68
    v_fmac_f32 v59, v69, v69
    v_lshlrev_b32 v70, 16, v37
    v_and_b32 v71, 0xffff0000, v37
    v_add_f32 v56, v56, v70
    v_add_f32 v57, v57, v71
    v_fmac_f32 v58, v70, v70
    v_fmac_f32 v59, v71, v71
    v_lshlrev_b32 v68, 16, v38
    v_and_b32 v69, 0xffff0000, v38
    v_add_f32 v56, v56, v68
    v_add_f32 v57, v57, v69
    v_fmac_f32 v58, v68, v68
    v_fmac_f32 v59, v69, v69
    v_lshlrev_b32 v70, 16, v39
    v_and_b32 v71, 0xffff0000, v39
    v_add_f32 v56, v56, v70
    v_add_f32 v57, v57, v71
    v_fmac_f32 v58, v70, v70
    v_fmac_f32 v59, v71, v71
    v_add_f32 v56, v56, v57
    v_add_f32 v57, v58, v59
    v_mov_b32 v68, v56
    s_nop 1
    v_permlane32_swap_b32 v56, v68
    s_nop 1
    v_add_f32 v56, v56, v68
    v_mov_b32 v68, v57
    s_nop 1
    v_permlane32_swap_b32 v57, v68
    s_nop 1
    v_add_f32 v57, v57, v68
    s_lshl_b32 s10, s9, 8
    s_add_u32 s10, s10, 133120
    v_lshl_add_u32 v5, v3, 3, s10
    ds_write_b64 v5, v[56:57]
    s_waitcnt lgkmcnt(0)
    s_barrier

L_g1a_exit:
    s_endpgm
L_g1a_compute:
    s_lshr_b32 s8, s7, 1
    s_and_b32 s9, s7, 1
    v_and_b32 v3, 31, v2
    v_lshrrev_b32 v4, 5, v2
    s_lshl_b32 s13, s5, 7
    s_lshl_b32 s14, s8, 6
    s_add_u32 s12, s13, s14
    v_lshrrev_b32 v5, 1, v3
    v_and_b32 v5, 7, v5
    v_add_u32 v6, s14, v3
    v_lshlrev_b32 v6, 7, v6

    v_add_u32 v7, 0, v4
    v_xor_b32 v7, v7, v5
    v_lshl_add_u32 v8, v7, 4, v6
    v_add_u32 v12, 65536, v8
    v_add_u32 v7, 2, v4
    v_xor_b32 v7, v7, v5
    v_lshl_add_u32 v9, v7, 4, v6
    v_add_u32 v13, 65536, v9
    v_add_u32 v7, 4, v4
    v_xor_b32 v7, v7, v5
    v_lshl_add_u32 v10, v7, 4, v6
    v_add_u32 v14, 65536, v10
    v_add_u32 v7, 6, v4
    v_xor_b32 v7, v7, v5
    v_lshl_add_u32 v11, v7, 4, v6
    v_add_u32 v15, 65536, v11
    v_lshrrev_b32 v5, 4, v2
    v_and_b32 v5, 1, v5
    v_and_b32 v6, 3, v2
    v_lshl_add_u32 v5, v5, 2, v6
    v_lshlrev_b32 v5, 2, v5
    v_bfe_u32 v6, v2, 2, 2
    v_lshl_add_u32 v7, v4, 3, v6
    v_lshlrev_b32 v7, 8, v7
    v_add_u32 v7, 16384, v7
    s_mul_i32 s10, s9, 120
    v_lshl_add_u32 v6, v6, 6, s10

    s_mov_b32 s11, 0x76453120
    v_bfe_u32 v28, s11, v5, 4
    v_lshl_add_u32 v28, v28, 3, v6
    v_and_b32 v28, 255, v28
    v_add_u32 v28, v28, v7
    v_add_u32 v30, 65536, v28

    s_mov_b32 s11, 0x8e79dbca
    v_bfe_u32 v29, s11, v5, 4
    v_lshl_add_u32 v29, v29, 3, v6
    v_and_b32 v29, 255, v29
    v_add_u32 v29, v29, v7
    v_add_u32 v31, 65536, v29

    v_add_u32 v17, s14, v3
    v_lshlrev_b32 v17, 3, v17
    v_add_u32 v17, 133120, v17
    s_lshl_b32 s10, s9, 8
    s_add_u32 s10, s10, 131072
    v_lshl_add_u32 v16, v3, 2, s10
    s_lshl_b32 s11, s8, 7
    s_add_u32 s10, s10, s11
    v_lshl_add_u32 v5, v4, 4, s10
    v_mov_b32 v160, 0x3f803f80
    v_mov_b32 v161, 0x3f803f80
    v_mov_b32 v162, 0x3f803f80
    v_mov_b32 v163, 0x3f803f80

    s_add_u32 s48, s34, 6291456
    s_addc_u32 s49, s35, 0
    s_mov_b32 s50, 9437184
    s_mov_b32 s51, 0x00020000
    s_lshr_b32 s68, s12, 5
    s_mul_i32 s68, s68, 1536
    s_mul_i32 s10, s6, 6
    s_mul_i32 s11, s9, 3
    s_add_u32 s10, s10, s11
    s_mov_b32 s15, 0x3ea52b5c

    s_add_u32 s11, s10, 0
    s_mul_i32 s61, s11, 98304
    s_add_u32 s61, s61, s68
    s_cmp_lt_u32 s11, 32
    s_cselect_b32 s12, s15, 1.0
    s_cmp_lt_u32 s11, 64
    s_movk_i32 s88, 0x3f80
    s_cselect_b32 s88, 0x3f803f80, s88
    s_cselect_b32 s89, 0x3f80, 0

    s_add_u32 s11, s10, 1
    s_mul_i32 s62, s11, 98304
    s_add_u32 s62, s62, s68
    s_cmp_lt_u32 s11, 32
    s_cselect_b32 s13, s15, 1.0
    s_cmp_lt_u32 s11, 64
    s_movk_i32 s90, 0x3f80
    s_cselect_b32 s90, 0x3f803f80, s90
    s_cselect_b32 s91, 0x3f80, 0

    s_add_u32 s11, s10, 2
    s_mul_i32 s63, s11, 98304
    s_add_u32 s63, s63, s68
    s_cmp_lt_u32 s11, 32
    s_cselect_b32 s14, s15, 1.0
    s_cmp_lt_u32 s11, 64
    s_movk_i32 s92, 0x3f80
    s_cselect_b32 s92, 0x3f803f80, s92
    s_cselect_b32 s93, 0x3f80, 0

    s_mov_b32 s64, -1
    s_mov_b32 s65, 0
    s_mov_b32 s66, 0
    s_mov_b32 s67, -1
    v_lshlrev_b32 v26, 4, v3
    v_xor_b32 v27, 128, v26
    v_add_u32 v27, 1024, v27
    v_mov_b32 v21, s13
    v_mov_b32 v22, s14
    v_mov_b32 v23, v26
    v_add_u32 v24, 98304, v26
    v_mov_b32 v25, v27
    s_mov_b64 exec, s[66:67]
    v_mov_b32 v21, s12
    v_mov_b32 v22, s13
    v_xor_b32 v23, 64, v26
    v_add_u32 v23, 512, v23
    v_mov_b32 v24, v27
    v_mov_b32 v25, v23
    s_mov_b64 exec, -1

    s_add_u32 s52, s34, 33554432
    s_addc_u32 s53, s35, 0
    s_mov_b32 s54, 2686976
    s_mov_b32 s55, 0x00020000
    s_mul_i32 s69, s6, 167936
    s_lshl_b32 s10, s9, 11
    s_add_u32 s70, s69, s10
    s_lshl_b32 s10, s8, 10
    s_add_u32 s69, s70, s10
    v_lshlrev_b32 v6, 4, v2

    s_barrier
    ds_read_b128 v[32:35], v8 offset:0
    ds_read_b128 v[36:39], v8 offset:4096
    ds_read_b64_tr_b16 v[56:57], v28 offset:0
    ds_read_b64_tr_b16 v[58:59], v28 offset:1024
    ds_read_b64_tr_b16 v[60:61], v29 offset:0
    ds_read_b64_tr_b16 v[62:63], v29 offset:1024
    ds_read_b128 v[40:43], v9 offset:0
    ds_read_b128 v[44:47], v9 offset:4096
    ds_read_b64_tr_b16 v[64:65], v28 offset:4096
    ds_read_b64_tr_b16 v[66:67], v28 offset:5120
    ds_read_b64_tr_b16 v[68:69], v29 offset:4096
    ds_read_b64_tr_b16 v[70:71], v29 offset:5120
    s_waitcnt lgkmcnt(6)
    v_mfma_f32_32x32x16_bf16 v[80:95], v[56:59], v[32:35], 0
    ds_read_b128 v[48:51], v10 offset:0
    ds_read_b128 v[52:55], v10 offset:4096
    ds_read_b64_tr_b16 v[72:73], v28 offset:8192
    ds_read_b64_tr_b16 v[74:75], v28 offset:9216
    ds_read_b64_tr_b16 v[76:77], v29 offset:8192
    ds_read_b64_tr_b16 v[78:79], v29 offset:9216
    v_mfma_f32_32x32x16_bf16 v[96:111], v[56:59], v[36:39], 0
    v_mfma_f32_32x32x16_bf16 v[112:127], v[60:63], v[32:35], 0
    v_mfma_f32_32x32x16_bf16 v[128:143], v[60:63], v[36:39], 0
    s_cmp_eq_u32 s8, 1
    s_cbranch_scc1 L_cs_9
    v_mfma_f32_32x32x16_bf16 v[144:159], v[56:59], v[160:163], 0
    s_cmp_lg_u32 s5, 0
    s_cbranch_scc1 L_cs_10
    s_add_u32 s10, s69, 0
    buffer_store_dwordx4 v[56:59], v6, s[52:55], s10 offen sc1
    s_branch L_cs_10
L_cs_9:
    v_mfma_f32_32x32x16_bf16 v[144:159], v[60:63], v[160:163], 0
    s_cmp_lg_u32 s5, 0
    s_cbranch_scc1 L_cs_10
    s_add_u32 s10, s69, 0
    buffer_store_dwordx4 v[60:63], v6, s[52:55], s10 offen sc1
L_cs_10:
    s_waitcnt lgkmcnt(6)
    v_mfma_f32_32x32x16_bf16 v[80:95], v[64:67], v[40:43], v[80:95]
    ds_read_b128 v[32:35], v11 offset:0
    ds_read_b128 v[36:39], v11 offset:4096
    ds_read_b64_tr_b16 v[56:57], v28 offset:12288
    ds_read_b64_tr_b16 v[58:59], v28 offset:13312
    ds_read_b64_tr_b16 v[60:61], v29 offset:12288
    ds_read_b64_tr_b16 v[62:63], v29 offset:13312
    v_mfma_f32_32x32x16_bf16 v[96:111], v[64:67], v[44:47], v[96:111]
    v_mfma_f32_32x32x16_bf16 v[112:127], v[68:71], v[40:43], v[112:127]
    v_mfma_f32_32x32x16_bf16 v[128:143], v[68:71], v[44:47], v[128:143]
    s_cmp_eq_u32 s8, 1
    s_cbranch_scc1 L_cs_11
    v_mfma_f32_32x32x16_bf16 v[144:159], v[64:67], v[160:163], v[144:159]
    s_cmp_lg_u32 s5, 1
    s_cbranch_scc1 L_cs_12
    s_add_u32 s10, s69, 4096
    buffer_store_dwordx4 v[64:67], v6, s[52:55], s10 offen sc1
    s_branch L_cs_12
L_cs_11:
    v_mfma_f32_32x32x16_bf16 v[144:159], v[68:71], v[160:163], v[144:159]
    s_cmp_lg_u32 s5, 1
    s_cbranch_scc1 L_cs_12
    s_add_u32 s10, s69, 4096
    buffer_store_dwordx4 v[68:71], v6, s[52:55], s10 offen sc1
L_cs_12:
    s_waitcnt lgkmcnt(6)
    s_barrier
    v_mfma_f32_32x32x16_bf16 v[80:95], v[72:75], v[48:51], v[80:95]
    ds_read_b128 v[40:43], v8 offset:32768
    ds_read_b128 v[44:47], v8 offset:36864
    ds_read_b64_tr_b16 v[64:65], v28 offset:32768
    ds_read_b64_tr_b16 v[66:67], v28 offset:33792
    ds_read_b64_tr_b16 v[68:69], v29 offset:32768
    ds_read_b64_tr_b16 v[70:71], v29 offset:33792
    v_mfma_f32_32x32x16_bf16 v[96:111], v[72:75], v[52:55], v[96:111]
    v_mfma_f32_32x32x16_bf16 v[112:127], v[76:79], v[48:51], v[112:127]
    v_mfma_f32_32x32x16_bf16 v[128:143], v[76:79], v[52:55], v[128:143]
    s_cmp_eq_u32 s8, 1
    s_cbranch_scc1 L_cs_13
    v_mfma_f32_32x32x16_bf16 v[144:159], v[72:75], v[160:163], v[144:159]
    s_cmp_lg_u32 s5, 2
    s_cbranch_scc1 L_cs_14
    s_add_u32 s10, s69, 8192
    buffer_store_dwordx4 v[72:75], v6, s[52:55], s10 offen sc1
    s_branch L_cs_14
L_cs_13:
    v_mfma_f32_32x32x16_bf16 v[144:159], v[76:79], v[160:163], v[144:159]
    s_cmp_lg_u32 s5, 2
    s_cbranch_scc1 L_cs_14
    s_add_u32 s10, s69, 8192
    buffer_store_dwordx4 v[76:79], v6, s[52:55], s10 offen sc1
L_cs_14:
    s_waitcnt lgkmcnt(6)
    v_mfma_f32_32x32x16_bf16 v[80:95], v[56:59], v[32:35], v[80:95]
    ds_read_b128 v[48:51], v9 offset:32768
    ds_read_b128 v[52:55], v9 offset:36864
    ds_read_b64_tr_b16 v[72:73], v28 offset:36864
    ds_read_b64_tr_b16 v[74:75], v28 offset:37888
    ds_read_b64_tr_b16 v[76:77], v29 offset:36864
    ds_read_b64_tr_b16 v[78:79], v29 offset:37888
    v_mfma_f32_32x32x16_bf16 v[96:111], v[56:59], v[36:39], v[96:111]
    v_mfma_f32_32x32x16_bf16 v[112:127], v[60:63], v[32:35], v[112:127]
    v_mfma_f32_32x32x16_bf16 v[128:143], v[60:63], v[36:39], v[128:143]
    s_cmp_eq_u32 s8, 1
    s_cbranch_scc1 L_cs_15
    v_mfma_f32_32x32x16_bf16 v[144:159], v[56:59], v[160:163], v[144:159]
    s_cmp_lg_u32 s5, 3
    s_cbranch_scc1 L_cs_16
    s_add_u32 s10, s69, 12288
    buffer_store_dwordx4 v[56:59], v6, s[52:55], s10 offen sc1
    s_branch L_cs_16
L_cs_15:
    v_mfma_f32_32x32x16_bf16 v[144:159], v[60:63], v[160:163], v[144:159]
    s_cmp_lg_u32 s5, 3
    s_cbranch_scc1 L_cs_16
    s_add_u32 s10, s69, 12288
    buffer_store_dwordx4 v[60:63], v6, s[52:55], s10 offen sc1
L_cs_16:
    s_waitcnt lgkmcnt(6)
    v_mfma_f32_32x32x16_bf16 v[80:95], v[64:67], v[40:43], v[80:95]
    ds_read_b128 v[32:35], v10 offset:32768
    ds_read_b128 v[36:39], v10 offset:36864
    ds_read_b64_tr_b16 v[56:57], v28 offset:40960
    ds_read_b64_tr_b16 v[58:59], v28 offset:41984
    ds_read_b64_tr_b16 v[60:61], v29 offset:40960
    ds_read_b64_tr_b16 v[62:63], v29 offset:41984
    v_mfma_f32_32x32x16_bf16 v[96:111], v[64:67], v[44:47], v[96:111]
    v_mfma_f32_32x32x16_bf16 v[112:127], v[68:71], v[40:43], v[112:127]
    v_mfma_f32_32x32x16_bf16 v[128:143], v[68:71], v[44:47], v[128:143]
    s_cmp_eq_u32 s8, 1
    s_cbranch_scc1 L_cs_17
    v_mfma_f32_32x32x16_bf16 v[144:159], v[64:67], v[160:163], v[144:159]
    s_cmp_lg_u32 s5, 4
    s_cbranch_scc1 L_cs_18
    s_add_u32 s10, s69, 16384
    buffer_store_dwordx4 v[64:67], v6, s[52:55], s10 offen sc1
    s_branch L_cs_18
L_cs_17:
    v_mfma_f32_32x32x16_bf16 v[144:159], v[68:71], v[160:163], v[144:159]
    s_cmp_lg_u32 s5, 4
    s_cbranch_scc1 L_cs_18
    s_add_u32 s10, s69, 16384
    buffer_store_dwordx4 v[68:71], v6, s[52:55], s10 offen sc1
L_cs_18:
    s_waitcnt lgkmcnt(6)
    v_mfma_f32_32x32x16_bf16 v[80:95], v[72:75], v[48:51], v[80:95]
    ds_read_b128 v[40:43], v11 offset:32768
    ds_read_b128 v[44:47], v11 offset:36864
    ds_read_b64_tr_b16 v[64:65], v28 offset:45056
    ds_read_b64_tr_b16 v[66:67], v28 offset:46080
    ds_read_b64_tr_b16 v[68:69], v29 offset:45056
    ds_read_b64_tr_b16 v[70:71], v29 offset:46080
    v_mfma_f32_32x32x16_bf16 v[96:111], v[72:75], v[52:55], v[96:111]
    v_mfma_f32_32x32x16_bf16 v[112:127], v[76:79], v[48:51], v[112:127]
    v_mfma_f32_32x32x16_bf16 v[128:143], v[76:79], v[52:55], v[128:143]
    s_cmp_eq_u32 s8, 1
    s_cbranch_scc1 L_cs_19
    v_mfma_f32_32x32x16_bf16 v[144:159], v[72:75], v[160:163], v[144:159]
    s_cmp_lg_u32 s5, 5
    s_cbranch_scc1 L_cs_20
    s_add_u32 s10, s69, 20480
    buffer_store_dwordx4 v[72:75], v6, s[52:55], s10 offen sc1
    s_branch L_cs_20
L_cs_19:
    v_mfma_f32_32x32x16_bf16 v[144:159], v[76:79], v[160:163], v[144:159]
    s_cmp_lg_u32 s5, 5
    s_cbranch_scc1 L_cs_20
    s_add_u32 s10, s69, 20480
    buffer_store_dwordx4 v[76:79], v6, s[52:55], s10 offen sc1
L_cs_20:
    s_waitcnt lgkmcnt(6)
    s_barrier
    v_mfma_f32_32x32x16_bf16 v[80:95], v[56:59], v[32:35], v[80:95]
    ds_read_b128 v[48:51], v12 offset:0
    ds_read_b128 v[52:55], v12 offset:4096
    ds_read_b64_tr_b16 v[72:73], v30 offset:0
    ds_read_b64_tr_b16 v[74:75], v30 offset:1024
    ds_read_b64_tr_b16 v[76:77], v31 offset:0
    ds_read_b64_tr_b16 v[78:79], v31 offset:1024
    v_mfma_f32_32x32x16_bf16 v[96:111], v[56:59], v[36:39], v[96:111]
    v_mfma_f32_32x32x16_bf16 v[112:127], v[60:63], v[32:35], v[112:127]
    v_mfma_f32_32x32x16_bf16 v[128:143], v[60:63], v[36:39], v[128:143]
    s_cmp_eq_u32 s8, 1
    s_cbranch_scc1 L_cs_21
    v_mfma_f32_32x32x16_bf16 v[144:159], v[56:59], v[160:163], v[144:159]
    s_cmp_lg_u32 s5, 6
    s_cbranch_scc1 L_cs_22
    s_add_u32 s10, s69, 24576
    buffer_store_dwordx4 v[56:59], v6, s[52:55], s10 offen sc1
    s_branch L_cs_22
L_cs_21:
    v_mfma_f32_32x32x16_bf16 v[144:159], v[60:63], v[160:163], v[144:159]
    s_cmp_lg_u32 s5, 6
    s_cbranch_scc1 L_cs_22
    s_add_u32 s10, s69, 24576
    buffer_store_dwordx4 v[60:63], v6, s[52:55], s10 offen sc1
L_cs_22:
    s_waitcnt lgkmcnt(6)
    v_mfma_f32_32x32x16_bf16 v[80:95], v[64:67], v[40:43], v[80:95]
    ds_read_b128 v[32:35], v13 offset:0
    ds_read_b128 v[36:39], v13 offset:4096
    ds_read_b64_tr_b16 v[56:57], v30 offset:4096
    ds_read_b64_tr_b16 v[58:59], v30 offset:5120
    ds_read_b64_tr_b16 v[60:61], v31 offset:4096
    ds_read_b64_tr_b16 v[62:63], v31 offset:5120
    v_mfma_f32_32x32x16_bf16 v[96:111], v[64:67], v[44:47], v[96:111]
    v_mfma_f32_32x32x16_bf16 v[112:127], v[68:71], v[40:43], v[112:127]
    v_mfma_f32_32x32x16_bf16 v[128:143], v[68:71], v[44:47], v[128:143]
    s_cmp_eq_u32 s8, 1
    s_cbranch_scc1 L_cs_23
    v_mfma_f32_32x32x16_bf16 v[144:159], v[64:67], v[160:163], v[144:159]
    s_cmp_lg_u32 s5, 7
    s_cbranch_scc1 L_cs_24
    s_add_u32 s10, s69, 28672
    buffer_store_dwordx4 v[64:67], v6, s[52:55], s10 offen sc1
    s_branch L_cs_24
L_cs_23:
    v_mfma_f32_32x32x16_bf16 v[144:159], v[68:71], v[160:163], v[144:159]
    s_cmp_lg_u32 s5, 7
    s_cbranch_scc1 L_cs_24
    s_add_u32 s10, s69, 28672
    buffer_store_dwordx4 v[68:71], v6, s[52:55], s10 offen sc1
L_cs_24:
    s_waitcnt lgkmcnt(6)
    v_mfma_f32_32x32x16_bf16 v[80:95], v[72:75], v[48:51], v[80:95]
    ds_read_b128 v[40:43], v14 offset:0
    ds_read_b128 v[44:47], v14 offset:4096
    ds_read_b64_tr_b16 v[64:65], v30 offset:8192
    ds_read_b64_tr_b16 v[66:67], v30 offset:9216
    ds_read_b64_tr_b16 v[68:69], v31 offset:8192
    ds_read_b64_tr_b16 v[70:71], v31 offset:9216
    v_mfma_f32_32x32x16_bf16 v[96:111], v[72:75], v[52:55], v[96:111]
    v_mfma_f32_32x32x16_bf16 v[112:127], v[76:79], v[48:51], v[112:127]
    v_mfma_f32_32x32x16_bf16 v[128:143], v[76:79], v[52:55], v[128:143]
    s_cmp_eq_u32 s8, 1
    s_cbranch_scc1 L_cs_25
    v_mfma_f32_32x32x16_bf16 v[144:159], v[72:75], v[160:163], v[144:159]
    s_cmp_lg_u32 s5, 8
    s_cbranch_scc1 L_cs_26
    s_add_u32 s10, s69, 32768
    buffer_store_dwordx4 v[72:75], v6, s[52:55], s10 offen sc1
    s_branch L_cs_26
L_cs_25:
    v_mfma_f32_32x32x16_bf16 v[144:159], v[76:79], v[160:163], v[144:159]
    s_cmp_lg_u32 s5, 8
    s_cbranch_scc1 L_cs_26
    s_add_u32 s10, s69, 32768
    buffer_store_dwordx4 v[76:79], v6, s[52:55], s10 offen sc1
L_cs_26:
    s_waitcnt lgkmcnt(6)
    v_mfma_f32_32x32x16_bf16 v[80:95], v[56:59], v[32:35], v[80:95]
    ds_read_b128 v[48:51], v15 offset:0
    ds_read_b128 v[52:55], v15 offset:4096
    ds_read_b64_tr_b16 v[72:73], v30 offset:12288
    ds_read_b64_tr_b16 v[74:75], v30 offset:13312
    ds_read_b64_tr_b16 v[76:77], v31 offset:12288
    ds_read_b64_tr_b16 v[78:79], v31 offset:13312
    v_mfma_f32_32x32x16_bf16 v[96:111], v[56:59], v[36:39], v[96:111]
    v_mfma_f32_32x32x16_bf16 v[112:127], v[60:63], v[32:35], v[112:127]
    v_mfma_f32_32x32x16_bf16 v[128:143], v[60:63], v[36:39], v[128:143]
    s_cmp_eq_u32 s8, 1
    s_cbranch_scc1 L_cs_27
    v_mfma_f32_32x32x16_bf16 v[144:159], v[56:59], v[160:163], v[144:159]
    s_cmp_lg_u32 s5, 9
    s_cbranch_scc1 L_cs_28
    s_add_u32 s10, s69, 36864
    buffer_store_dwordx4 v[56:59], v6, s[52:55], s10 offen sc1
    s_branch L_cs_28
L_cs_27:
    v_mfma_f32_32x32x16_bf16 v[144:159], v[60:63], v[160:163], v[144:159]
    s_cmp_lg_u32 s5, 9
    s_cbranch_scc1 L_cs_28
    s_add_u32 s10, s69, 36864
    buffer_store_dwordx4 v[60:63], v6, s[52:55], s10 offen sc1
L_cs_28:
    s_waitcnt lgkmcnt(6)
    s_barrier
    v_mfma_f32_32x32x16_bf16 v[80:95], v[64:67], v[40:43], v[80:95]
    ds_read_b128 v[32:35], v12 offset:32768
    ds_read_b128 v[36:39], v12 offset:36864
    ds_read_b64_tr_b16 v[56:57], v30 offset:32768
    ds_read_b64_tr_b16 v[58:59], v30 offset:33792
    ds_read_b64_tr_b16 v[60:61], v31 offset:32768
    ds_read_b64_tr_b16 v[62:63], v31 offset:33792
    v_mfma_f32_32x32x16_bf16 v[96:111], v[64:67], v[44:47], v[96:111]
    v_mfma_f32_32x32x16_bf16 v[112:127], v[68:71], v[40:43], v[112:127]
    v_mfma_f32_32x32x16_bf16 v[128:143], v[68:71], v[44:47], v[128:143]
    s_cmp_eq_u32 s8, 1
    s_cbranch_scc1 L_cs_29
    v_mfma_f32_32x32x16_bf16 v[144:159], v[64:67], v[160:163], v[144:159]
    s_cmp_lg_u32 s5, 10
    s_cbranch_scc1 L_cs_30
    s_add_u32 s10, s69, 40960
    buffer_store_dwordx4 v[64:67], v6, s[52:55], s10 offen sc1
    s_branch L_cs_30
L_cs_29:
    v_mfma_f32_32x32x16_bf16 v[144:159], v[68:71], v[160:163], v[144:159]
    s_cmp_lg_u32 s5, 10
    s_cbranch_scc1 L_cs_30
    s_add_u32 s10, s69, 40960
    buffer_store_dwordx4 v[68:71], v6, s[52:55], s10 offen sc1
L_cs_30:
    s_waitcnt lgkmcnt(6)
    v_mfma_f32_32x32x16_bf16 v[80:95], v[72:75], v[48:51], v[80:95]
    ds_read_b128 v[40:43], v13 offset:32768
    ds_read_b128 v[44:47], v13 offset:36864
    ds_read_b64_tr_b16 v[64:65], v30 offset:36864
    ds_read_b64_tr_b16 v[66:67], v30 offset:37888
    ds_read_b64_tr_b16 v[68:69], v31 offset:36864
    ds_read_b64_tr_b16 v[70:71], v31 offset:37888
    v_mfma_f32_32x32x16_bf16 v[96:111], v[72:75], v[52:55], v[96:111]
    v_mfma_f32_32x32x16_bf16 v[112:127], v[76:79], v[48:51], v[112:127]
    v_mfma_f32_32x32x16_bf16 v[128:143], v[76:79], v[52:55], v[128:143]
    s_cmp_eq_u32 s8, 1
    s_cbranch_scc1 L_cs_31
    v_mfma_f32_32x32x16_bf16 v[144:159], v[72:75], v[160:163], v[144:159]
    s_cmp_lg_u32 s5, 11
    s_cbranch_scc1 L_cs_32
    s_add_u32 s10, s69, 45056
    buffer_store_dwordx4 v[72:75], v6, s[52:55], s10 offen sc1
    s_branch L_cs_32
L_cs_31:
    v_mfma_f32_32x32x16_bf16 v[144:159], v[76:79], v[160:163], v[144:159]
    s_cmp_lg_u32 s5, 11
    s_cbranch_scc1 L_cs_32
    s_add_u32 s10, s69, 45056
    buffer_store_dwordx4 v[76:79], v6, s[52:55], s10 offen sc1
L_cs_32:
    s_waitcnt lgkmcnt(6)
    v_mfma_f32_32x32x16_bf16 v[80:95], v[56:59], v[32:35], v[80:95]
    ds_read_b128 v[48:51], v14 offset:32768
    ds_read_b128 v[52:55], v14 offset:36864
    ds_read_b64_tr_b16 v[72:73], v30 offset:40960
    ds_read_b64_tr_b16 v[74:75], v30 offset:41984
    ds_read_b64_tr_b16 v[76:77], v31 offset:40960
    ds_read_b64_tr_b16 v[78:79], v31 offset:41984
    v_mfma_f32_32x32x16_bf16 v[96:111], v[56:59], v[36:39], v[96:111]
    v_mfma_f32_32x32x16_bf16 v[112:127], v[60:63], v[32:35], v[112:127]
    v_mfma_f32_32x32x16_bf16 v[128:143], v[60:63], v[36:39], v[128:143]
    s_cmp_eq_u32 s8, 1
    s_cbranch_scc1 L_cs_33
    v_mfma_f32_32x32x16_bf16 v[144:159], v[56:59], v[160:163], v[144:159]
    s_cmp_lg_u32 s5, 12
    s_cbranch_scc1 L_cs_34
    s_add_u32 s10, s69, 49152
    buffer_store_dwordx4 v[56:59], v6, s[52:55], s10 offen sc1
    s_branch L_cs_34
L_cs_33:
    v_mfma_f32_32x32x16_bf16 v[144:159], v[60:63], v[160:163], v[144:159]
    s_cmp_lg_u32 s5, 12
    s_cbranch_scc1 L_cs_34
    s_add_u32 s10, s69, 49152
    buffer_store_dwordx4 v[60:63], v6, s[52:55], s10 offen sc1
L_cs_34:
    s_waitcnt lgkmcnt(6)
    v_mfma_f32_32x32x16_bf16 v[80:95], v[64:67], v[40:43], v[80:95]
    ds_read_b128 v[32:35], v15 offset:32768
    ds_read_b128 v[36:39], v15 offset:36864
    ds_read_b64_tr_b16 v[56:57], v30 offset:45056
    ds_read_b64_tr_b16 v[58:59], v30 offset:46080
    ds_read_b64_tr_b16 v[60:61], v31 offset:45056
    ds_read_b64_tr_b16 v[62:63], v31 offset:46080
    v_mfma_f32_32x32x16_bf16 v[96:111], v[64:67], v[44:47], v[96:111]
    v_mfma_f32_32x32x16_bf16 v[112:127], v[68:71], v[40:43], v[112:127]
    v_mfma_f32_32x32x16_bf16 v[128:143], v[68:71], v[44:47], v[128:143]
    s_cmp_eq_u32 s8, 1
    s_cbranch_scc1 L_cs_35
    v_mfma_f32_32x32x16_bf16 v[144:159], v[64:67], v[160:163], v[144:159]
    s_cmp_lg_u32 s5, 13
    s_cbranch_scc1 L_cs_36
    s_add_u32 s10, s69, 53248
    buffer_store_dwordx4 v[64:67], v6, s[52:55], s10 offen sc1
    s_branch L_cs_36
L_cs_35:
    v_mfma_f32_32x32x16_bf16 v[144:159], v[68:71], v[160:163], v[144:159]
    s_cmp_lg_u32 s5, 13
    s_cbranch_scc1 L_cs_36
    s_add_u32 s10, s69, 53248
    buffer_store_dwordx4 v[68:71], v6, s[52:55], s10 offen sc1
L_cs_36:
    s_waitcnt lgkmcnt(6)
    s_barrier
    v_mfma_f32_32x32x16_bf16 v[80:95], v[72:75], v[48:51], v[80:95]
    ds_read_b128 v[40:43], v8 offset:0
    ds_read_b128 v[44:47], v8 offset:4096
    ds_read_b64_tr_b16 v[64:65], v28 offset:0
    ds_read_b64_tr_b16 v[66:67], v28 offset:1024
    ds_read_b64_tr_b16 v[68:69], v29 offset:0
    ds_read_b64_tr_b16 v[70:71], v29 offset:1024
    v_mfma_f32_32x32x16_bf16 v[96:111], v[72:75], v[52:55], v[96:111]
    v_mfma_f32_32x32x16_bf16 v[112:127], v[76:79], v[48:51], v[112:127]
    v_mfma_f32_32x32x16_bf16 v[128:143], v[76:79], v[52:55], v[128:143]
    s_cmp_eq_u32 s8, 1
    s_cbranch_scc1 L_cs_37
    v_mfma_f32_32x32x16_bf16 v[144:159], v[72:75], v[160:163], v[144:159]
    s_cmp_lg_u32 s5, 14
    s_cbranch_scc1 L_cs_38
    s_add_u32 s10, s69, 57344
    buffer_store_dwordx4 v[72:75], v6, s[52:55], s10 offen sc1
    s_branch L_cs_38
L_cs_37:
    v_mfma_f32_32x32x16_bf16 v[144:159], v[76:79], v[160:163], v[144:159]
    s_cmp_lg_u32 s5, 14
    s_cbranch_scc1 L_cs_38
    s_add_u32 s10, s69, 57344
    buffer_store_dwordx4 v[76:79], v6, s[52:55], s10 offen sc1
L_cs_38:
    s_waitcnt lgkmcnt(6)
    v_mfma_f32_32x32x16_bf16 v[80:95], v[56:59], v[32:35], v[80:95]
    ds_read_b128 v[48:51], v9 offset:0
    ds_read_b128 v[52:55], v9 offset:4096
    ds_read_b64_tr_b16 v[72:73], v28 offset:4096
    ds_read_b64_tr_b16 v[74:75], v28 offset:5120
    ds_read_b64_tr_b16 v[76:77], v29 offset:4096
    ds_read_b64_tr_b16 v[78:79], v29 offset:5120
    v_mfma_f32_32x32x16_bf16 v[96:111], v[56:59], v[36:39], v[96:111]
    v_mfma_f32_32x32x16_bf16 v[112:127], v[60:63], v[32:35], v[112:127]
    v_mfma_f32_32x32x16_bf16 v[128:143], v[60:63], v[36:39], v[128:143]
    s_cmp_eq_u32 s8, 1
    s_cbranch_scc1 L_cs_39
    v_mfma_f32_32x32x16_bf16 v[144:159], v[56:59], v[160:163], v[144:159]
    s_cmp_lg_u32 s5, 15
    s_cbranch_scc1 L_cs_40
    s_add_u32 s10, s69, 61440
    buffer_store_dwordx4 v[56:59], v6, s[52:55], s10 offen sc1
    s_branch L_cs_40
L_cs_39:
    v_mfma_f32_32x32x16_bf16 v[144:159], v[60:63], v[160:163], v[144:159]
    s_cmp_lg_u32 s5, 15
    s_cbranch_scc1 L_cs_40
    s_add_u32 s10, s69, 61440
    buffer_store_dwordx4 v[60:63], v6, s[52:55], s10 offen sc1
L_cs_40:
    s_waitcnt lgkmcnt(6)
    v_mfma_f32_32x32x16_bf16 v[80:95], v[64:67], v[40:43], v[80:95]
    ds_read_b128 v[32:35], v10 offset:0
    ds_read_b128 v[36:39], v10 offset:4096
    ds_read_b64_tr_b16 v[56:57], v28 offset:8192
    ds_read_b64_tr_b16 v[58:59], v28 offset:9216
    ds_read_b64_tr_b16 v[60:61], v29 offset:8192
    ds_read_b64_tr_b16 v[62:63], v29 offset:9216
    v_mfma_f32_32x32x16_bf16 v[96:111], v[64:67], v[44:47], v[96:111]
    v_mfma_f32_32x32x16_bf16 v[112:127], v[68:71], v[40:43], v[112:127]
    v_mfma_f32_32x32x16_bf16 v[128:143], v[68:71], v[44:47], v[128:143]
    s_cmp_eq_u32 s8, 1
    s_cbranch_scc1 L_cs_41
    v_mfma_f32_32x32x16_bf16 v[144:159], v[64:67], v[160:163], v[144:159]
    s_cmp_lg_u32 s5, 0
    s_cbranch_scc1 L_cs_42
    s_add_u32 s10, s69, 65536
    buffer_store_dwordx4 v[64:67], v6, s[52:55], s10 offen sc1
    s_branch L_cs_42
L_cs_41:
    v_mfma_f32_32x32x16_bf16 v[144:159], v[68:71], v[160:163], v[144:159]
    s_cmp_lg_u32 s5, 0
    s_cbranch_scc1 L_cs_42
    s_add_u32 s10, s69, 65536
    buffer_store_dwordx4 v[68:71], v6, s[52:55], s10 offen sc1
L_cs_42:
    s_waitcnt lgkmcnt(6)
    v_mfma_f32_32x32x16_bf16 v[80:95], v[72:75], v[48:51], v[80:95]
    ds_read_b128 v[40:43], v11 offset:0
    ds_read_b128 v[44:47], v11 offset:4096
    ds_read_b64_tr_b16 v[64:65], v28 offset:12288
    ds_read_b64_tr_b16 v[66:67], v28 offset:13312
    ds_read_b64_tr_b16 v[68:69], v29 offset:12288
    ds_read_b64_tr_b16 v[70:71], v29 offset:13312
    v_mfma_f32_32x32x16_bf16 v[96:111], v[72:75], v[52:55], v[96:111]
    v_mfma_f32_32x32x16_bf16 v[112:127], v[76:79], v[48:51], v[112:127]
    v_mfma_f32_32x32x16_bf16 v[128:143], v[76:79], v[52:55], v[128:143]
    s_cmp_eq_u32 s8, 1
    s_cbranch_scc1 L_cs_43
    v_mfma_f32_32x32x16_bf16 v[144:159], v[72:75], v[160:163], v[144:159]
    s_cmp_lg_u32 s5, 1
    s_cbranch_scc1 L_cs_44
    s_add_u32 s10, s69, 69632
    buffer_store_dwordx4 v[72:75], v6, s[52:55], s10 offen sc1
    s_branch L_cs_44
L_cs_43:
    v_mfma_f32_32x32x16_bf16 v[144:159], v[76:79], v[160:163], v[144:159]
    s_cmp_lg_u32 s5, 1
    s_cbranch_scc1 L_cs_44
    s_add_u32 s10, s69, 69632
    buffer_store_dwordx4 v[76:79], v6, s[52:55], s10 offen sc1
L_cs_44:
    s_waitcnt lgkmcnt(6)
    s_barrier
    v_mfma_f32_32x32x16_bf16 v[80:95], v[56:59], v[32:35], v[80:95]
    ds_read_b128 v[48:51], v8 offset:32768
    ds_read_b128 v[52:55], v8 offset:36864
    ds_read_b64_tr_b16 v[72:73], v28 offset:32768
    ds_read_b64_tr_b16 v[74:75], v28 offset:33792
    ds_read_b64_tr_b16 v[76:77], v29 offset:32768
    ds_read_b64_tr_b16 v[78:79], v29 offset:33792
    v_mfma_f32_32x32x16_bf16 v[96:111], v[56:59], v[36:39], v[96:111]
    v_mfma_f32_32x32x16_bf16 v[112:127], v[60:63], v[32:35], v[112:127]
    v_mfma_f32_32x32x16_bf16 v[128:143], v[60:63], v[36:39], v[128:143]
    s_cmp_eq_u32 s8, 1
    s_cbranch_scc1 L_cs_45
    v_mfma_f32_32x32x16_bf16 v[144:159], v[56:59], v[160:163], v[144:159]
    s_cmp_lg_u32 s5, 2
    s_cbranch_scc1 L_cs_46
    s_add_u32 s10, s69, 73728
    buffer_store_dwordx4 v[56:59], v6, s[52:55], s10 offen sc1
    s_branch L_cs_46
L_cs_45:
    v_mfma_f32_32x32x16_bf16 v[144:159], v[60:63], v[160:163], v[144:159]
    s_cmp_lg_u32 s5, 2
    s_cbranch_scc1 L_cs_46
    s_add_u32 s10, s69, 73728
    buffer_store_dwordx4 v[60:63], v6, s[52:55], s10 offen sc1
L_cs_46:
    s_waitcnt lgkmcnt(6)
    v_mfma_f32_32x32x16_bf16 v[80:95], v[64:67], v[40:43], v[80:95]
    ds_read_b128 v[32:35], v9 offset:32768
    ds_read_b128 v[36:39], v9 offset:36864
    ds_read_b64_tr_b16 v[56:57], v28 offset:36864
    ds_read_b64_tr_b16 v[58:59], v28 offset:37888
    ds_read_b64_tr_b16 v[60:61], v29 offset:36864
    ds_read_b64_tr_b16 v[62:63], v29 offset:37888
    v_mfma_f32_32x32x16_bf16 v[96:111], v[64:67], v[44:47], v[96:111]
    v_mfma_f32_32x32x16_bf16 v[112:127], v[68:71], v[40:43], v[112:127]
    v_mfma_f32_32x32x16_bf16 v[128:143], v[68:71], v[44:47], v[128:143]
    s_cmp_eq_u32 s8, 1
    s_cbranch_scc1 L_cs_47
    v_mfma_f32_32x32x16_bf16 v[144:159], v[64:67], v[160:163], v[144:159]
    s_cmp_lg_u32 s5, 3
    s_cbranch_scc1 L_cs_48
    s_add_u32 s10, s69, 77824
    buffer_store_dwordx4 v[64:67], v6, s[52:55], s10 offen sc1
    s_branch L_cs_48
L_cs_47:
    v_mfma_f32_32x32x16_bf16 v[144:159], v[68:71], v[160:163], v[144:159]
    s_cmp_lg_u32 s5, 3
    s_cbranch_scc1 L_cs_48
    s_add_u32 s10, s69, 77824
    buffer_store_dwordx4 v[68:71], v6, s[52:55], s10 offen sc1
L_cs_48:
    s_waitcnt lgkmcnt(6)
    v_mfma_f32_32x32x16_bf16 v[80:95], v[72:75], v[48:51], v[80:95]
    ds_read_b128 v[40:43], v10 offset:32768
    ds_read_b128 v[44:47], v10 offset:36864
    ds_read_b64_tr_b16 v[64:65], v28 offset:40960
    ds_read_b64_tr_b16 v[66:67], v28 offset:41984
    ds_read_b64_tr_b16 v[68:69], v29 offset:40960
    ds_read_b64_tr_b16 v[70:71], v29 offset:41984
    v_mfma_f32_32x32x16_bf16 v[96:111], v[72:75], v[52:55], v[96:111]
    v_mfma_f32_32x32x16_bf16 v[112:127], v[76:79], v[48:51], v[112:127]
    v_mfma_f32_32x32x16_bf16 v[128:143], v[76:79], v[52:55], v[128:143]
    s_cmp_eq_u32 s8, 1
    s_cbranch_scc1 L_cs_49
    v_mfma_f32_32x32x16_bf16 v[144:159], v[72:75], v[160:163], v[144:159]
    s_cmp_lg_u32 s5, 4
    s_cbranch_scc1 L_cs_50
    s_add_u32 s10, s69, 81920
    buffer_store_dwordx4 v[72:75], v6, s[52:55], s10 offen sc1
    s_branch L_cs_50
L_cs_49:
    v_mfma_f32_32x32x16_bf16 v[144:159], v[76:79], v[160:163], v[144:159]
    s_cmp_lg_u32 s5, 4
    s_cbranch_scc1 L_cs_50
    s_add_u32 s10, s69, 81920
    buffer_store_dwordx4 v[76:79], v6, s[52:55], s10 offen sc1
L_cs_50:
    s_waitcnt lgkmcnt(6)
    v_mfma_f32_32x32x16_bf16 v[80:95], v[56:59], v[32:35], v[80:95]
    ds_read_b128 v[48:51], v11 offset:32768
    ds_read_b128 v[52:55], v11 offset:36864
    ds_read_b64_tr_b16 v[72:73], v28 offset:45056
    ds_read_b64_tr_b16 v[74:75], v28 offset:46080
    ds_read_b64_tr_b16 v[76:77], v29 offset:45056
    ds_read_b64_tr_b16 v[78:79], v29 offset:46080
    v_mfma_f32_32x32x16_bf16 v[96:111], v[56:59], v[36:39], v[96:111]
    v_mfma_f32_32x32x16_bf16 v[112:127], v[60:63], v[32:35], v[112:127]
    v_mfma_f32_32x32x16_bf16 v[128:143], v[60:63], v[36:39], v[128:143]
    s_cmp_eq_u32 s8, 1
    s_cbranch_scc1 L_cs_51
    v_mfma_f32_32x32x16_bf16 v[144:159], v[56:59], v[160:163], v[144:159]
    s_cmp_lg_u32 s5, 5
    s_cbranch_scc1 L_cs_52
    s_add_u32 s10, s69, 86016
    buffer_store_dwordx4 v[56:59], v6, s[52:55], s10 offen sc1
    s_branch L_cs_52
L_cs_51:
    v_mfma_f32_32x32x16_bf16 v[144:159], v[60:63], v[160:163], v[144:159]
    s_cmp_lg_u32 s5, 5
    s_cbranch_scc1 L_cs_52
    s_add_u32 s10, s69, 86016
    buffer_store_dwordx4 v[60:63], v6, s[52:55], s10 offen sc1
L_cs_52:
    s_waitcnt lgkmcnt(6)
    s_barrier
    v_mfma_f32_32x32x16_bf16 v[80:95], v[64:67], v[40:43], v[80:95]
    ds_read_b128 v[32:35], v12 offset:0
    ds_read_b128 v[36:39], v12 offset:4096
    ds_read_b64_tr_b16 v[56:57], v30 offset:0
    ds_read_b64_tr_b16 v[58:59], v30 offset:1024
    ds_read_b64_tr_b16 v[60:61], v31 offset:0
    ds_read_b64_tr_b16 v[62:63], v31 offset:1024
    v_mfma_f32_32x32x16_bf16 v[96:111], v[64:67], v[44:47], v[96:111]
    v_mfma_f32_32x32x16_bf16 v[112:127], v[68:71], v[40:43], v[112:127]
    v_mfma_f32_32x32x16_bf16 v[128:143], v[68:71], v[44:47], v[128:143]
    s_cmp_eq_u32 s8, 1
    s_cbranch_scc1 L_cs_53
    v_mfma_f32_32x32x16_bf16 v[144:159], v[64:67], v[160:163], v[144:159]
    s_cmp_lg_u32 s5, 6
    s_cbranch_scc1 L_cs_54
    s_add_u32 s10, s69, 90112
    buffer_store_dwordx4 v[64:67], v6, s[52:55], s10 offen sc1
    s_branch L_cs_54
L_cs_53:
    v_mfma_f32_32x32x16_bf16 v[144:159], v[68:71], v[160:163], v[144:159]
    s_cmp_lg_u32 s5, 6
    s_cbranch_scc1 L_cs_54
    s_add_u32 s10, s69, 90112
    buffer_store_dwordx4 v[68:71], v6, s[52:55], s10 offen sc1
L_cs_54:
    s_waitcnt lgkmcnt(6)
    v_mfma_f32_32x32x16_bf16 v[80:95], v[72:75], v[48:51], v[80:95]
    ds_read_b128 v[40:43], v13 offset:0
    ds_read_b128 v[44:47], v13 offset:4096
    ds_read_b64_tr_b16 v[64:65], v30 offset:4096
    ds_read_b64_tr_b16 v[66:67], v30 offset:5120
    ds_read_b64_tr_b16 v[68:69], v31 offset:4096
    ds_read_b64_tr_b16 v[70:71], v31 offset:5120
    v_mfma_f32_32x32x16_bf16 v[96:111], v[72:75], v[52:55], v[96:111]
    v_mfma_f32_32x32x16_bf16 v[112:127], v[76:79], v[48:51], v[112:127]
    v_mfma_f32_32x32x16_bf16 v[128:143], v[76:79], v[52:55], v[128:143]
    s_cmp_eq_u32 s8, 1
    s_cbranch_scc1 L_cs_55
    v_mfma_f32_32x32x16_bf16 v[144:159], v[72:75], v[160:163], v[144:159]
    s_cmp_lg_u32 s5, 7
    s_cbranch_scc1 L_cs_56
    s_add_u32 s10, s69, 94208
    buffer_store_dwordx4 v[72:75], v6, s[52:55], s10 offen sc1
    s_branch L_cs_56
L_cs_55:
    v_mfma_f32_32x32x16_bf16 v[144:159], v[76:79], v[160:163], v[144:159]
    s_cmp_lg_u32 s5, 7
    s_cbranch_scc1 L_cs_56
    s_add_u32 s10, s69, 94208
    buffer_store_dwordx4 v[76:79], v6, s[52:55], s10 offen sc1
L_cs_56:
    s_waitcnt lgkmcnt(6)
    v_mfma_f32_32x32x16_bf16 v[80:95], v[56:59], v[32:35], v[80:95]
    ds_read_b128 v[48:51], v14 offset:0
    ds_read_b128 v[52:55], v14 offset:4096
    ds_read_b64_tr_b16 v[72:73], v30 offset:8192
    ds_read_b64_tr_b16 v[74:75], v30 offset:9216
    ds_read_b64_tr_b16 v[76:77], v31 offset:8192
    ds_read_b64_tr_b16 v[78:79], v31 offset:9216
    v_mfma_f32_32x32x16_bf16 v[96:111], v[56:59], v[36:39], v[96:111]
    v_mfma_f32_32x32x16_bf16 v[112:127], v[60:63], v[32:35], v[112:127]
    v_mfma_f32_32x32x16_bf16 v[128:143], v[60:63], v[36:39], v[128:143]
    s_cmp_eq_u32 s8, 1
    s_cbranch_scc1 L_cs_57
    v_mfma_f32_32x32x16_bf16 v[144:159], v[56:59], v[160:163], v[144:159]
    s_cmp_lg_u32 s5, 8
    s_cbranch_scc1 L_cs_58
    s_add_u32 s10, s69, 98304
    buffer_store_dwordx4 v[56:59], v6, s[52:55], s10 offen sc1
    s_branch L_cs_58
L_cs_57:
    v_mfma_f32_32x32x16_bf16 v[144:159], v[60:63], v[160:163], v[144:159]
    s_cmp_lg_u32 s5, 8
    s_cbranch_scc1 L_cs_58
    s_add_u32 s10, s69, 98304
    buffer_store_dwordx4 v[60:63], v6, s[52:55], s10 offen sc1
L_cs_58:
    s_waitcnt lgkmcnt(6)
    v_mfma_f32_32x32x16_bf16 v[80:95], v[64:67], v[40:43], v[80:95]
    ds_read_b128 v[32:35], v15 offset:0
    ds_read_b128 v[36:39], v15 offset:4096
    ds_read_b64_tr_b16 v[56:57], v30 offset:12288
    ds_read_b64_tr_b16 v[58:59], v30 offset:13312
    ds_read_b64_tr_b16 v[60:61], v31 offset:12288
    ds_read_b64_tr_b16 v[62:63], v31 offset:13312
    v_mfma_f32_32x32x16_bf16 v[96:111], v[64:67], v[44:47], v[96:111]
    v_mfma_f32_32x32x16_bf16 v[112:127], v[68:71], v[40:43], v[112:127]
    v_mfma_f32_32x32x16_bf16 v[128:143], v[68:71], v[44:47], v[128:143]
    s_cmp_eq_u32 s8, 1
    s_cbranch_scc1 L_cs_59
    v_mfma_f32_32x32x16_bf16 v[144:159], v[64:67], v[160:163], v[144:159]
    s_cmp_lg_u32 s5, 9
    s_cbranch_scc1 L_cs_60
    s_add_u32 s10, s69, 102400
    buffer_store_dwordx4 v[64:67], v6, s[52:55], s10 offen sc1
    s_branch L_cs_60
L_cs_59:
    v_mfma_f32_32x32x16_bf16 v[144:159], v[68:71], v[160:163], v[144:159]
    s_cmp_lg_u32 s5, 9
    s_cbranch_scc1 L_cs_60
    s_add_u32 s10, s69, 102400
    buffer_store_dwordx4 v[68:71], v6, s[52:55], s10 offen sc1
L_cs_60:
    s_waitcnt lgkmcnt(6)
    s_barrier
    v_mfma_f32_32x32x16_bf16 v[80:95], v[72:75], v[48:51], v[80:95]
    ds_read_b128 v[40:43], v12 offset:32768
    ds_read_b128 v[44:47], v12 offset:36864
    ds_read_b64_tr_b16 v[64:65], v30 offset:32768
    ds_read_b64_tr_b16 v[66:67], v30 offset:33792
    ds_read_b64_tr_b16 v[68:69], v31 offset:32768
    ds_read_b64_tr_b16 v[70:71], v31 offset:33792
    v_mfma_f32_32x32x16_bf16 v[96:111], v[72:75], v[52:55], v[96:111]
    v_mfma_f32_32x32x16_bf16 v[112:127], v[76:79], v[48:51], v[112:127]
    v_mfma_f32_32x32x16_bf16 v[128:143], v[76:79], v[52:55], v[128:143]
    s_cmp_eq_u32 s8, 1
    s_cbranch_scc1 L_cs_61
    v_mfma_f32_32x32x16_bf16 v[144:159], v[72:75], v[160:163], v[144:159]
    s_cmp_lg_u32 s5, 10
    s_cbranch_scc1 L_cs_62
    s_add_u32 s10, s69, 106496
    buffer_store_dwordx4 v[72:75], v6, s[52:55], s10 offen sc1
    s_branch L_cs_62
L_cs_61:
    v_mfma_f32_32x32x16_bf16 v[144:159], v[76:79], v[160:163], v[144:159]
    s_cmp_lg_u32 s5, 10
    s_cbranch_scc1 L_cs_62
    s_add_u32 s10, s69, 106496
    buffer_store_dwordx4 v[76:79], v6, s[52:55], s10 offen sc1
L_cs_62:
    s_waitcnt lgkmcnt(6)
    v_mfma_f32_32x32x16_bf16 v[80:95], v[56:59], v[32:35], v[80:95]
    ds_read_b128 v[48:51], v13 offset:32768
    ds_read_b128 v[52:55], v13 offset:36864
    ds_read_b64_tr_b16 v[72:73], v30 offset:36864
    ds_read_b64_tr_b16 v[74:75], v30 offset:37888
    ds_read_b64_tr_b16 v[76:77], v31 offset:36864
    ds_read_b64_tr_b16 v[78:79], v31 offset:37888
    v_mfma_f32_32x32x16_bf16 v[96:111], v[56:59], v[36:39], v[96:111]
    v_mfma_f32_32x32x16_bf16 v[112:127], v[60:63], v[32:35], v[112:127]
    v_mfma_f32_32x32x16_bf16 v[128:143], v[60:63], v[36:39], v[128:143]
    s_cmp_eq_u32 s8, 1
    s_cbranch_scc1 L_cs_63
    v_mfma_f32_32x32x16_bf16 v[144:159], v[56:59], v[160:163], v[144:159]
    s_cmp_lg_u32 s5, 11
    s_cbranch_scc1 L_cs_64
    s_add_u32 s10, s69, 110592
    buffer_store_dwordx4 v[56:59], v6, s[52:55], s10 offen sc1
    s_branch L_cs_64
L_cs_63:
    v_mfma_f32_32x32x16_bf16 v[144:159], v[60:63], v[160:163], v[144:159]
    s_cmp_lg_u32 s5, 11
    s_cbranch_scc1 L_cs_64
    s_add_u32 s10, s69, 110592
    buffer_store_dwordx4 v[60:63], v6, s[52:55], s10 offen sc1
L_cs_64:
    s_waitcnt lgkmcnt(6)
    v_mfma_f32_32x32x16_bf16 v[80:95], v[64:67], v[40:43], v[80:95]
    ds_read_b128 v[32:35], v14 offset:32768
    ds_read_b128 v[36:39], v14 offset:36864
    ds_read_b64_tr_b16 v[56:57], v30 offset:40960
    ds_read_b64_tr_b16 v[58:59], v30 offset:41984
    ds_read_b64_tr_b16 v[60:61], v31 offset:40960
    ds_read_b64_tr_b16 v[62:63], v31 offset:41984
    v_mfma_f32_32x32x16_bf16 v[96:111], v[64:67], v[44:47], v[96:111]
    v_mfma_f32_32x32x16_bf16 v[112:127], v[68:71], v[40:43], v[112:127]
    v_mfma_f32_32x32x16_bf16 v[128:143], v[68:71], v[44:47], v[128:143]
    s_cmp_eq_u32 s8, 1
    s_cbranch_scc1 L_cs_65
    v_mfma_f32_32x32x16_bf16 v[144:159], v[64:67], v[160:163], v[144:159]
    s_cmp_lg_u32 s5, 12
    s_cbranch_scc1 L_cs_66
    s_add_u32 s10, s69, 114688
    buffer_store_dwordx4 v[64:67], v6, s[52:55], s10 offen sc1
    s_branch L_cs_66
L_cs_65:
    v_mfma_f32_32x32x16_bf16 v[144:159], v[68:71], v[160:163], v[144:159]
    s_cmp_lg_u32 s5, 12
    s_cbranch_scc1 L_cs_66
    s_add_u32 s10, s69, 114688
    buffer_store_dwordx4 v[68:71], v6, s[52:55], s10 offen sc1
L_cs_66:
    s_waitcnt lgkmcnt(6)
    v_mfma_f32_32x32x16_bf16 v[80:95], v[72:75], v[48:51], v[80:95]
    ds_read_b128 v[40:43], v15 offset:32768
    ds_read_b128 v[44:47], v15 offset:36864
    ds_read_b64_tr_b16 v[64:65], v30 offset:45056
    ds_read_b64_tr_b16 v[66:67], v30 offset:46080
    ds_read_b64_tr_b16 v[68:69], v31 offset:45056
    ds_read_b64_tr_b16 v[70:71], v31 offset:46080
    v_mfma_f32_32x32x16_bf16 v[96:111], v[72:75], v[52:55], v[96:111]
    v_mfma_f32_32x32x16_bf16 v[112:127], v[76:79], v[48:51], v[112:127]
    v_mfma_f32_32x32x16_bf16 v[128:143], v[76:79], v[52:55], v[128:143]
    s_cmp_eq_u32 s8, 1
    s_cbranch_scc1 L_cs_67
    v_mfma_f32_32x32x16_bf16 v[144:159], v[72:75], v[160:163], v[144:159]
    s_cmp_lg_u32 s5, 13
    s_cbranch_scc1 L_cs_68
    s_add_u32 s10, s69, 118784
    buffer_store_dwordx4 v[72:75], v6, s[52:55], s10 offen sc1
    s_branch L_cs_68
L_cs_67:
    v_mfma_f32_32x32x16_bf16 v[144:159], v[76:79], v[160:163], v[144:159]
    s_cmp_lg_u32 s5, 13
    s_cbranch_scc1 L_cs_68
    s_add_u32 s10, s69, 118784
    buffer_store_dwordx4 v[76:79], v6, s[52:55], s10 offen sc1
L_cs_68:
    s_waitcnt lgkmcnt(6)
    s_barrier
    v_mfma_f32_32x32x16_bf16 v[80:95], v[56:59], v[32:35], v[80:95]
    ds_read_b128 v[48:51], v8 offset:0
    ds_read_b128 v[52:55], v8 offset:4096
    ds_read_b64_tr_b16 v[72:73], v28 offset:0
    ds_read_b64_tr_b16 v[74:75], v28 offset:1024
    ds_read_b64_tr_b16 v[76:77], v29 offset:0
    ds_read_b64_tr_b16 v[78:79], v29 offset:1024
    v_mfma_f32_32x32x16_bf16 v[96:111], v[56:59], v[36:39], v[96:111]
    v_mfma_f32_32x32x16_bf16 v[112:127], v[60:63], v[32:35], v[112:127]
    v_mfma_f32_32x32x16_bf16 v[128:143], v[60:63], v[36:39], v[128:143]
    s_cmp_eq_u32 s8, 1
    s_cbranch_scc1 L_cs_69
    v_mfma_f32_32x32x16_bf16 v[144:159], v[56:59], v[160:163], v[144:159]
    s_cmp_lg_u32 s5, 14
    s_cbranch_scc1 L_cs_70
    s_add_u32 s10, s69, 122880
    buffer_store_dwordx4 v[56:59], v6, s[52:55], s10 offen sc1
    s_branch L_cs_70
L_cs_69:
    v_mfma_f32_32x32x16_bf16 v[144:159], v[60:63], v[160:163], v[144:159]
    s_cmp_lg_u32 s5, 14
    s_cbranch_scc1 L_cs_70
    s_add_u32 s10, s69, 122880
    buffer_store_dwordx4 v[60:63], v6, s[52:55], s10 offen sc1
L_cs_70:
    s_waitcnt lgkmcnt(6)
    v_mfma_f32_32x32x16_bf16 v[80:95], v[64:67], v[40:43], v[80:95]
    ds_read_b128 v[32:35], v9 offset:0
    ds_read_b128 v[36:39], v9 offset:4096
    ds_read_b64_tr_b16 v[56:57], v28 offset:4096
    ds_read_b64_tr_b16 v[58:59], v28 offset:5120
    ds_read_b64_tr_b16 v[60:61], v29 offset:4096
    ds_read_b64_tr_b16 v[62:63], v29 offset:5120
    v_mfma_f32_32x32x16_bf16 v[96:111], v[64:67], v[44:47], v[96:111]
    v_mfma_f32_32x32x16_bf16 v[112:127], v[68:71], v[40:43], v[112:127]
    v_mfma_f32_32x32x16_bf16 v[128:143], v[68:71], v[44:47], v[128:143]
    s_cmp_eq_u32 s8, 1
    s_cbranch_scc1 L_cs_71
    v_mfma_f32_32x32x16_bf16 v[144:159], v[64:67], v[160:163], v[144:159]
    s_cmp_lg_u32 s5, 15
    s_cbranch_scc1 L_cs_72
    s_add_u32 s10, s69, 126976
    buffer_store_dwordx4 v[64:67], v6, s[52:55], s10 offen sc1
    s_branch L_cs_72
L_cs_71:
    v_mfma_f32_32x32x16_bf16 v[144:159], v[68:71], v[160:163], v[144:159]
    s_cmp_lg_u32 s5, 15
    s_cbranch_scc1 L_cs_72
    s_add_u32 s10, s69, 126976
    buffer_store_dwordx4 v[68:71], v6, s[52:55], s10 offen sc1
L_cs_72:
    s_waitcnt lgkmcnt(6)
    v_mfma_f32_32x32x16_bf16 v[80:95], v[72:75], v[48:51], v[80:95]
    ds_read_b128 v[40:43], v10 offset:0
    ds_read_b128 v[44:47], v10 offset:4096
    ds_read_b64_tr_b16 v[64:65], v28 offset:8192
    ds_read_b64_tr_b16 v[66:67], v28 offset:9216
    ds_read_b64_tr_b16 v[68:69], v29 offset:8192
    ds_read_b64_tr_b16 v[70:71], v29 offset:9216
    v_mfma_f32_32x32x16_bf16 v[96:111], v[72:75], v[52:55], v[96:111]
    v_mfma_f32_32x32x16_bf16 v[112:127], v[76:79], v[48:51], v[112:127]
    v_mfma_f32_32x32x16_bf16 v[128:143], v[76:79], v[52:55], v[128:143]
    s_cmp_eq_u32 s8, 1
    s_cbranch_scc1 L_cs_73
    v_mfma_f32_32x32x16_bf16 v[144:159], v[72:75], v[160:163], v[144:159]
    s_cmp_lg_u32 s5, 0
    s_cbranch_scc1 L_cs_74
    s_add_u32 s10, s69, 131072
    buffer_store_dwordx4 v[72:75], v6, s[52:55], s10 offen sc1
    s_branch L_cs_74
L_cs_73:
    v_mfma_f32_32x32x16_bf16 v[144:159], v[76:79], v[160:163], v[144:159]
    s_cmp_lg_u32 s5, 0
    s_cbranch_scc1 L_cs_74
    s_add_u32 s10, s69, 131072
    buffer_store_dwordx4 v[76:79], v6, s[52:55], s10 offen sc1
L_cs_74:
    s_waitcnt lgkmcnt(6)
    v_mfma_f32_32x32x16_bf16 v[80:95], v[56:59], v[32:35], v[80:95]
    ds_read_b128 v[48:51], v11 offset:0
    ds_read_b128 v[52:55], v11 offset:4096
    ds_read_b64_tr_b16 v[72:73], v28 offset:12288
    ds_read_b64_tr_b16 v[74:75], v28 offset:13312
    ds_read_b64_tr_b16 v[76:77], v29 offset:12288
    ds_read_b64_tr_b16 v[78:79], v29 offset:13312
    v_mfma_f32_32x32x16_bf16 v[96:111], v[56:59], v[36:39], v[96:111]
    v_mfma_f32_32x32x16_bf16 v[112:127], v[60:63], v[32:35], v[112:127]
    v_mfma_f32_32x32x16_bf16 v[128:143], v[60:63], v[36:39], v[128:143]
    s_cmp_eq_u32 s8, 1
    s_cbranch_scc1 L_cs_75
    v_mfma_f32_32x32x16_bf16 v[144:159], v[56:59], v[160:163], v[144:159]
    s_cmp_lg_u32 s5, 1
    s_cbranch_scc1 L_cs_76
    s_add_u32 s10, s69, 135168
    buffer_store_dwordx4 v[56:59], v6, s[52:55], s10 offen sc1
    s_branch L_cs_76
L_cs_75:
    v_mfma_f32_32x32x16_bf16 v[144:159], v[60:63], v[160:163], v[144:159]
    s_cmp_lg_u32 s5, 1
    s_cbranch_scc1 L_cs_76
    s_add_u32 s10, s69, 135168
    buffer_store_dwordx4 v[60:63], v6, s[52:55], s10 offen sc1
L_cs_76:
    s_waitcnt lgkmcnt(6)
    s_barrier
    v_mfma_f32_32x32x16_bf16 v[80:95], v[64:67], v[40:43], v[80:95]
    ds_read_b128 v[32:35], v8 offset:32768
    ds_read_b128 v[36:39], v8 offset:36864
    ds_read_b64_tr_b16 v[56:57], v28 offset:32768
    ds_read_b64_tr_b16 v[58:59], v28 offset:33792
    ds_read_b64_tr_b16 v[60:61], v29 offset:32768
    ds_read_b64_tr_b16 v[62:63], v29 offset:33792
    v_mfma_f32_32x32x16_bf16 v[96:111], v[64:67], v[44:47], v[96:111]
    v_mfma_f32_32x32x16_bf16 v[112:127], v[68:71], v[40:43], v[112:127]
    v_mfma_f32_32x32x16_bf16 v[128:143], v[68:71], v[44:47], v[128:143]
    s_cmp_eq_u32 s8, 1
    s_cbranch_scc1 L_cs_77
    v_mfma_f32_32x32x16_bf16 v[144:159], v[64:67], v[160:163], v[144:159]
    s_cmp_lg_u32 s5, 2
    s_cbranch_scc1 L_cs_78
    s_add_u32 s10, s69, 139264
    buffer_store_dwordx4 v[64:67], v6, s[52:55], s10 offen sc1
    s_branch L_cs_78
L_cs_77:
    v_mfma_f32_32x32x16_bf16 v[144:159], v[68:71], v[160:163], v[144:159]
    s_cmp_lg_u32 s5, 2
    s_cbranch_scc1 L_cs_78
    s_add_u32 s10, s69, 139264
    buffer_store_dwordx4 v[68:71], v6, s[52:55], s10 offen sc1
L_cs_78:
    s_waitcnt lgkmcnt(6)
    v_mfma_f32_32x32x16_bf16 v[80:95], v[72:75], v[48:51], v[80:95]
    ds_read_b128 v[40:43], v9 offset:32768
    ds_read_b128 v[44:47], v9 offset:36864
    ds_read_b64_tr_b16 v[64:65], v28 offset:36864
    ds_read_b64_tr_b16 v[66:67], v28 offset:37888
    ds_read_b64_tr_b16 v[68:69], v29 offset:36864
    ds_read_b64_tr_b16 v[70:71], v29 offset:37888
    v_mfma_f32_32x32x16_bf16 v[96:111], v[72:75], v[52:55], v[96:111]
    v_mfma_f32_32x32x16_bf16 v[112:127], v[76:79], v[48:51], v[112:127]
    v_mfma_f32_32x32x16_bf16 v[128:143], v[76:79], v[52:55], v[128:143]
    s_cmp_eq_u32 s8, 1
    s_cbranch_scc1 L_cs_79
    v_mfma_f32_32x32x16_bf16 v[144:159], v[72:75], v[160:163], v[144:159]
    s_cmp_lg_u32 s5, 3
    s_cbranch_scc1 L_cs_80
    s_add_u32 s10, s69, 143360
    buffer_store_dwordx4 v[72:75], v6, s[52:55], s10 offen sc1
    s_branch L_cs_80
L_cs_79:
    v_mfma_f32_32x32x16_bf16 v[144:159], v[76:79], v[160:163], v[144:159]
    s_cmp_lg_u32 s5, 3
    s_cbranch_scc1 L_cs_80
    s_add_u32 s10, s69, 143360
    buffer_store_dwordx4 v[76:79], v6, s[52:55], s10 offen sc1
L_cs_80:
    s_waitcnt lgkmcnt(6)
    v_mfma_f32_32x32x16_bf16 v[80:95], v[56:59], v[32:35], v[80:95]
    ds_read_b128 v[48:51], v10 offset:32768
    ds_read_b128 v[52:55], v10 offset:36864
    ds_read_b64_tr_b16 v[72:73], v28 offset:40960
    ds_read_b64_tr_b16 v[74:75], v28 offset:41984
    ds_read_b64_tr_b16 v[76:77], v29 offset:40960
    ds_read_b64_tr_b16 v[78:79], v29 offset:41984
    v_mfma_f32_32x32x16_bf16 v[96:111], v[56:59], v[36:39], v[96:111]
    v_mfma_f32_32x32x16_bf16 v[112:127], v[60:63], v[32:35], v[112:127]
    v_mfma_f32_32x32x16_bf16 v[128:143], v[60:63], v[36:39], v[128:143]
    s_cmp_eq_u32 s8, 1
    s_cbranch_scc1 L_cs_81
    v_mfma_f32_32x32x16_bf16 v[144:159], v[56:59], v[160:163], v[144:159]
    s_cmp_lg_u32 s5, 4
    s_cbranch_scc1 L_cs_82
    s_add_u32 s10, s69, 147456
    buffer_store_dwordx4 v[56:59], v6, s[52:55], s10 offen sc1
    s_branch L_cs_82
L_cs_81:
    v_mfma_f32_32x32x16_bf16 v[144:159], v[60:63], v[160:163], v[144:159]
    s_cmp_lg_u32 s5, 4
    s_cbranch_scc1 L_cs_82
    s_add_u32 s10, s69, 147456
    buffer_store_dwordx4 v[60:63], v6, s[52:55], s10 offen sc1
L_cs_82:
    s_waitcnt lgkmcnt(6)
    v_mfma_f32_32x32x16_bf16 v[80:95], v[64:67], v[40:43], v[80:95]
    ds_read_b128 v[32:35], v11 offset:32768
    ds_read_b128 v[36:39], v11 offset:36864
    ds_read_b64_tr_b16 v[56:57], v28 offset:45056
    ds_read_b64_tr_b16 v[58:59], v28 offset:46080
    ds_read_b64_tr_b16 v[60:61], v29 offset:45056
    ds_read_b64_tr_b16 v[62:63], v29 offset:46080
    v_mfma_f32_32x32x16_bf16 v[96:111], v[64:67], v[44:47], v[96:111]
    v_mfma_f32_32x32x16_bf16 v[112:127], v[68:71], v[40:43], v[112:127]
    v_mfma_f32_32x32x16_bf16 v[128:143], v[68:71], v[44:47], v[128:143]
    s_cmp_eq_u32 s8, 1
    s_cbranch_scc1 L_cs_83
    v_mfma_f32_32x32x16_bf16 v[144:159], v[64:67], v[160:163], v[144:159]
    s_cmp_lg_u32 s5, 5
    s_cbranch_scc1 L_cs_84
    s_add_u32 s10, s69, 151552
    buffer_store_dwordx4 v[64:67], v6, s[52:55], s10 offen sc1
    s_branch L_cs_84
L_cs_83:
    v_mfma_f32_32x32x16_bf16 v[144:159], v[68:71], v[160:163], v[144:159]
    s_cmp_lg_u32 s5, 5
    s_cbranch_scc1 L_cs_84
    s_add_u32 s10, s69, 151552
    buffer_store_dwordx4 v[68:71], v6, s[52:55], s10 offen sc1
L_cs_84:
    s_waitcnt lgkmcnt(6)
    v_mfma_f32_32x32x16_bf16 v[80:95], v[72:75], v[48:51], v[80:95]
    v_mfma_f32_32x32x16_bf16 v[96:111], v[72:75], v[52:55], v[96:111]
    v_mfma_f32_32x32x16_bf16 v[112:127], v[76:79], v[48:51], v[112:127]
    v_mfma_f32_32x32x16_bf16 v[128:143], v[76:79], v[52:55], v[128:143]
    s_cmp_eq_u32 s8, 1
    s_cbranch_scc1 L_cs_85
    v_mfma_f32_32x32x16_bf16 v[144:159], v[72:75], v[160:163], v[144:159]
    s_cmp_lg_u32 s5, 6
    s_cbranch_scc1 L_cs_86
    s_add_u32 s10, s69, 155648
    buffer_store_dwordx4 v[72:75], v6, s[52:55], s10 offen sc1
    s_branch L_cs_86
L_cs_85:
    v_mfma_f32_32x32x16_bf16 v[144:159], v[76:79], v[160:163], v[144:159]
    s_cmp_lg_u32 s5, 6
    s_cbranch_scc1 L_cs_86
    s_add_u32 s10, s69, 155648
    buffer_store_dwordx4 v[76:79], v6, s[52:55], s10 offen sc1
L_cs_86:
    s_waitcnt lgkmcnt(0)
    v_mfma_f32_32x32x16_bf16 v[80:95], v[56:59], v[32:35], v[80:95]
    v_mfma_f32_32x32x16_bf16 v[96:111], v[56:59], v[36:39], v[96:111]
    v_mfma_f32_32x32x16_bf16 v[112:127], v[60:63], v[32:35], v[112:127]
    v_mfma_f32_32x32x16_bf16 v[128:143], v[60:63], v[36:39], v[128:143]
    s_cmp_eq_u32 s8, 1
    s_cbranch_scc1 L_cs_87
    v_mfma_f32_32x32x16_bf16 v[144:159], v[56:59], v[160:163], v[144:159]
    s_cmp_lg_u32 s5, 7
    s_cbranch_scc1 L_cs_88
    s_add_u32 s10, s69, 159744
    buffer_store_dwordx4 v[56:59], v6, s[52:55], s10 offen sc1
    s_branch L_cs_88
L_cs_87:
    v_mfma_f32_32x32x16_bf16 v[144:159], v[60:63], v[160:163], v[144:159]
    s_cmp_lg_u32 s5, 7
    s_cbranch_scc1 L_cs_88
    s_add_u32 s10, s69, 159744
    buffer_store_dwordx4 v[60:63], v6, s[52:55], s10 offen sc1
L_cs_88:
    s_nop 15
    s_mov_b32 exec_lo, 1
    s_mov_b32 exec_hi, 1
    ds_write_b128 v5, v[144:147] offset:0
    ds_write_b128 v5, v[148:151] offset:32
    ds_write_b128 v5, v[152:155] offset:64
    ds_write_b128 v5, v[156:159] offset:96
    s_mov_b64 exec, -1
    s_waitcnt lgkmcnt(0)
    s_barrier
    ds_read_b32 v32, v16 offset:0
    ds_read_b32 v36, v16 offset:128
    ds_read_b64 v[40:41], v17
    ds_read_b64 v[42:43], v17 offset:256
    s_waitcnt lgkmcnt(2)
    v_and_b32 v33, 0xffff0000, v32
    v_sub_f32 v32, v32, v33
    v_cvt_pk_bf16_f32 v57, v32, 0
    v_lshrrev_b32 v34, 16, v33
    v_or_b32 v56, v33, v34
    v_mov_b32 v58, 0
    v_mov_b32 v59, 0

    v_and_b32 v37, 0xffff0000, v36
    v_sub_f32 v36, v36, v37
    v_cvt_pk_bf16_f32 v61, v36, 0
    v_lshrrev_b32 v38, 16, v37
    v_or_b32 v60, v37, v38
    v_mov_b32 v62, 0
    v_mov_b32 v63, 0

    s_mov_b64 exec, s[66:67]
    v_mov_b32 v56, 0
    v_mov_b32 v57, 0
    v_mov_b32 v60, 0
    v_mov_b32 v61, 0
    s_mov_b64 exec, -1
    s_mov_b32 s10, 0x3acccccd
    s_waitcnt lgkmcnt(0)

    v_mul_f32 v40, s10, v40
    v_mul_f32 v41, s10, v41
    v_fma_f32 v41, -v40, v40, v41
    v_max_f32 v41, 0, v41
    v_add_f32 v41, 0x3727c5ac, v41
    v_rsq_f32 v18, v41
    v_xor_b32 v40, 0x80000000, v40
    v_and_b32 v44, 0xffff0000, v40
    v_sub_f32 v40, v40, v44
    v_lshrrev_b32 v65, 16, v44
    v_cvt_pk_bf16_f32 v45, 0, v40
    v_or_b32 v64, v65, v45
    v_mov_b32 v67, v65
    v_mov_b32 v66, v64

    v_mul_f32 v42, s10, v42
    v_mul_f32 v43, s10, v43
    v_fma_f32 v43, -v42, v42, v43
    v_max_f32 v43, 0, v43
    v_add_f32 v43, 0x3727c5ac, v43
    v_rsq_f32 v19, v43
    v_xor_b32 v42, 0x80000000, v42
    v_and_b32 v44, 0xffff0000, v42
    v_sub_f32 v42, v42, v44
    v_lshrrev_b32 v69, 16, v44
    v_cvt_pk_bf16_f32 v45, 0, v42
    v_or_b32 v68, v69, v45
    v_mov_b32 v71, v69
    v_mov_b32 v70, v68

    s_nop 1
    v_mfma_f32_32x32x16_bf16 v[80:95], v[56:59], v[64:67], v[80:95]
    v_mfma_f32_32x32x16_bf16 v[96:111], v[56:59], v[68:71], v[96:111]
    v_mfma_f32_32x32x16_bf16 v[112:127], v[60:63], v[64:67], v[112:127]
    v_mfma_f32_32x32x16_bf16 v[128:143], v[60:63], v[68:71], v[128:143]
    s_or_b32 s10, s5, s8
    s_cmp_lg_u32 s10, 0
    s_cbranch_scc1 L_g1a_noxk
    s_add_u32 s10, s70, 163840
    buffer_store_dwordx4 v[56:59], v6, s[52:55], s10 offen
    buffer_store_dwordx4 v[60:63], v6, s[52:55], s10 offen offset:1024

L_g1a_noxk:
    s_nop 7
    v_mul_f32 v8, s12, v18
    v_mul_f32 v9, s12, v18
    v_mul_f32 v10, s13, v18
    v_mul_f32 v11, s13, v18
    v_mul_f32 v12, s14, v18
    v_mul_f32 v13, s14, v18
    v_mul_f32 v14, v21, v18
    v_mul_f32 v15, v21, v18
    v_mul_f32 v28, v22, v18
    v_mul_f32 v29, v22, v18
    s_nop 4
    v_pk_mul_f32 v[80:81], v[80:81], v[8:9]
    v_pk_mul_f32 v[82:83], v[82:83], v[8:9]
    v_cvt_pk_bf16_f32 v32, v80, v81
    v_cvt_pk_bf16_f32 v33, v82, v83
    v_pk_mul_f32 v[84:85], v[84:85], v[8:9]
    v_pk_mul_f32 v[86:87], v[86:87], v[8:9]
    v_cvt_pk_bf16_f32 v34, v84, v85
    v_cvt_pk_bf16_f32 v35, v86, v87
    buffer_store_dwordx4 v[32:35], v23, s[48:51], s61 offen offset:0
    v_pk_mul_f32 v[112:113], v[112:113], v[12:13]
    v_pk_mul_f32 v[114:115], v[114:115], v[12:13]
    v_cvt_pk_bf16_f32 v36, v112, v113
    v_cvt_pk_bf16_f32 v37, v114, v115
    v_pk_mul_f32 v[116:117], v[116:117], v[12:13]
    v_pk_mul_f32 v[118:119], v[118:119], v[12:13]
    v_cvt_pk_bf16_f32 v38, v116, v117
    v_cvt_pk_bf16_f32 v39, v118, v119
    buffer_store_dwordx4 v[36:39], v23, s[48:51], s63 offen offset:0
    v_pk_mul_f32 v[88:89], v[88:89], v[14:15]
    v_pk_mul_f32 v[90:91], v[90:91], v[14:15]
    v_cvt_pk_bf16_f32 v40, v88, v89
    v_cvt_pk_bf16_f32 v41, v90, v91
    v_pk_mul_f32 v[92:93], v[92:93], v[10:11]
    v_pk_mul_f32 v[94:95], v[94:95], v[10:11]
    v_cvt_pk_bf16_f32 v42, v92, v93
    v_cvt_pk_bf16_f32 v43, v94, v95
    s_mov_b64 exec, s[66:67]
    v_mov_b32 v42, s88
    v_mov_b32 v43, s89
    s_mov_b64 exec, -1
    buffer_store_dwordx4 v[40:43], v24, s[48:51], s61 offen offset:0

    v_pk_mul_f32 v[120:121], v[120:121], v[10:11]
    v_pk_mul_f32 v[122:123], v[122:123], v[10:11]
    v_cvt_pk_bf16_f32 v44, v120, v121
    v_cvt_pk_bf16_f32 v45, v122, v123
    v_pk_mul_f32 v[124:125], v[124:125], v[28:29]
    v_pk_mul_f32 v[126:127], v[126:127], v[28:29]
    v_cvt_pk_bf16_f32 v46, v124, v125
    v_cvt_pk_bf16_f32 v47, v126, v127
    s_mov_b64 exec, s[64:65]
    v_mov_b32 v64, v46
    v_mov_b32 v65, v47
    v_mov_b32 v66, s92
    v_mov_b32 v67, s93
    v_mov_b32 v46, s90
    v_mov_b32 v47, s91
    buffer_store_dwordx4 v[64:67], v25, s[48:51], s63 offen offset:0
    s_mov_b64 exec, -1
    buffer_store_dwordx4 v[44:47], v25, s[48:51], s62 offen offset:0

    v_mul_f32 v8, s12, v19
    v_mul_f32 v9, s12, v19
    v_mul_f32 v10, s13, v19
    v_mul_f32 v11, s13, v19
    v_mul_f32 v12, s14, v19
    v_mul_f32 v13, s14, v19
    v_mul_f32 v14, v21, v19
    v_mul_f32 v15, v21, v19
    v_mul_f32 v28, v22, v19
    v_mul_f32 v29, v22, v19
    v_pk_mul_f32 v[96:97], v[96:97], v[8:9]
    v_pk_mul_f32 v[98:99], v[98:99], v[8:9]
    v_cvt_pk_bf16_f32 v48, v96, v97
    v_cvt_pk_bf16_f32 v49, v98, v99
    v_pk_mul_f32 v[100:101], v[100:101], v[8:9]
    v_pk_mul_f32 v[102:103], v[102:103], v[8:9]
    v_cvt_pk_bf16_f32 v50, v100, v101
    v_cvt_pk_bf16_f32 v51, v102, v103
    buffer_store_dwordx4 v[48:51], v23, s[48:51], s61 offen offset:1536
    v_pk_mul_f32 v[128:129], v[128:129], v[12:13]
    v_pk_mul_f32 v[130:131], v[130:131], v[12:13]
    v_cvt_pk_bf16_f32 v52, v128, v129
    v_cvt_pk_bf16_f32 v53, v130, v131
    v_pk_mul_f32 v[132:133], v[132:133], v[12:13]
    v_pk_mul_f32 v[134:135], v[134:135], v[12:13]
    v_cvt_pk_bf16_f32 v54, v132, v133
    v_cvt_pk_bf16_f32 v55, v134, v135
    buffer_store_dwordx4 v[52:55], v23, s[48:51], s63 offen offset:1536
    v_pk_mul_f32 v[104:105], v[104:105], v[14:15]
    v_pk_mul_f32 v[106:107], v[106:107], v[14:15]
    v_cvt_pk_bf16_f32 v56, v104, v105
    v_cvt_pk_bf16_f32 v57, v106, v107
    v_pk_mul_f32 v[108:109], v[108:109], v[10:11]
    v_pk_mul_f32 v[110:111], v[110:111], v[10:11]
    v_cvt_pk_bf16_f32 v58, v108, v109
    v_cvt_pk_bf16_f32 v59, v110, v111
    s_mov_b64 exec, s[66:67]
    v_mov_b32 v58, s88
    v_mov_b32 v59, s89
    s_mov_b64 exec, -1
    buffer_store_dwordx4 v[56:59], v24, s[48:51], s61 offen offset:1536

    v_pk_mul_f32 v[136:137], v[136:137], v[10:11]
    v_pk_mul_f32 v[138:139], v[138:139], v[10:11]
    v_cvt_pk_bf16_f32 v60, v136, v137
    v_cvt_pk_bf16_f32 v61, v138, v139
    v_pk_mul_f32 v[140:141], v[140:141], v[28:29]
    v_pk_mul_f32 v[142:143], v[142:143], v[28:29]
    v_cvt_pk_bf16_f32 v62, v140, v141
    v_cvt_pk_bf16_f32 v63, v142, v143
    s_mov_b64 exec, s[64:65]
    v_mov_b32 v68, v62
    v_mov_b32 v69, v63
    v_mov_b32 v70, s92
    v_mov_b32 v71, s93
    v_mov_b32 v62, s90
    v_mov_b32 v63, s91
    buffer_store_dwordx4 v[68:71], v25, s[48:51], s63 offen offset:1536
    s_mov_b64 exec, -1
    buffer_store_dwordx4 v[60:63], v25, s[48:51], s62 offen offset:1536

    s_endpgm
.globl atta_kernel
.p2align 8
.type atta_kernel,@function
atta_kernel:
    s_mov_b32 s62, 1
    s_mov_b32 s96, 0
    s_branch L_att_entry
.globl attb_kernel
.p2align 8
.type attb_kernel,@function
attb_kernel:
    s_mov_b32 s62, 0
    s_movk_i32 s96, 12288
L_att_entry:
    s_cmp_ge_u32 s2, 256
    s_cbranch_scc1 L_att_exit
    s_load_dwordx16 s[16:31], s[0:1], 0
    s_load_dwordx4 s[32:35], s[0:1], 64
    s_and_b32 s3, s2, 7
    s_lshl_b32 s5, s3, 2
    s_bfe_u32 s4, s2, 0x20003
    s_add_u32 s5, s5, s4
    s_lshr_b32 s6, s2, 5
    v_lshrrev_b32 v1, 6, v0
    v_and_b32 v2, 63, v0
    v_and_b32 v3, 31, v0
    v_readfirstlane_b32 s7, v1
    v_lshrrev_b32 v4, 5, v2
    v_lshlrev_b32 v14, 2, v4
    v_xor_b32 v14, v14, v3
    v_lshlrev_b32 v14, 4, v14
    v_lshl_add_u32 v6, v4, 9, v14
    v_xor_b32 v14, 8, v3
    v_lshlrev_b32 v14, 4, v14
    v_lshl_add_u32 v14, v4, 3, v14
    v_add_u32 v7, 1024, v14
    v_bfe_u32 v15, v2, 4, 1
    v_and_b32 v100, 3, v2
    v_lshlrev_b32 v101, 1, v15
    v_sub_u32 v101, 3, v101
    v_min_u32 v100, v100, v101
    v_lshl_add_u32 v100, v15, 2, v100
    v_lshrrev_b32 v101, 1, v100
    v_and_b32 v100, 1, v100
    v_bfe_u32 v14, v2, 2, 2
    v_lshl_add_u32 v14, v4, 2, v14
    v_lshlrev_b32 v102, 2, v101
    v_xor_b32 v14, v14, v102
    v_lshlrev_b32 v14, 4, v14
    v_lshl_add_u32 v14, v101, 9, v14
    v_lshl_add_u32 v14, v100, 3, v14
    v_add_u32 v8, 12288, v14
    v_xor_b32 v9, 128, v8
    s_and_b32 s8, s7, 7
    s_lshr_b32 s9, s7, 3
    s_mul_i32 s59, s9, 24576
    s_bfe_u32 s10, s7, 0x10002
    s_lshl_b32 s10, s10, 5
    s_add_u32 s10, s10, 32
    s_add_u32 s10, s10, s5
    s_mul_i32 s10, s10, 98304
    s_mul_i32 s11, s9, 49152
    s_add_u32 s10, s10, s11
    s_and_b32 s11, s7, 3
    s_mul_i32 s11, s11, 3072
    s_add_u32 s10, s10, s11
    v_lshl_add_u32 v5, v2, 4, s10
    s_mul_i32 s53, s7, 3072
    s_lshl_b32 s10, s6, 3
    s_add_u32 s10, s10, s8
    s_lshl_b32 s54, s10, 5
    s_mul_i32 s10, s10, 1536
    s_mul_i32 s11, s5, 98304
    s_add_u32 s55, s10, s11
    s_mov_b32 s64, -1
    s_mov_b32 s65, 0
    s_mov_b32 s66, 0
    s_mov_b32 s67, -1
    s_mov_b32 s56, 0
    v_mov_b32 v100, 0
    v_mov_b32 v101, 147456
    ds_write_b32 v101, v100
    s_waitcnt lgkmcnt(0)

    s_add_u32 s40, s34, 6291456
    s_addc_u32 s41, s35, 0
    s_mov_b32 s42, 9437184
    s_mov_b32 s43, 0x00020000
    s_add_u32 s48, s34, 16777216
    s_addc_u32 s49, s35, 0
    s_mov_b32 s50, 2621440
    s_mov_b32 s51, 0x00020000
    s_add_u32 s44, s34, 44564480
    s_addc_u32 s45, s35, 0
    s_mov_b32 s46, 46080
    s_mov_b32 s47, 0x00020000
    s_cmp_ge_u32 s2, 0
    s_cbranch_scc1 L_att_nofl
    s_cmp_lg_u32 s7, 15
    s_cbranch_scc1 L_att_nofl
    s_lshl_b32 s10, s2, 8
    s_add_u32 s10, s10, s96
    v_lshlrev_b32 v14, 2, v2
    buffer_store_dword v100, v14, s[44:47], s10 offen

L_att_nofl:
    buffer_load_dwordx4 v[16:19], v6, s[40:43], s55 offen
    buffer_load_dwordx2 v[20:21], v7, s[40:43], s55 offen

L_att_restart:
    s_bitcmp1_b32 s7, 1
    s_cbranch_scc1 L_att_late
    s_mov_b32 s57, 0
    s_add_u32 m0, s53, 0
    s_nop 0
    buffer_load_dwordx4 v5, s[40:43], s57 offen offset:0 lds
    buffer_load_dwordx4 v5, s[40:43], s57 offen offset:1024 lds
    buffer_load_dwordx4 v5, s[40:43], s57 offen offset:2048 lds
L_att_late:
    s_mov_b32 s63, 0
    s_cmp_eq_u32 s62, 0
    s_cbranch_scc1 L_attp_done
    s_mov_b32 s62, 0
    s_cmp_ge_u32 s7, 8
    s_cbranch_scc1 L_attp_done
    s_cmp_eq_u32 s7, 5
    s_cbranch_scc1 L_attp_done
    s_cmp_ge_u32 s2, 192
    s_cbranch_scc1 L_attp_hi
    s_add_u32 s92, s2, 120
    s_mov_b32 s93, s7
    s_cmp_lt_u32 s7, 5
    s_cbranch_scc1 L_attp_go
    s_lshl_b32 s95, s2, 1
    s_add_u32 s95, s95, s7
    s_sub_u32 s95, s95, 6
    s_branch L_attp_beta

L_attp_hi:
    s_cmp_ge_u32 s7, 5
    s_cbranch_scc1 L_attp_done
    s_sub_u32 s95, s2, 192
    s_mul_i32 s95, s95, 5
    s_add_u32 s95, s95, s7
    s_add_u32 s95, s95, 384

L_attp_beta:
    s_cmp_ge_u32 s95, 680
    s_cbranch_scc1 L_attp_done
    s_cmp_ge_u32 s95, 200
    s_cbranch_scc1 L_attp_bwd

    s_mul_i32 s92, s95, 209716
    s_lshr_b32 s92, s92, 20
    s_mul_i32 s94, s92, 5
    s_sub_u32 s93, s95, s94
    s_add_u32 s92, s92, 312
    s_branch L_attp_go

L_attp_bwd:
    s_sub_u32 s95, s95, 200
    s_mul_i32 s92, s95, 174763
    s_lshr_b32 s92, s92, 20
    s_mul_i32 s94, s92, 6
    s_sub_u32 s93, s95, s94
    s_add_u32 s92, s92, 352
L_attp_go:
    s_mov_b32 s62, 1
    v_and_b32 v74, 15, v2
    v_lshrrev_b32 v73, 4, v2
    s_cmp_ge_u32 s92, 352
    s_cbranch_scc1 L_attp_wd
    s_cmp_ge_u32 s92, 312
    s_cbranch_scc1 L_attp_wo
    s_mov_b32 s62, 2
    s_cmp_eq_u32 s93, 0
    s_cselect_b32 s63, 1, 0

L_attp_wgu:
    s_cmp_ge_u32 s92, 216
    s_cselect_b32 s36, s26, s24
    s_cselect_b32 s37, s27, s25
    s_cselect_b32 s14, 256, 0
    s_movk_i32 s94, 120
    s_cselect_b32 s94, 216, s94
    s_sub_u32 s13, s92, s94
    s_mov_b32 s38, 1966080
    s_mov_b32 s39, 0x00020000

    s_add_u32 s68, s34, 36700160
    s_addc_u32 s69, s35, 0
    s_mov_b32 s70, 4030464
    s_mov_b32 s71, 0x00020000
    s_mul_i32 s90, s13, 43691
    s_lshr_b32 s90, s90, 20
    s_mul_i32 s94, s90, 24
    s_sub_u32 s12, s13, s94
    s_lshl_b32 s94, s12, 4
    v_add_u32 v68, s94, v74
    v_lshrrev_b32 v69, 2, v68
    v_mul_u32_u24 v70, 43691, v69
    v_lshrrev_b32 v70, 18, v70
    v_mul_u32_u24 v71, 6, v70
    v_sub_u32 v71, v69, v71
    v_mul_u32_u24 v70, 251904, v70
    v_lshl_add_u32 v70, v71, 10, v70
    v_and_b32 v71, 1, v68
    v_lshl_add_u32 v70, v71, 7, v70
    v_bfe_u32 v71, v68, 1, 1
    v_lshl_add_u32 v70, v71, 6, v70
    v_add_u32 v23, s14, v70
    s_movk_i32 s88, 3072
    s_movk_i32 s95, 6144

L_attp_c13:
    s_lshl_b32 s89, s88, 2
    s_mul_i32 s91, s95, 40
    v_lshrrev_b32 v69, 1, v73
    v_mul_lo_u32 v69, v69, s95
    v_add_u32 v22, v69, v23
    v_and_b32 v69, 1, v73
    v_lshl_add_u32 v22, v69, 9, v22
    s_mul_i32 s94, s90, 5
    s_add_u32 s94, s94, s93
    s_mul_i32 s13, s94, s95
    s_lshl_b32 s13, s13, 1
    v_add_u32 v22, s13, v22
    s_lshl_b32 s13, s88, 3
    v_mul_lo_u32 v69, v73, s13
    v_lshl_add_u32 v69, v68, 3, v69
    s_mul_i32 s13, s94, s88
    s_lshl_b32 s13, s13, 5
    v_add_u32 v0, s13, v69
    s_branch L_attp_done

L_attp_wo:
    s_mov_b32 s36, s20
    s_mov_b32 s37, s21
    s_mov_b32 s38, 819200
    s_mov_b32 s39, 0x00020000
    s_add_u32 s68, s34, 40894464
    s_addc_u32 s69, s35, 0
    s_mov_b32 s70, 819200
    s_mov_b32 s71, 0x00020000
    s_sub_u32 s13, s92, 312
    s_mul_i32 s90, s13, 104858
    s_lshr_b32 s90, s90, 20
    s_mul_i32 s94, s90, 10
    s_sub_u32 s12, s13, s94
    s_lshl_b32 s94, s12, 4
    v_add_u32 v68, s94, v74
    v_lshrrev_b32 v69, 2, v68
    v_mul_u32_u24 v70, 52429, v69
    v_lshrrev_b32 v70, 18, v70
    v_mul_u32_u24 v71, 5, v70
    v_sub_u32 v71, v69, v71
    v_mul_u32_u24 v70, 102400, v70
    v_lshl_add_u32 v70, v71, 10, v70
    v_and_b32 v71, 3, v68
    v_lshl_add_u32 v70, v71, 6, v70
    v_lshl_add_u32 v22, v73, 8, v70
    s_movk_i32 s88, 1280

    s_cmp_eq_u32 s93, 4
    s_cbranch_scc1 L_attp_wot
    s_movk_i32 s89, 10240
    v_lshrrev_b32 v69, 1, v73
    v_mul_u32_u24 v69, 25600, v69
    v_and_b32 v70, 1, v73
    v_mul_u32_u24 v70, 5120, v70
    v_add_u32 v69, v69, v70
    v_lshl_add_u32 v69, v68, 3, v69
    s_lshl_b32 s94, s90, 2
    s_add_u32 s94, s94, s93
    s_mul_i32 s13, s94, 51200
    v_add_u32 v0, s13, v69
    s_mul_i32 s13, s94, 5120
    v_add_u32 v22, s13, v22
    s_branch L_attp_done

L_attp_wot:
    s_movk_i32 s89, 25600
    v_mul_u32_u24 v69, 51200, v73
    v_lshl_add_u32 v69, v68, 3, v69
    s_mul_i32 s13, s90, 204800
    s_add_u32 s13, s13, 20480
    v_add_u32 v0, s13, v69
    s_add_u32 s13, s90, 16
    s_mul_i32 s13, s13, 5120
    v_add_u32 v22, s13, v22
    s_branch L_attp_done

L_attp_wd:
    s_mov_b32 s36, s28
    s_mov_b32 s37, s29
    s_mov_b32 s38, 1966080
    s_mov_b32 s39, 0x00020000
    s_add_u32 s68, s34, 41943040
    s_addc_u32 s69, s35, 0
    s_mov_b32 s70, 1966080
    s_mov_b32 s71, 0x00020000
    s_sub_u32 s13, s92, 352
    s_mul_i32 s90, s13, 104858
    s_lshr_b32 s90, s90, 20
    s_mul_i32 s94, s90, 10
    s_sub_u32 s12, s13, s94
    s_lshl_b32 s94, s12, 4
    v_add_u32 v68, s94, v74
    v_lshrrev_b32 v69, 2, v68
    v_mul_u32_u24 v70, 52429, v69
    v_lshrrev_b32 v70, 18, v70
    v_mul_u32_u24 v71, 5, v70
    v_sub_u32 v71, v69, v71
    v_mul_u32_u24 v70, 245760, v70
    v_lshl_add_u32 v70, v71, 10, v70
    v_and_b32 v71, 3, v68
    v_lshl_add_u32 v70, v71, 6, v70
    v_lshl_add_u32 v22, v73, 8, v70
    s_movk_i32 s88, 1280

    s_movk_i32 s89, 5120
    v_mul_u32_u24 v69, 10240, v73
    v_lshl_add_u32 v69, v68, 3, v69
    s_mul_i32 s94, s90, 6
    s_add_u32 s94, s94, s93
    s_mul_i32 s13, s94, 40960
    v_add_u32 v0, s13, v69
    s_mul_i32 s13, s94, 5120
    v_add_u32 v22, s13, v22

L_attp_done:
    v_mov_b32 v52, 0
    v_mov_b32 v53, 0
    v_mov_b32 v54, 0
    v_mov_b32 v55, 0
    v_mov_b32 v56, 0
    v_mov_b32 v57, 0
    v_mov_b32 v58, 0
    v_mov_b32 v59, 0
    v_mov_b32 v60, 0
    v_mov_b32 v61, 0
    v_mov_b32 v62, 0
    v_mov_b32 v63, 0
    v_mov_b32 v64, 0
    v_mov_b32 v65, 0
    v_mov_b32 v66, 0
    v_mov_b32 v67, 0
    v_mov_b32 v48, 0
    v_mov_b32 v40, 0
    v_mov_b32 v49, 0
    v_mov_b32 v41, 0
    v_mov_b32 v50, 0
    v_mov_b32 v42, 0
    v_mov_b32 v51, 0
    v_mov_b32 v43, 0
    v_mov_b32 v98, 0
    v_mov_b32 v99, 0
    v_add_u32 v10, s59, v6
    v_add_u32 v11, s59, v7
    s_mov_b32 s52, 0
    s_mov_b32 s58, s59
    s_mov_b32 s60, 12288
    s_add_u32 s61, s53, 49152
    s_waitcnt vmcnt(0)

    s_barrier
    s_bitcmp0_b32 s7, 1
    s_cbranch_scc1 L_att_early

    s_mov_b32 s57, 0
    s_add_u32 m0, s53, 0
    s_nop 0
    buffer_load_dwordx4 v5, s[40:43], s57 offen offset:0 lds
    buffer_load_dwordx4 v5, s[40:43], s57 offen offset:1024 lds
    buffer_load_dwordx4 v5, s[40:43], s57 offen offset:2048 lds
L_att_early:
    s_cmp_lg_u32 s56, 0
    s_cbranch_scc1 L_att_have_m
    ds_read_b128 v[24:27], v6
    ds_read_b64 v[32:33], v7
    s_mov_b64 exec, s[66:67]
    v_mov_b32 v20, 0
    v_mov_b32 v21, 0
    s_mov_b64 exec, -1
    s_waitcnt lgkmcnt(0)
    s_nop 1
    v_mfma_f32_32x32x16_bf16 v[68:83], v[24:27], v[16:19], 0
    v_mfma_f32_32x32x8_bf16 v[68:83], v[32:33], v[20:21], v[68:83]
    s_nop 15
    v_max3_f32 v100, v68, v69, v70

    v_max3_f32 v100, v100, v71, v72
    v_max3_f32 v100, v100, v73, v74
    v_max3_f32 v100, v100, v75, v76
    v_max3_f32 v100, v100, v77, v78
    v_max3_f32 v100, v100, v79, v80
    v_max3_f32 v100, v100, v81, v82
    v_max_f32 v100, v100, v83
L_att_set_m:
    v_mov_b32 v101, v100
    s_nop 1
    v_permlane32_swap_b32 v100, v101
    s_nop 1
    v_max_f32 v100, v100, v101
    v_xor_b32 v100, 0x80000000, v100
    v_and_b32 v101, 0xffff0000, v100
    v_sub_f32 v100, v100, v101
    v_and_b32 v102, 0xffff0000, v100
    v_sub_f32 v100, v100, v102
    v_lshrrev_b32 v101, 16, v101
    s_mov_b64 exec, s[66:67]
    v_or_b32 v20, v101, v102
    v_lshrrev_b32 v21, 16, v100
    s_mov_b64 exec, -1
    s_cmp_lg_u32 s56, 0
    s_cbranch_scc1 L_att_restart

L_att_have_m:
    ds_read_b128 v[24:27], v10
    ds_read_b64 v[32:33], v11
    ds_read_b128 v[28:31], v10 offset:1536
    ds_read_b64 v[34:35], v11 offset:1536
    s_waitcnt lgkmcnt(2)
    v_mfma_f32_32x32x16_bf16 v[68:83], v[24:27], v[16:19], 0
    v_mfma_f32_32x32x8_bf16 v[68:83], v[32:33], v[20:21], v[68:83]
    s_nop 15

.p2align 6
L_att_loop:
    s_setprio 2
    v_exp_f32 v68, v68
    v_cvt_pk_bf16_f32 v51, v98, v99
    v_add_u32 v12, s58, v8
    v_add_u32 v13, s58, v9
    v_exp_f32 v69, v69
    s_waitcnt lgkmcnt(2)
    v_mfma_f32_32x32x16_bf16 v[52:67], v[40:43], v[48:51], v[52:67]
    s_cmp_eq_u32 s52, 3
    s_cbranch_scc1 L_nodma_89
    s_mov_b32 m0, s61
    s_nop 0
    buffer_load_dwordx4 v5, s[40:43], s60 offen offset:0 lds

L_nodma_89:
    ds_read_b64_tr_b16 v[36:37], v12 offset:0
    ds_read_b64_tr_b16 v[38:39], v13 offset:0
    ds_read_b64_tr_b16 v[40:41], v12 offset:256
    ds_read_b64_tr_b16 v[42:43], v13 offset:256
    ds_read_b128 v[24:27], v10 offset:3072
    ds_read_b64 v[32:33], v11 offset:3072
    v_exp_f32 v70, v70
    v_cvt_pk_bf16_f32 v44, v68, v69
    v_exp_f32 v71, v71
    v_exp_f32 v72, v72
    v_cvt_pk_bf16_f32 v45, v70, v71
    s_waitcnt lgkmcnt(6)
    v_mfma_f32_32x32x16_bf16 v[84:99], v[28:31], v[16:19], 0
    v_exp_f32 v73, v73
    v_exp_f32 v74, v74
    v_cvt_pk_bf16_f32 v46, v72, v73
    v_exp_f32 v75, v75
    v_exp_f32 v76, v76
    v_cvt_pk_bf16_f32 v47, v74, v75
    v_mfma_f32_32x32x8_bf16 v[84:99], v[34:35], v[20:21], v[84:99]
    v_exp_f32 v77, v77
    v_exp_f32 v78, v78
    v_cvt_pk_bf16_f32 v48, v76, v77
    v_exp_f32 v79, v79
    s_waitcnt lgkmcnt(4)
    v_mfma_f32_32x32x16_bf16 v[52:67], v[36:39], v[44:47], v[52:67]
    v_exp_f32 v80, v80
    v_cvt_pk_bf16_f32 v49, v78, v79
    v_exp_f32 v81, v81
    v_exp_f32 v82, v82
    v_cvt_pk_bf16_f32 v50, v80, v81
    v_exp_f32 v83, v83
    v_exp_f32 v84, v84
    v_cvt_pk_bf16_f32 v51, v82, v83
    v_exp_f32 v85, v85
    s_waitcnt lgkmcnt(2)
    v_mfma_f32_32x32x16_bf16 v[52:67], v[40:43], v[48:51], v[52:67]
    s_cmp_eq_u32 s52, 3
    s_cbranch_scc1 L_nodma_90
    s_mov_b32 m0, s61
    s_nop 0
    buffer_load_dwordx4 v5, s[40:43], s60 offen offset:1024 lds

L_nodma_90:
    ds_read_b64_tr_b16 v[36:37], v12 offset:1536
    ds_read_b64_tr_b16 v[38:39], v13 offset:1536
    ds_read_b64_tr_b16 v[40:41], v12 offset:1792
    ds_read_b64_tr_b16 v[42:43], v13 offset:1792
    ds_read_b128 v[28:31], v10 offset:4608
    ds_read_b64 v[34:35], v11 offset:4608
    v_exp_f32 v86, v86
    v_cvt_pk_bf16_f32 v44, v84, v85
    v_exp_f32 v87, v87
    v_exp_f32 v88, v88
    v_cvt_pk_bf16_f32 v45, v86, v87
    s_waitcnt lgkmcnt(6)
    v_mfma_f32_32x32x16_bf16 v[68:83], v[24:27], v[16:19], 0
    v_exp_f32 v89, v89
    v_exp_f32 v90, v90
    v_cvt_pk_bf16_f32 v46, v88, v89
    v_exp_f32 v91, v91
    v_exp_f32 v92, v92
    v_cvt_pk_bf16_f32 v47, v90, v91
    v_mfma_f32_32x32x8_bf16 v[68:83], v[32:33], v[20:21], v[68:83]
    v_exp_f32 v93, v93
    v_exp_f32 v94, v94
    v_cvt_pk_bf16_f32 v48, v92, v93
    v_exp_f32 v95, v95
    s_waitcnt lgkmcnt(4)
    v_mfma_f32_32x32x16_bf16 v[52:67], v[36:39], v[44:47], v[52:67]
    v_exp_f32 v96, v96
    v_cvt_pk_bf16_f32 v49, v94, v95
    v_exp_f32 v97, v97
    v_exp_f32 v98, v98
    v_cvt_pk_bf16_f32 v50, v96, v97
    v_exp_f32 v99, v99
    s_setprio 1
    v_exp_f32 v68, v68
    v_cvt_pk_bf16_f32 v51, v98, v99
    v_exp_f32 v69, v69
    s_waitcnt lgkmcnt(2)
    v_mfma_f32_32x32x16_bf16 v[52:67], v[40:43], v[48:51], v[52:67]
    s_cmp_lg_u32 s52, 0
    s_cbranch_scc1 L_nobar_91
    s_waitcnt vmcnt(2)
    s_barrier

L_nobar_91:
    s_cmp_eq_u32 s52, 3
    s_cbranch_scc1 L_nodma_92
    s_mov_b32 m0, s61
    s_nop 0
    buffer_load_dwordx4 v5, s[40:43], s60 offen offset:2048 lds

L_nodma_92:
    ds_read_b64_tr_b16 v[36:37], v12 offset:3072
    ds_read_b64_tr_b16 v[38:39], v13 offset:3072
    ds_read_b64_tr_b16 v[40:41], v12 offset:3328
    ds_read_b64_tr_b16 v[42:43], v13 offset:3328
    ds_read_b128 v[24:27], v10 offset:6144
    ds_read_b64 v[32:33], v11 offset:6144
    v_exp_f32 v70, v70
    v_cvt_pk_bf16_f32 v44, v68, v69
    v_exp_f32 v71, v71
    v_exp_f32 v72, v72
    v_cvt_pk_bf16_f32 v45, v70, v71
    s_waitcnt lgkmcnt(6)
    v_mfma_f32_32x32x16_bf16 v[84:99], v[28:31], v[16:19], 0
    v_exp_f32 v73, v73
    v_exp_f32 v74, v74
    v_cvt_pk_bf16_f32 v46, v72, v73
    v_exp_f32 v75, v75
    v_exp_f32 v76, v76
    v_cvt_pk_bf16_f32 v47, v74, v75
    v_mfma_f32_32x32x8_bf16 v[84:99], v[34:35], v[20:21], v[84:99]
    v_exp_f32 v77, v77
    v_exp_f32 v78, v78
    v_cvt_pk_bf16_f32 v48, v76, v77
    v_exp_f32 v79, v79
    s_waitcnt lgkmcnt(4)
    v_mfma_f32_32x32x16_bf16 v[52:67], v[36:39], v[44:47], v[52:67]
    v_exp_f32 v80, v80
    v_cvt_pk_bf16_f32 v49, v78, v79
    v_exp_f32 v81, v81
    v_exp_f32 v82, v82
    v_cvt_pk_bf16_f32 v50, v80, v81
    v_exp_f32 v83, v83
    v_exp_f32 v84, v84
    v_cvt_pk_bf16_f32 v51, v82, v83
    v_exp_f32 v85, v85
    s_waitcnt lgkmcnt(2)
    v_mfma_f32_32x32x16_bf16 v[52:67], v[40:43], v[48:51], v[52:67]
    s_cmp_lg_u32 s52, 0
    s_cbranch_scc1 L_nold_93
    s_cmp_eq_u32 s62, 0
    s_cbranch_scc1 L_attp_nold
    s_mov_b32 s12, 0

    buffer_load_dwordx2 v[108:109], v0, s[36:39], s12 offen
    s_add_u32 s12, s12, s88
    buffer_load_dwordx2 v[110:111], v0, s[36:39], s12 offen
    s_add_u32 s12, s12, s88
    buffer_load_dwordx2 v[112:113], v0, s[36:39], s12 offen
    s_add_u32 s12, s12, s88
    buffer_load_dwordx2 v[114:115], v0, s[36:39], s12 offen
    s_mov_b32 s12, s89
    buffer_load_dwordx2 v[116:117], v0, s[36:39], s12 offen
    s_add_u32 s12, s12, s88
    buffer_load_dwordx2 v[118:119], v0, s[36:39], s12 offen
    s_add_u32 s12, s12, s88
    buffer_load_dwordx2 v[120:121], v0, s[36:39], s12 offen
    s_add_u32 s12, s12, s88
    buffer_load_dwordx2 v[122:123], v0, s[36:39], s12 offen
L_attp_nold:
L_nold_93:
    ds_read_b64_tr_b16 v[36:37], v12 offset:4608
    ds_read_b64_tr_b16 v[38:39], v13 offset:4608
    ds_read_b64_tr_b16 v[40:41], v12 offset:4864
    ds_read_b64_tr_b16 v[42:43], v13 offset:4864
    ds_read_b128 v[28:31], v10 offset:7680
    ds_read_b64 v[34:35], v11 offset:7680
    v_exp_f32 v86, v86
    v_cvt_pk_bf16_f32 v44, v84, v85
    v_exp_f32 v87, v87
    v_exp_f32 v88, v88
    v_cvt_pk_bf16_f32 v45, v86, v87
    s_waitcnt lgkmcnt(6)
    v_mfma_f32_32x32x16_bf16 v[68:83], v[24:27], v[16:19], 0
    v_exp_f32 v89, v89
    v_exp_f32 v90, v90
    v_cvt_pk_bf16_f32 v46, v88, v89
    v_exp_f32 v91, v91
    v_exp_f32 v92, v92
    v_cvt_pk_bf16_f32 v47, v90, v91
    v_mfma_f32_32x32x8_bf16 v[68:83], v[32:33], v[20:21], v[68:83]
    v_exp_f32 v93, v93
    v_exp_f32 v94, v94
    v_cvt_pk_bf16_f32 v48, v92, v93
    v_exp_f32 v95, v95
    s_waitcnt lgkmcnt(4)
    v_mfma_f32_32x32x16_bf16 v[52:67], v[36:39], v[44:47], v[52:67]
    v_exp_f32 v96, v96
    v_cvt_pk_bf16_f32 v49, v94, v95
    v_exp_f32 v97, v97
    v_exp_f32 v98, v98
    v_cvt_pk_bf16_f32 v50, v96, v97
    v_exp_f32 v99, v99
    s_setprio 0
    v_exp_f32 v68, v68
    v_cvt_pk_bf16_f32 v51, v98, v99
    v_exp_f32 v69, v69
    s_waitcnt lgkmcnt(2)
    v_mfma_f32_32x32x16_bf16 v[52:67], v[40:43], v[48:51], v[52:67]
    ds_read_b64_tr_b16 v[36:37], v12 offset:6144
    ds_read_b64_tr_b16 v[38:39], v13 offset:6144
    ds_read_b64_tr_b16 v[40:41], v12 offset:6400
    ds_read_b64_tr_b16 v[42:43], v13 offset:6400
    ds_read_b128 v[24:27], v10 offset:9216
    ds_read_b64 v[32:33], v11 offset:9216
    v_exp_f32 v70, v70
    v_cvt_pk_bf16_f32 v44, v68, v69
    v_exp_f32 v71, v71
    v_exp_f32 v72, v72
    v_cvt_pk_bf16_f32 v45, v70, v71
    s_waitcnt lgkmcnt(6)
    v_mfma_f32_32x32x16_bf16 v[84:99], v[28:31], v[16:19], 0
    v_exp_f32 v73, v73
    v_exp_f32 v74, v74
    v_cvt_pk_bf16_f32 v46, v72, v73
    v_exp_f32 v75, v75
    v_exp_f32 v76, v76
    v_cvt_pk_bf16_f32 v47, v74, v75
    v_mfma_f32_32x32x8_bf16 v[84:99], v[34:35], v[20:21], v[84:99]
    v_exp_f32 v77, v77
    v_exp_f32 v78, v78
    v_cvt_pk_bf16_f32 v48, v76, v77
    v_exp_f32 v79, v79
    s_waitcnt lgkmcnt(4)
    v_mfma_f32_32x32x16_bf16 v[52:67], v[36:39], v[44:47], v[52:67]
    v_exp_f32 v80, v80
    v_cvt_pk_bf16_f32 v49, v78, v79
    v_exp_f32 v81, v81
    v_exp_f32 v82, v82
    v_cvt_pk_bf16_f32 v50, v80, v81
    v_exp_f32 v83, v83
    v_exp_f32 v84, v84
    v_cvt_pk_bf16_f32 v51, v82, v83
    v_exp_f32 v85, v85
    s_waitcnt lgkmcnt(2)
    v_mfma_f32_32x32x16_bf16 v[52:67], v[40:43], v[48:51], v[52:67]
    ds_read_b64_tr_b16 v[36:37], v12 offset:7680
    ds_read_b64_tr_b16 v[38:39], v13 offset:7680
    ds_read_b64_tr_b16 v[40:41], v12 offset:7936
    ds_read_b64_tr_b16 v[42:43], v13 offset:7936
    ds_read_b128 v[28:31], v10 offset:10752
    ds_read_b64 v[34:35], v11 offset:10752
    v_exp_f32 v86, v86
    v_cvt_pk_bf16_f32 v44, v84, v85
    v_exp_f32 v87, v87
    v_exp_f32 v88, v88
    v_cvt_pk_bf16_f32 v45, v86, v87
    s_waitcnt lgkmcnt(6)
    v_mfma_f32_32x32x16_bf16 v[68:83], v[24:27], v[16:19], 0
    v_exp_f32 v89, v89
    v_exp_f32 v90, v90
    v_cvt_pk_bf16_f32 v46, v88, v89
    v_exp_f32 v91, v91
    v_exp_f32 v92, v92
    v_cvt_pk_bf16_f32 v47, v90, v91
    v_mfma_f32_32x32x8_bf16 v[68:83], v[32:33], v[20:21], v[68:83]
    v_exp_f32 v93, v93
    v_exp_f32 v94, v94
    v_cvt_pk_bf16_f32 v48, v92, v93
    v_exp_f32 v95, v95
    s_waitcnt lgkmcnt(4)
    v_mfma_f32_32x32x16_bf16 v[52:67], v[36:39], v[44:47], v[52:67]
    v_exp_f32 v96, v96
    v_cvt_pk_bf16_f32 v49, v94, v95
    v_exp_f32 v97, v97
    v_exp_f32 v98, v98
    v_cvt_pk_bf16_f32 v50, v96, v97
    v_exp_f32 v99, v99
    v_exp_f32 v68, v68
    v_cvt_pk_bf16_f32 v51, v98, v99
    v_exp_f32 v69, v69
    s_waitcnt lgkmcnt(2)
    v_mfma_f32_32x32x16_bf16 v[52:67], v[40:43], v[48:51], v[52:67]
    s_add_u32 s58, s58, 49152
    s_cmp_ge_u32 s58, 147456
    s_cselect_b32 s58, s59, s58
    v_add_u32 v10, s58, v6
    v_add_u32 v11, s58, v7
    s_cmp_eq_u32 s52, 0
    s_cselect_b32 s12, s62, 0
    s_cmp_eq_u32 s52, 3
    s_cselect_b32 s12, 1, s12
    s_cmp_lg_u32 s12, 0
    s_waitcnt vmcnt(8)
    s_cbranch_scc1 L_nodma_94
    s_waitcnt vmcnt(0)

L_nodma_94:
    s_barrier
    s_add_u32 s60, s60, 12288
    s_add_u32 s61, s61, 49152
    s_cmp_ge_u32 s61, 147456
    s_cselect_b32 s61, s53, s61

    s_cmp_lg_u32 s52, 2
    s_cbranch_scc1 L_nos2_95
    s_cmp_eq_u32 s63, 0
    s_cbranch_scc1 L_attp_s2done
    s_mov_b32 s63, 0
    s_lshl_b32 s12, s7, 8
    s_add_u32 s12, s12, 147520
    v_and_b32 v1, 15, v2
    v_lshl_add_u32 v1, v1, 4, s12

    ds_read_b128 v[108:111], v1 offset:256
    ds_read_b128 v[112:115], v1 offset:512
    ds_read_b128 v[116:119], v1 offset:768
    ds_read_b128 v[120:123], v1 offset:1024
    s_waitcnt lgkmcnt(0)
    v_add_f32 v104, v104, v108
    v_add_f32 v105, v105, v109
    v_add_f32 v106, v106, v110
    v_add_f32 v107, v107, v111
    v_add_f32 v104, v104, v112
    v_add_f32 v105, v105, v113
    v_add_f32 v106, v106, v114
    v_add_f32 v107, v107, v115
    v_add_f32 v104, v104, v116
    v_add_f32 v105, v105, v117
    v_add_f32 v106, v106, v118
    v_add_f32 v107, v107, v119
    v_add_f32 v104, v104, v120
    v_add_f32 v105, v105, v121
    v_add_f32 v106, v106, v122
    v_add_f32 v107, v107, v123
    v_and_b32 v124, 0xffff0000, v104
    v_sub_f32 v104, v104, v124
    v_cvt_pk_bf16_f32 v109, v104, 0
    v_lshrrev_b32 v125, 16, v124
    v_or_b32 v108, v124, v125

    v_and_b32 v124, 0xffff0000, v105
    v_sub_f32 v105, v105, v124
    v_cvt_pk_bf16_f32 v111, v105, 0
    v_lshrrev_b32 v125, 16, v124
    v_or_b32 v110, v124, v125

    v_and_b32 v124, 0xffff0000, v106
    v_sub_f32 v106, v106, v124
    v_cvt_pk_bf16_f32 v113, v106, 0
    v_lshrrev_b32 v125, 16, v124
    v_or_b32 v112, v124, v125

    v_and_b32 v124, 0xffff0000, v107
    v_sub_f32 v107, v107, v124
    v_cvt_pk_bf16_f32 v115, v107, 0
    v_lshrrev_b32 v125, 16, v124
    v_or_b32 v114, v124, v125

    s_lshr_b32 s12, s90, 1
    s_lshl_b32 s12, s12, 9
    s_and_b32 s13, s90, 1
    s_lshl_b32 s13, s13, 3
    s_add_u32 s12, s12, s13
    s_add_u32 s12, s12, s91
    s_mov_b64 exec, 0xffff

    buffer_store_dwordx2 v[108:109], v23, s[68:71], s12 offen offset:0
    buffer_store_dwordx2 v[110:111], v23, s[68:71], s12 offen offset:16
    buffer_store_dwordx2 v[112:113], v23, s[68:71], s12 offen offset:32
    buffer_store_dwordx2 v[114:115], v23, s[68:71], s12 offen offset:48
    s_mov_b64 exec, -1
L_attp_s2done:
L_nos2_95:
    s_cmp_lg_u32 s52, 1
    s_cbranch_scc1 L_nos1_96
    s_cmp_eq_u32 s62, 0
    s_cbranch_scc1 L_attp_s1done
    s_mov_b32 s12, 0x05040100
    s_mov_b32 s13, 0x07060302
    s_mov_b32 s14, 0x3f803f80
    s_cmp_eq_u32 s62, 1

    v_mov_b32 v104, 0
    v_perm_b32 v124, v110, v108, s12
    v_perm_b32 v125, v114, v112, s12
    v_perm_b32 v126, v118, v116, s12
    v_perm_b32 v127, v122, v120, s12
    buffer_store_dwordx4 v[124:127], v22, s[68:71], 0 offen offset:0
    s_cbranch_scc1 L_nodot_97
    v_dot2_f32_bf16 v104, v124, s14, v104
    v_dot2_f32_bf16 v104, v125, s14, v104
    v_dot2_f32_bf16 v104, v126, s14, v104
    v_dot2_f32_bf16 v104, v127, s14, v104
L_nodot_97:
    s_nop 1
    v_mov_b32 v105, 0
    v_perm_b32 v124, v110, v108, s13
    v_perm_b32 v125, v114, v112, s13
    v_perm_b32 v126, v118, v116, s13
    v_perm_b32 v127, v122, v120, s13
    buffer_store_dwordx4 v[124:127], v22, s[68:71], 0 offen offset:16
    s_cbranch_scc1 L_nodot_98
    v_dot2_f32_bf16 v105, v124, s14, v105
    v_dot2_f32_bf16 v105, v125, s14, v105
    v_dot2_f32_bf16 v105, v126, s14, v105
    v_dot2_f32_bf16 v105, v127, s14, v105
L_nodot_98:
    s_nop 1
    v_mov_b32 v106, 0
    v_perm_b32 v124, v111, v109, s12
    v_perm_b32 v125, v115, v113, s12
    v_perm_b32 v126, v119, v117, s12
    v_perm_b32 v127, v123, v121, s12
    buffer_store_dwordx4 v[124:127], v22, s[68:71], 0 offen offset:32
    s_cbranch_scc1 L_nodot_99
    v_dot2_f32_bf16 v106, v124, s14, v106
    v_dot2_f32_bf16 v106, v125, s14, v106
    v_dot2_f32_bf16 v106, v126, s14, v106
    v_dot2_f32_bf16 v106, v127, s14, v106
L_nodot_99:
    s_nop 1
    v_mov_b32 v107, 0
    v_perm_b32 v124, v111, v109, s13
    v_perm_b32 v125, v115, v113, s13
    v_perm_b32 v126, v119, v117, s13
    v_perm_b32 v127, v123, v121, s13
    buffer_store_dwordx4 v[124:127], v22, s[68:71], 0 offen offset:48
    s_cbranch_scc1 L_nodot_100
    v_dot2_f32_bf16 v107, v124, s14, v107
    v_dot2_f32_bf16 v107, v125, s14, v107
    v_dot2_f32_bf16 v107, v126, s14, v107
    v_dot2_f32_bf16 v107, v127, s14, v107
L_nodot_100:
    s_nop 1
    s_cmp_eq_u32 s62, 1
    s_mov_b32 s62, 0
    s_cbranch_scc1 L_attp_s1done
    s_nop 0

    v_mov_b32 v124, v104
    v_mov_b32 v125, v105
    v_mov_b32 v126, v106
    v_mov_b32 v127, v107
    s_nop 1
    v_permlane16_swap_b32 v104, v124
    v_permlane16_swap_b32 v105, v125
    v_permlane16_swap_b32 v106, v126
    v_permlane16_swap_b32 v107, v127
    s_nop 1
    v_add_f32 v104, v104, v124
    v_add_f32 v105, v105, v125
    v_add_f32 v106, v106, v126
    v_add_f32 v107, v107, v127
    v_mov_b32 v124, v104
    v_mov_b32 v125, v105
    v_mov_b32 v126, v106
    v_mov_b32 v127, v107
    s_nop 1
    v_permlane32_swap_b32 v104, v124
    v_permlane32_swap_b32 v105, v125
    v_permlane32_swap_b32 v106, v126
    v_permlane32_swap_b32 v107, v127
    s_nop 1
    v_add_f32 v104, v104, v124
    v_add_f32 v105, v105, v125
    v_add_f32 v106, v106, v126
    v_add_f32 v107, v107, v127
    s_lshl_b32 s12, s7, 8
    s_add_u32 s12, s12, 147520
    v_and_b32 v1, 15, v2
    v_lshl_add_u32 v1, v1, 4, s12
    ds_write_b128 v1, v[104:107]
    s_waitcnt lgkmcnt(0)

L_attp_s1done:
L_nos1_96:
    s_cmp_lg_u32 s52, 2
    s_cbranch_scc1 L_nopf_101
    s_lshr_b32 s12, s2, 3
    s_lshl_b32 s12, s12, 4
    s_add_u32 s12, s12, s7
    s_lshr_b32 s13, s3, 2

    s_add_u32 s44, s34, 40894464
    s_addc_u32 s45, s35, 0
    s_mov_b32 s46, 819200
    s_mov_b32 s47, 0x00020000
    s_mul_i32 s14, s13, 409600
    s_mul_i32 s15, s12, 896
    s_add_u32 s14, s14, s15
    s_add_u32 s46, s14, 896
    s_min_u32 s46, s46, 819200
    v_lshlrev_b32 v104, 7, v2
    buffer_load_dword v105, v104, s[44:47], s14 offen
    s_add_u32 s14, s14, 8192
    s_add_u32 s44, s34, 36700160
    s_addc_u32 s45, s35, 0
    s_mov_b32 s46, 4030464
    s_mov_b32 s47, 0x00020000
    s_mul_i32 s14, s13, 2015232
    s_mul_i32 s15, s12, 3968
    s_add_u32 s14, s14, s15
    s_add_u32 s46, s14, 3968
    s_min_u32 s46, s46, 4030464
    v_lshlrev_b32 v104, 7, v2
    buffer_load_dword v105, v104, s[44:47], s14 offen
    s_add_u32 s14, s14, 8192
L_nopf_101:
    s_setprio 3
    ds_read_b64_tr_b16 v[36:37], v12 offset:9216
    ds_read_b64_tr_b16 v[38:39], v13 offset:9216
    ds_read_b64_tr_b16 v[40:41], v12 offset:9472
    ds_read_b64_tr_b16 v[42:43], v13 offset:9472
    ds_read_b128 v[24:27], v10 offset:0
    ds_read_b64 v[32:33], v11 offset:0
    v_exp_f32 v70, v70
    v_cvt_pk_bf16_f32 v44, v68, v69
    v_exp_f32 v71, v71
    v_exp_f32 v72, v72
    v_cvt_pk_bf16_f32 v45, v70, v71
    s_waitcnt lgkmcnt(6)
    v_mfma_f32_32x32x16_bf16 v[84:99], v[28:31], v[16:19], 0
    v_exp_f32 v73, v73
    v_exp_f32 v74, v74
    v_cvt_pk_bf16_f32 v46, v72, v73
    v_exp_f32 v75, v75
    v_exp_f32 v76, v76
    v_cvt_pk_bf16_f32 v47, v74, v75
    v_mfma_f32_32x32x8_bf16 v[84:99], v[34:35], v[20:21], v[84:99]
    v_exp_f32 v77, v77
    v_exp_f32 v78, v78
    v_cvt_pk_bf16_f32 v48, v76, v77
    v_exp_f32 v79, v79
    s_waitcnt lgkmcnt(4)
    v_mfma_f32_32x32x16_bf16 v[52:67], v[36:39], v[44:47], v[52:67]
    v_exp_f32 v80, v80
    v_cvt_pk_bf16_f32 v49, v78, v79
    v_exp_f32 v81, v81
    v_exp_f32 v82, v82
    v_cvt_pk_bf16_f32 v50, v80, v81
    v_exp_f32 v83, v83
    v_exp_f32 v84, v84
    v_cvt_pk_bf16_f32 v51, v82, v83
    v_exp_f32 v85, v85
    s_waitcnt lgkmcnt(2)
    v_mfma_f32_32x32x16_bf16 v[52:67], v[40:43], v[48:51], v[52:67]
    ds_read_b64_tr_b16 v[36:37], v12 offset:10752
    ds_read_b64_tr_b16 v[38:39], v13 offset:10752
    ds_read_b64_tr_b16 v[40:41], v12 offset:11008
    ds_read_b64_tr_b16 v[42:43], v13 offset:11008
    ds_read_b128 v[28:31], v10 offset:1536
    ds_read_b64 v[34:35], v11 offset:1536
    v_exp_f32 v86, v86
    v_cvt_pk_bf16_f32 v44, v84, v85
    v_exp_f32 v87, v87
    v_exp_f32 v88, v88
    v_cvt_pk_bf16_f32 v45, v86, v87
    s_waitcnt lgkmcnt(6)
    v_mfma_f32_32x32x16_bf16 v[68:83], v[24:27], v[16:19], 0
    v_exp_f32 v89, v89
    v_exp_f32 v90, v90
    v_cvt_pk_bf16_f32 v46, v88, v89
    v_exp_f32 v91, v91
    v_exp_f32 v92, v92
    v_cvt_pk_bf16_f32 v47, v90, v91
    v_mfma_f32_32x32x8_bf16 v[68:83], v[32:33], v[20:21], v[68:83]
    v_exp_f32 v93, v93
    v_exp_f32 v94, v94
    v_cvt_pk_bf16_f32 v48, v92, v93
    v_exp_f32 v95, v95
    s_waitcnt lgkmcnt(4)
    v_mfma_f32_32x32x16_bf16 v[52:67], v[36:39], v[44:47], v[52:67]
    v_exp_f32 v96, v96
    v_cvt_pk_bf16_f32 v49, v94, v95
    v_exp_f32 v97, v97
    v_exp_f32 v98, v98
    v_cvt_pk_bf16_f32 v50, v96, v97
    v_exp_f32 v99, v99
    s_add_u32 s52, s52, 1
    s_cmp_lt_u32 s52, 4
    s_cbranch_scc1 L_att_loop

    s_nop 0
    v_cvt_pk_bf16_f32 v51, v98, v99
    s_waitcnt lgkmcnt(0)
    s_nop 1
    v_mfma_f32_32x32x16_bf16 v[52:67], v[40:43], v[48:51], v[52:67]
    s_mul_i32 s10, s8, 3072
    s_add_u32 s10, s10, 49152
    v_lshl_add_u32 v103, v2, 4, s10
    v_add_u32 v13, s54, v3
    v_lshrrev_b32 v14, 4, v13
    v_mul_u32_u24 v14, 20480, v14
    v_and_b32 v13, 15, v13
    v_lshl_add_u32 v14, v13, 4, v14
    v_lshl_add_u32 v15, v4, 8, v14
    s_lshl_b32 s10, s5, 9
    s_lshr_b32 s11, s5, 1
    s_lshl_b32 s11, s11, 8
    s_and_b32 s12, s5, 1
    s_lshl_b32 s12, s12, 3
    s_add_u32 s11, s11, s12
    s_add_u32 s11, s11, 16384
    s_nop 4
    s_cmp_eq_u32 s9, 0
    s_cbranch_scc1 L_att_lower
    ds_write_b128 v103, v[52:55]
    ds_write_b128 v103, v[56:59] offset:1024
    ds_write_b128 v103, v[60:63] offset:2048
    s_waitcnt lgkmcnt(0)
    s_barrier
    s_branch L_att_join

L_att_lower:
    s_barrier
    ds_read_b128 v[68:71], v103
    ds_read_b128 v[72:75], v103 offset:1024
    ds_read_b128 v[76:79], v103 offset:2048
    s_waitcnt lgkmcnt(0)

    v_pk_add_f32 v[52:53], v[52:53], v[68:69]
    v_pk_add_f32 v[54:55], v[54:55], v[70:71]
    v_pk_add_f32 v[56:57], v[56:57], v[72:73]
    v_pk_add_f32 v[58:59], v[58:59], v[74:75]
    v_pk_add_f32 v[60:61], v[60:61], v[76:77]
    v_pk_add_f32 v[62:63], v[62:63], v[78:79]
    v_mov_b32 v100, v60
    v_mov_b32 v101, v60
    v_mul_f32 v102, 0, v52
    s_nop 0
    v_permlane32_swap_b32 v100, v101

    v_fma_f32 v102, 0, v53, v102
    v_fma_f32 v102, 0, v54, v102
    v_fma_f32 v102, 0, v55, v102
    v_fma_f32 v102, 0, v56, v102
    v_fma_f32 v102, 0, v57, v102
    v_fma_f32 v102, 0, v58, v102
    v_fma_f32 v102, 0, v59, v102
    v_fma_f32 v102, 0, v60, v102
    v_fma_f32 v102, 0, v61, v102
    v_fma_f32 v102, 0, v62, v102
    v_fma_f32 v102, 0, v63, v102
    v_rcp_f32 v101, v101
    v_cmp_u_f32 vcc, v102, v102
    v_mul_f32 v52, v52, v101
    v_mul_f32 v53, v53, v101
    v_mul_f32 v54, v54, v101
    v_mul_f32 v55, v55, v101
    v_mul_f32 v56, v56, v101
    v_mul_f32 v57, v57, v101
    v_mul_f32 v58, v58, v101
    v_mul_f32 v59, v59, v101
    v_mul_f32 v60, v60, v101
    v_mul_f32 v61, v61, v101
    v_mul_f32 v62, v62, v101
    v_mul_f32 v63, v63, v101
    v_cvt_pk_bf16_f32 v44, v52, v53
    v_cvt_pk_bf16_f32 v45, v54, v55
    v_cvt_pk_bf16_f32 v46, v56, v57
    v_cvt_pk_bf16_f32 v47, v58, v59
    v_cvt_pk_bf16_f32 v48, v60, v61
    v_cvt_pk_bf16_f32 v49, v62, v63
    buffer_store_dwordx4 v[44:47], v15, s[48:51], s10 offen
    s_mov_b64 exec, s[64:65]
    buffer_store_dwordx2 v[48:49], v14, s[48:51], s11 offen
    s_mov_b64 exec, -1
    s_cbranch_vccz L_att_join
    v_mov_b32 v101, 147456
    v_mov_b32 v100, 1
    ds_write_b32 v101, v100

L_att_join:
    s_cmp_lg_u32 s56, 0
    s_cbranch_scc1 L_att_done
    v_mov_b32 v101, 147456
    s_waitcnt lgkmcnt(0)
    s_barrier
    ds_read_b32 v100, v101
    s_waitcnt lgkmcnt(0)
    v_readfirstlane_b32 s10, v100
    s_nop 3
    s_cmp_eq_u32 s10, 0
    s_cbranch_scc1 L_att_done

    s_mov_b32 s56, 1
    s_mov_b64 exec, s[66:67]
    v_mov_b32 v20, 0
    v_mov_b32 v21, 0
    s_mov_b64 exec, -1
    v_mov_b32 v100, 0xff800000
    s_add_u32 s10, s5, 32
    s_mul_i32 s10, s10, 98304
    s_mov_b32 s11, 64

L_att_maxloop:
    buffer_load_dwordx4 v[24:27], v6, s[40:43], s10 offen
    buffer_load_dwordx2 v[32:33], v7, s[40:43], s10 offen
    s_waitcnt vmcnt(0)
    v_mfma_f32_32x32x16_bf16 v[68:83], v[24:27], v[16:19], 0
    v_mfma_f32_32x32x8_bf16 v[68:83], v[32:33], v[20:21], v[68:83]
    s_nop 15

    v_max3_f32 v100, v100, v68, v69
    v_max3_f32 v100, v100, v70, v71
    v_max3_f32 v100, v100, v72, v73
    v_max3_f32 v100, v100, v74, v75
    v_max3_f32 v100, v100, v76, v77
    v_max3_f32 v100, v100, v78, v79
    v_max3_f32 v100, v100, v80, v81
    v_max3_f32 v100, v100, v82, v83
    s_add_u32 s10, s10, 1536
    s_sub_u32 s11, s11, 1
    s_cmp_lg_u32 s11, 0
    s_cbranch_scc1 L_att_maxloop
    s_branch L_att_set_m

L_att_done:
L_att_exit:
    s_endpgm
.globl cha_kernel
.p2align 8
.type cha_kernel,@function
cha_kernel:
    s_cmp_ge_u32 s2, 256
    s_cbranch_scc1 L_ch_exit
    s_load_dwordx16 s[16:31], s[0:1], 0
    s_load_dwordx4 s[32:35], s[0:1], 64
    s_and_b32 s3, s2, 7
    s_lshr_b32 s4, s2, 3
    s_and_b32 s5, s3, 3
    s_lshl_b32 s5, s5, 2
    s_and_b32 s8, s4, 3
    s_add_u32 s36, s5, s8
    s_lshr_b32 s6, s3, 2
    s_lshl_b32 s9, s6, 3
    s_lshr_b32 s8, s4, 2
    s_add_u32 s37, s9, s8
    s_lshl_b32 s38, s36, 1
    s_and_b32 s8, s8, 1
    s_add_u32 s38, s38, s8
    s_lshl_b32 s39, s6, 2
    s_lshr_b32 s8, s4, 3
    s_add_u32 s39, s39, s8
    v_lshrrev_b32 v1, 6, v0
    v_and_b32 v2, 63, v0
    s_nop 0
    v_readfirstlane_b32 s7, v1

    s_waitcnt lgkmcnt(0)
    s_mov_b32 s98, 0
    s_mov_b32 s94, s16
    s_mov_b32 s95, s17
    s_add_u32 s96, s34, 3145728
    s_addc_u32 s97, s35, 0
    s_branch L_ch_body
L_ch_exit:
    s_endpgm
L_ch_body:
    s_cmp_lt_u32 s7, 4
    s_cbranch_scc1 L_ch_compute
    s_and_b32 s9, s7, 1
    s_cmp_ge_u32 s7, 6
    s_cbranch_scc1 L_ch_xload
    s_add_u32 s52, s34, 40894464
    s_addc_u32 s53, s35, 0
    s_mov_b32 s54, 819200
    s_mov_b32 s55, 0x00020000
    s_mul_i32 s11, s9, 5120
    s_add_u32 s57, s11, 8192
    s_mul_i32 s10, s39, 102400
    s_add_u32 s10, s10, s11
    v_lshl_add_u32 v8, v2, 4, s10
    v_add_u32 v9, 4096, v8

    s_mov_b32 s58, 0
    s_add_u32 m0, s57, 0
    s_nop 0
    buffer_load_dwordx4 v8, s[52:55], s58 offen offset:0 lds
    buffer_load_dwordx4 v8, s[52:55], s58 offen offset:1024 lds
    buffer_load_dwordx4 v8, s[52:55], s58 offen offset:2048 lds
    buffer_load_dwordx4 v8, s[52:55], s58 offen offset:3072 lds
    s_add_u32 m0, s57, 4096
    s_nop 0
    buffer_load_dwordx4 v9, s[52:55], s58 offen lds
    s_mov_b32 s58, 10240
    s_add_u32 m0, s57, 18432
    s_nop 0
    buffer_load_dwordx4 v8, s[52:55], s58 offen offset:0 lds
    buffer_load_dwordx4 v8, s[52:55], s58 offen offset:1024 lds
    buffer_load_dwordx4 v8, s[52:55], s58 offen offset:2048 lds
    buffer_load_dwordx4 v8, s[52:55], s58 offen offset:3072 lds
    s_add_u32 m0, s57, 22528
    s_nop 0
    buffer_load_dwordx4 v9, s[52:55], s58 offen lds
    s_mov_b32 s58, 20480
    s_add_u32 m0, s57, 36864
    s_nop 0
    buffer_load_dwordx4 v8, s[52:55], s58 offen offset:0 lds
    buffer_load_dwordx4 v8, s[52:55], s58 offen offset:1024 lds
    buffer_load_dwordx4 v8, s[52:55], s58 offen offset:2048 lds
    buffer_load_dwordx4 v8, s[52:55], s58 offen offset:3072 lds
    s_add_u32 m0, s57, 40960
    s_nop 0
    buffer_load_dwordx4 v9, s[52:55], s58 offen lds
    s_mov_b32 s58, 30720
    s_add_u32 m0, s57, 55296
    s_nop 0
    buffer_load_dwordx4 v8, s[52:55], s58 offen offset:0 lds
    buffer_load_dwordx4 v8, s[52:55], s58 offen offset:1024 lds
    buffer_load_dwordx4 v8, s[52:55], s58 offen offset:2048 lds
    buffer_load_dwordx4 v8, s[52:55], s58 offen offset:3072 lds
    s_add_u32 m0, s57, 59392
    s_nop 0
    buffer_load_dwordx4 v9, s[52:55], s58 offen lds
    s_waitcnt vmcnt(15)
    s_barrier
    s_mov_b32 s58, 40960
    s_add_u32 m0, s57, 73728
    s_nop 0
    buffer_load_dwordx4 v8, s[52:55], s58 offen offset:0 lds
    buffer_load_dwordx4 v8, s[52:55], s58 offen offset:1024 lds
    buffer_load_dwordx4 v8, s[52:55], s58 offen offset:2048 lds
    buffer_load_dwordx4 v8, s[52:55], s58 offen offset:3072 lds
    s_add_u32 m0, s57, 77824
    s_nop 0
    buffer_load_dwordx4 v9, s[52:55], s58 offen lds
    s_waitcnt vmcnt(15)
    s_barrier
    s_mov_b32 s58, 51200
    s_add_u32 m0, s57, 92160
    s_nop 0
    buffer_load_dwordx4 v8, s[52:55], s58 offen offset:0 lds
    buffer_load_dwordx4 v8, s[52:55], s58 offen offset:1024 lds
    buffer_load_dwordx4 v8, s[52:55], s58 offen offset:2048 lds
    buffer_load_dwordx4 v8, s[52:55], s58 offen offset:3072 lds
    s_add_u32 m0, s57, 96256
    s_nop 0
    buffer_load_dwordx4 v9, s[52:55], s58 offen lds
    s_waitcnt vmcnt(15)
    s_barrier
    s_mov_b32 s58, 61440
    s_add_u32 m0, s57, 110592
    s_nop 0
    buffer_load_dwordx4 v8, s[52:55], s58 offen offset:0 lds
    buffer_load_dwordx4 v8, s[52:55], s58 offen offset:1024 lds
    buffer_load_dwordx4 v8, s[52:55], s58 offen offset:2048 lds
    buffer_load_dwordx4 v8, s[52:55], s58 offen offset:3072 lds
    s_add_u32 m0, s57, 114688
    s_nop 0
    buffer_load_dwordx4 v9, s[52:55], s58 offen lds
    s_waitcnt vmcnt(15)
    s_barrier
    s_mov_b32 s58, 71680
    s_add_u32 m0, s57, 129024
    s_nop 0
    buffer_load_dwordx4 v8, s[52:55], s58 offen offset:0 lds
    buffer_load_dwordx4 v8, s[52:55], s58 offen offset:1024 lds
    buffer_load_dwordx4 v8, s[52:55], s58 offen offset:2048 lds
    buffer_load_dwordx4 v8, s[52:55], s58 offen offset:3072 lds
    s_add_u32 m0, s57, 133120
    s_nop 0
    buffer_load_dwordx4 v9, s[52:55], s58 offen lds
    s_waitcnt vmcnt(15)
    s_barrier
    s_mov_b32 s58, 81920
    s_add_u32 m0, s57, 0
    s_nop 0
    buffer_load_dwordx4 v8, s[52:55], s58 offen offset:0 lds
    buffer_load_dwordx4 v8, s[52:55], s58 offen offset:1024 lds
    buffer_load_dwordx4 v8, s[52:55], s58 offen offset:2048 lds
    buffer_load_dwordx4 v8, s[52:55], s58 offen offset:3072 lds
    s_add_u32 m0, s57, 4096
    s_nop 0
    buffer_load_dwordx4 v9, s[52:55], s58 offen lds
    s_waitcnt vmcnt(15)
    s_barrier
    s_mov_b32 s58, 92160
    s_add_u32 m0, s57, 18432
    s_nop 0
    buffer_load_dwordx4 v8, s[52:55], s58 offen offset:0 lds
    buffer_load_dwordx4 v8, s[52:55], s58 offen offset:1024 lds
    buffer_load_dwordx4 v8, s[52:55], s58 offen offset:2048 lds
    buffer_load_dwordx4 v8, s[52:55], s58 offen offset:3072 lds
    s_add_u32 m0, s57, 22528
    s_nop 0
    buffer_load_dwordx4 v9, s[52:55], s58 offen lds
    s_waitcnt vmcnt(15)
    s_barrier
    s_waitcnt vmcnt(10)
    s_barrier
    s_waitcnt vmcnt(5)
    s_barrier
    s_waitcnt vmcnt(0)
    s_barrier
    s_barrier
    s_add_u32 s52, s34, 36700160
    s_addc_u32 s53, s35, 0
    s_mov_b32 s54, 4030464
    s_mov_b32 s55, 0x00020000
    s_mul_i32 s10, s37, 251904
    s_mul_i32 s11, s9, 6144
    s_add_u32 s10, s10, s11
    v_lshl_add_u32 v8, v2, 4, s10
    v_add_u32 v9, 4096, v8
    s_add_u32 s57, s11, 8192

    s_mov_b32 s58, 0
    s_add_u32 m0, s57, 0
    s_nop 0
    buffer_load_dwordx4 v8, s[52:55], s58 offen offset:0 lds
    buffer_load_dwordx4 v8, s[52:55], s58 offen offset:1024 lds
    buffer_load_dwordx4 v8, s[52:55], s58 offen offset:2048 lds
    buffer_load_dwordx4 v8, s[52:55], s58 offen offset:3072 lds
    s_add_u32 m0, s57, 4096
    s_nop 0
    buffer_load_dwordx4 v9, s[52:55], s58 offen offset:0 lds
    buffer_load_dwordx4 v9, s[52:55], s58 offen offset:1024 lds
    s_mov_b32 s58, 12288
    s_add_u32 m0, s57, 20480
    s_nop 0
    buffer_load_dwordx4 v8, s[52:55], s58 offen offset:0 lds
    buffer_load_dwordx4 v8, s[52:55], s58 offen offset:1024 lds
    buffer_load_dwordx4 v8, s[52:55], s58 offen offset:2048 lds
    buffer_load_dwordx4 v8, s[52:55], s58 offen offset:3072 lds
    s_add_u32 m0, s57, 24576
    s_nop 0
    buffer_load_dwordx4 v9, s[52:55], s58 offen offset:0 lds
    buffer_load_dwordx4 v9, s[52:55], s58 offen offset:1024 lds
    s_mov_b32 s58, 24576
    s_add_u32 m0, s57, 40960
    s_nop 0
    buffer_load_dwordx4 v8, s[52:55], s58 offen offset:0 lds
    buffer_load_dwordx4 v8, s[52:55], s58 offen offset:1024 lds
    buffer_load_dwordx4 v8, s[52:55], s58 offen offset:2048 lds
    buffer_load_dwordx4 v8, s[52:55], s58 offen offset:3072 lds
    s_add_u32 m0, s57, 45056
    s_nop 0
    buffer_load_dwordx4 v9, s[52:55], s58 offen offset:0 lds
    buffer_load_dwordx4 v9, s[52:55], s58 offen offset:1024 lds
    s_mov_b32 s58, 36864
    s_add_u32 m0, s57, 61440
    s_nop 0
    buffer_load_dwordx4 v8, s[52:55], s58 offen offset:0 lds
    buffer_load_dwordx4 v8, s[52:55], s58 offen offset:1024 lds
    buffer_load_dwordx4 v8, s[52:55], s58 offen offset:2048 lds
    buffer_load_dwordx4 v8, s[52:55], s58 offen offset:3072 lds
    s_add_u32 m0, s57, 65536
    s_nop 0
    buffer_load_dwordx4 v9, s[52:55], s58 offen offset:0 lds
    buffer_load_dwordx4 v9, s[52:55], s58 offen offset:1024 lds
    s_barrier
    s_waitcnt vmcnt(18)
    s_barrier
    s_mov_b32 s58, 49152
    s_add_u32 m0, s57, 81920
    s_nop 0
    buffer_load_dwordx4 v8, s[52:55], s58 offen offset:0 lds
    buffer_load_dwordx4 v8, s[52:55], s58 offen offset:1024 lds
    buffer_load_dwordx4 v8, s[52:55], s58 offen offset:2048 lds
    buffer_load_dwordx4 v8, s[52:55], s58 offen offset:3072 lds
    s_add_u32 m0, s57, 86016
    s_nop 0
    buffer_load_dwordx4 v9, s[52:55], s58 offen offset:0 lds
    buffer_load_dwordx4 v9, s[52:55], s58 offen offset:1024 lds
    s_waitcnt vmcnt(18)
    s_barrier
    s_mov_b32 s58, 61440
    s_add_u32 m0, s57, 102400
    s_nop 0
    buffer_load_dwordx4 v8, s[52:55], s58 offen offset:0 lds
    buffer_load_dwordx4 v8, s[52:55], s58 offen offset:1024 lds
    buffer_load_dwordx4 v8, s[52:55], s58 offen offset:2048 lds
    buffer_load_dwordx4 v8, s[52:55], s58 offen offset:3072 lds
    s_add_u32 m0, s57, 106496
    s_nop 0
    buffer_load_dwordx4 v9, s[52:55], s58 offen offset:0 lds
    buffer_load_dwordx4 v9, s[52:55], s58 offen offset:1024 lds
    s_waitcnt vmcnt(18)
    s_barrier
    s_mov_b32 s58, 73728
    s_add_u32 m0, s57, 122880
    s_nop 0
    buffer_load_dwordx4 v8, s[52:55], s58 offen offset:0 lds
    buffer_load_dwordx4 v8, s[52:55], s58 offen offset:1024 lds
    buffer_load_dwordx4 v8, s[52:55], s58 offen offset:2048 lds
    buffer_load_dwordx4 v8, s[52:55], s58 offen offset:3072 lds
    s_add_u32 m0, s57, 126976
    s_nop 0
    buffer_load_dwordx4 v9, s[52:55], s58 offen offset:0 lds
    buffer_load_dwordx4 v9, s[52:55], s58 offen offset:1024 lds
    s_waitcnt vmcnt(18)
    s_barrier
    s_mov_b32 s58, 86016
    s_add_u32 m0, s57, 143360
    s_nop 0
    buffer_load_dwordx4 v8, s[52:55], s58 offen offset:0 lds
    buffer_load_dwordx4 v8, s[52:55], s58 offen offset:1024 lds
    buffer_load_dwordx4 v8, s[52:55], s58 offen offset:2048 lds
    buffer_load_dwordx4 v8, s[52:55], s58 offen offset:3072 lds
    s_add_u32 m0, s57, 147456
    s_nop 0
    buffer_load_dwordx4 v9, s[52:55], s58 offen offset:0 lds
    buffer_load_dwordx4 v9, s[52:55], s58 offen offset:1024 lds
    s_waitcnt vmcnt(18)
    s_barrier
    s_mov_b32 s58, 98304
    s_add_u32 m0, s57, 0
    s_nop 0
    buffer_load_dwordx4 v8, s[52:55], s58 offen offset:0 lds
    buffer_load_dwordx4 v8, s[52:55], s58 offen offset:1024 lds
    buffer_load_dwordx4 v8, s[52:55], s58 offen offset:2048 lds
    buffer_load_dwordx4 v8, s[52:55], s58 offen offset:3072 lds
    s_add_u32 m0, s57, 4096
    s_nop 0
    buffer_load_dwordx4 v9, s[52:55], s58 offen offset:0 lds
    buffer_load_dwordx4 v9, s[52:55], s58 offen offset:1024 lds
    s_waitcnt vmcnt(18)
    s_barrier
    s_mov_b32 s58, 110592
    s_add_u32 m0, s57, 20480
    s_nop 0
    buffer_load_dwordx4 v8, s[52:55], s58 offen offset:0 lds
    buffer_load_dwordx4 v8, s[52:55], s58 offen offset:1024 lds
    buffer_load_dwordx4 v8, s[52:55], s58 offen offset:2048 lds
    buffer_load_dwordx4 v8, s[52:55], s58 offen offset:3072 lds
    s_add_u32 m0, s57, 24576
    s_nop 0
    buffer_load_dwordx4 v9, s[52:55], s58 offen offset:0 lds
    buffer_load_dwordx4 v9, s[52:55], s58 offen offset:1024 lds
    s_waitcnt vmcnt(18)
    s_barrier
    s_mov_b32 s58, 122880
    s_add_u32 m0, s57, 40960
    s_nop 0
    buffer_load_dwordx4 v8, s[52:55], s58 offen offset:0 lds
    buffer_load_dwordx4 v8, s[52:55], s58 offen offset:1024 lds
    buffer_load_dwordx4 v8, s[52:55], s58 offen offset:2048 lds
    buffer_load_dwordx4 v8, s[52:55], s58 offen offset:3072 lds
    s_add_u32 m0, s57, 45056
    s_nop 0
    buffer_load_dwordx4 v9, s[52:55], s58 offen offset:0 lds
    buffer_load_dwordx4 v9, s[52:55], s58 offen offset:1024 lds
    s_waitcnt vmcnt(18)
    s_barrier
    s_mov_b32 s58, 135168
    s_add_u32 m0, s57, 61440
    s_nop 0
    buffer_load_dwordx4 v8, s[52:55], s58 offen offset:0 lds
    buffer_load_dwordx4 v8, s[52:55], s58 offen offset:1024 lds
    buffer_load_dwordx4 v8, s[52:55], s58 offen offset:2048 lds
    buffer_load_dwordx4 v8, s[52:55], s58 offen offset:3072 lds
    s_add_u32 m0, s57, 65536
    s_nop 0
    buffer_load_dwordx4 v9, s[52:55], s58 offen offset:0 lds
    buffer_load_dwordx4 v9, s[52:55], s58 offen offset:1024 lds
    s_waitcnt vmcnt(18)
    s_barrier
    s_mov_b32 s58, 147456
    s_add_u32 m0, s57, 81920
    s_nop 0
    buffer_load_dwordx4 v8, s[52:55], s58 offen offset:0 lds
    buffer_load_dwordx4 v8, s[52:55], s58 offen offset:1024 lds
    buffer_load_dwordx4 v8, s[52:55], s58 offen offset:2048 lds
    buffer_load_dwordx4 v8, s[52:55], s58 offen offset:3072 lds
    s_add_u32 m0, s57, 86016
    s_nop 0
    buffer_load_dwordx4 v9, s[52:55], s58 offen offset:0 lds
    buffer_load_dwordx4 v9, s[52:55], s58 offen offset:1024 lds
    s_waitcnt vmcnt(18)
    s_barrier
    s_mov_b32 s58, 159744
    s_add_u32 m0, s57, 102400
    s_nop 0
    buffer_load_dwordx4 v8, s[52:55], s58 offen offset:0 lds
    buffer_load_dwordx4 v8, s[52:55], s58 offen offset:1024 lds
    buffer_load_dwordx4 v8, s[52:55], s58 offen offset:2048 lds
    buffer_load_dwordx4 v8, s[52:55], s58 offen offset:3072 lds
    s_add_u32 m0, s57, 106496
    s_nop 0
    buffer_load_dwordx4 v9, s[52:55], s58 offen offset:0 lds
    buffer_load_dwordx4 v9, s[52:55], s58 offen offset:1024 lds
    s_waitcnt vmcnt(18)
    s_barrier
    s_mov_b32 s58, 172032
    s_add_u32 m0, s57, 122880
    s_nop 0
    buffer_load_dwordx4 v8, s[52:55], s58 offen offset:0 lds
    buffer_load_dwordx4 v8, s[52:55], s58 offen offset:1024 lds
    buffer_load_dwordx4 v8, s[52:55], s58 offen offset:2048 lds
    buffer_load_dwordx4 v8, s[52:55], s58 offen offset:3072 lds
    s_add_u32 m0, s57, 126976
    s_nop 0
    buffer_load_dwordx4 v9, s[52:55], s58 offen offset:0 lds
    buffer_load_dwordx4 v9, s[52:55], s58 offen offset:1024 lds
    s_waitcnt vmcnt(18)
    s_barrier
    s_mov_b32 s58, 184320
    s_add_u32 m0, s57, 143360
    s_nop 0
    buffer_load_dwordx4 v8, s[52:55], s58 offen offset:0 lds
    buffer_load_dwordx4 v8, s[52:55], s58 offen offset:1024 lds
    buffer_load_dwordx4 v8, s[52:55], s58 offen offset:2048 lds
    buffer_load_dwordx4 v8, s[52:55], s58 offen offset:3072 lds
    s_add_u32 m0, s57, 147456
    s_nop 0
    buffer_load_dwordx4 v9, s[52:55], s58 offen offset:0 lds
    buffer_load_dwordx4 v9, s[52:55], s58 offen offset:1024 lds
    s_waitcnt vmcnt(18)
    s_barrier
    s_mov_b32 s58, 196608
    s_add_u32 m0, s57, 0
    s_nop 0
    buffer_load_dwordx4 v8, s[52:55], s58 offen offset:0 lds
    buffer_load_dwordx4 v8, s[52:55], s58 offen offset:1024 lds
    buffer_load_dwordx4 v8, s[52:55], s58 offen offset:2048 lds
    buffer_load_dwordx4 v8, s[52:55], s58 offen offset:3072 lds
    s_add_u32 m0, s57, 4096
    s_nop 0
    buffer_load_dwordx4 v9, s[52:55], s58 offen offset:0 lds
    buffer_load_dwordx4 v9, s[52:55], s58 offen offset:1024 lds
    s_waitcnt vmcnt(18)
    s_barrier
    s_mov_b32 s58, 208896
    s_add_u32 m0, s57, 20480
    s_nop 0
    buffer_load_dwordx4 v8, s[52:55], s58 offen offset:0 lds
    buffer_load_dwordx4 v8, s[52:55], s58 offen offset:1024 lds
    buffer_load_dwordx4 v8, s[52:55], s58 offen offset:2048 lds
    buffer_load_dwordx4 v8, s[52:55], s58 offen offset:3072 lds
    s_add_u32 m0, s57, 24576
    s_nop 0
    buffer_load_dwordx4 v9, s[52:55], s58 offen offset:0 lds
    buffer_load_dwordx4 v9, s[52:55], s58 offen offset:1024 lds
    s_waitcnt vmcnt(18)
    s_barrier
    s_mov_b32 s58, 221184
    s_add_u32 m0, s57, 40960
    s_nop 0
    buffer_load_dwordx4 v8, s[52:55], s58 offen offset:0 lds
    buffer_load_dwordx4 v8, s[52:55], s58 offen offset:1024 lds
    buffer_load_dwordx4 v8, s[52:55], s58 offen offset:2048 lds
    buffer_load_dwordx4 v8, s[52:55], s58 offen offset:3072 lds
    s_add_u32 m0, s57, 45056
    s_nop 0
    buffer_load_dwordx4 v9, s[52:55], s58 offen offset:0 lds
    buffer_load_dwordx4 v9, s[52:55], s58 offen offset:1024 lds
    s_waitcnt vmcnt(18)
    s_barrier
    s_mov_b32 s58, 233472
    s_add_u32 m0, s57, 61440
    s_nop 0
    buffer_load_dwordx4 v8, s[52:55], s58 offen offset:0 lds
    buffer_load_dwordx4 v8, s[52:55], s58 offen offset:1024 lds
    buffer_load_dwordx4 v8, s[52:55], s58 offen offset:2048 lds
    buffer_load_dwordx4 v8, s[52:55], s58 offen offset:3072 lds
    s_add_u32 m0, s57, 65536
    s_nop 0
    buffer_load_dwordx4 v9, s[52:55], s58 offen offset:0 lds
    buffer_load_dwordx4 v9, s[52:55], s58 offen offset:1024 lds
    s_waitcnt vmcnt(18)
    s_barrier
    s_waitcnt vmcnt(12)
    s_barrier
    s_waitcnt vmcnt(6)
    s_barrier
    s_waitcnt vmcnt(0)
    s_barrier
    s_barrier
    s_add_u32 s52, s34, 41943040
    s_addc_u32 s53, s35, 0
    s_mov_b32 s54, 1966080
    s_mov_b32 s55, 0x00020000
    s_mul_i32 s11, s9, 5120
    s_add_u32 s57, s11, 8192
    s_mul_i32 s10, s39, 245760
    s_add_u32 s10, s10, s11
    v_lshl_add_u32 v8, v2, 4, s10
    v_add_u32 v9, 4096, v8

    s_mov_b32 s58, 0
    s_add_u32 m0, s57, 0
    s_nop 0
    buffer_load_dwordx4 v8, s[52:55], s58 offen offset:0 lds
    buffer_load_dwordx4 v8, s[52:55], s58 offen offset:1024 lds
    buffer_load_dwordx4 v8, s[52:55], s58 offen offset:2048 lds
    buffer_load_dwordx4 v8, s[52:55], s58 offen offset:3072 lds
    s_add_u32 m0, s57, 4096
    s_nop 0
    buffer_load_dwordx4 v9, s[52:55], s58 offen lds
    s_mov_b32 s58, 10240
    s_add_u32 m0, s57, 18432
    s_nop 0
    buffer_load_dwordx4 v8, s[52:55], s58 offen offset:0 lds
    buffer_load_dwordx4 v8, s[52:55], s58 offen offset:1024 lds
    buffer_load_dwordx4 v8, s[52:55], s58 offen offset:2048 lds
    buffer_load_dwordx4 v8, s[52:55], s58 offen offset:3072 lds
    s_add_u32 m0, s57, 22528
    s_nop 0
    buffer_load_dwordx4 v9, s[52:55], s58 offen lds
    s_mov_b32 s58, 20480
    s_add_u32 m0, s57, 36864
    s_nop 0
    buffer_load_dwordx4 v8, s[52:55], s58 offen offset:0 lds
    buffer_load_dwordx4 v8, s[52:55], s58 offen offset:1024 lds
    buffer_load_dwordx4 v8, s[52:55], s58 offen offset:2048 lds
    buffer_load_dwordx4 v8, s[52:55], s58 offen offset:3072 lds
    s_add_u32 m0, s57, 40960
    s_nop 0
    buffer_load_dwordx4 v9, s[52:55], s58 offen lds
    s_mov_b32 s58, 30720
    s_add_u32 m0, s57, 55296
    s_nop 0
    buffer_load_dwordx4 v8, s[52:55], s58 offen offset:0 lds
    buffer_load_dwordx4 v8, s[52:55], s58 offen offset:1024 lds
    buffer_load_dwordx4 v8, s[52:55], s58 offen offset:2048 lds
    buffer_load_dwordx4 v8, s[52:55], s58 offen offset:3072 lds
    s_add_u32 m0, s57, 59392
    s_nop 0
    buffer_load_dwordx4 v9, s[52:55], s58 offen lds
    s_barrier
    s_waitcnt vmcnt(15)
    s_barrier
    s_mov_b32 s58, 40960
    s_add_u32 m0, s57, 73728
    s_nop 0
    buffer_load_dwordx4 v8, s[52:55], s58 offen offset:0 lds
    buffer_load_dwordx4 v8, s[52:55], s58 offen offset:1024 lds
    buffer_load_dwordx4 v8, s[52:55], s58 offen offset:2048 lds
    buffer_load_dwordx4 v8, s[52:55], s58 offen offset:3072 lds
    s_add_u32 m0, s57, 77824
    s_nop 0
    buffer_load_dwordx4 v9, s[52:55], s58 offen lds
    s_waitcnt vmcnt(15)
    s_barrier
    s_mov_b32 s58, 51200
    s_add_u32 m0, s57, 92160
    s_nop 0
    buffer_load_dwordx4 v8, s[52:55], s58 offen offset:0 lds
    buffer_load_dwordx4 v8, s[52:55], s58 offen offset:1024 lds
    buffer_load_dwordx4 v8, s[52:55], s58 offen offset:2048 lds
    buffer_load_dwordx4 v8, s[52:55], s58 offen offset:3072 lds
    s_add_u32 m0, s57, 96256
    s_nop 0
    buffer_load_dwordx4 v9, s[52:55], s58 offen lds
    s_waitcnt vmcnt(15)
    s_barrier
    s_mov_b32 s58, 61440
    s_add_u32 m0, s57, 110592
    s_nop 0
    buffer_load_dwordx4 v8, s[52:55], s58 offen offset:0 lds
    buffer_load_dwordx4 v8, s[52:55], s58 offen offset:1024 lds
    buffer_load_dwordx4 v8, s[52:55], s58 offen offset:2048 lds
    buffer_load_dwordx4 v8, s[52:55], s58 offen offset:3072 lds
    s_add_u32 m0, s57, 114688
    s_nop 0
    buffer_load_dwordx4 v9, s[52:55], s58 offen lds
    s_waitcnt vmcnt(15)
    s_barrier
    s_mov_b32 s58, 71680
    s_add_u32 m0, s57, 129024
    s_nop 0
    buffer_load_dwordx4 v8, s[52:55], s58 offen offset:0 lds
    buffer_load_dwordx4 v8, s[52:55], s58 offen offset:1024 lds
    buffer_load_dwordx4 v8, s[52:55], s58 offen offset:2048 lds
    buffer_load_dwordx4 v8, s[52:55], s58 offen offset:3072 lds
    s_add_u32 m0, s57, 133120
    s_nop 0
    buffer_load_dwordx4 v9, s[52:55], s58 offen lds
    s_waitcnt vmcnt(15)
    s_barrier
    s_mov_b32 s58, 81920
    s_add_u32 m0, s57, 0
    s_nop 0
    buffer_load_dwordx4 v8, s[52:55], s58 offen offset:0 lds
    buffer_load_dwordx4 v8, s[52:55], s58 offen offset:1024 lds
    buffer_load_dwordx4 v8, s[52:55], s58 offen offset:2048 lds
    buffer_load_dwordx4 v8, s[52:55], s58 offen offset:3072 lds
    s_add_u32 m0, s57, 4096
    s_nop 0
    buffer_load_dwordx4 v9, s[52:55], s58 offen lds
    s_waitcnt vmcnt(15)
    s_barrier
    s_mov_b32 s58, 92160
    s_add_u32 m0, s57, 18432
    s_nop 0
    buffer_load_dwordx4 v8, s[52:55], s58 offen offset:0 lds
    buffer_load_dwordx4 v8, s[52:55], s58 offen offset:1024 lds
    buffer_load_dwordx4 v8, s[52:55], s58 offen offset:2048 lds
    buffer_load_dwordx4 v8, s[52:55], s58 offen offset:3072 lds
    s_add_u32 m0, s57, 22528
    s_nop 0
    buffer_load_dwordx4 v9, s[52:55], s58 offen lds
    s_waitcnt vmcnt(15)
    s_barrier
    s_mov_b32 s58, 102400
    s_add_u32 m0, s57, 36864
    s_nop 0
    buffer_load_dwordx4 v8, s[52:55], s58 offen offset:0 lds
    buffer_load_dwordx4 v8, s[52:55], s58 offen offset:1024 lds
    buffer_load_dwordx4 v8, s[52:55], s58 offen offset:2048 lds
    buffer_load_dwordx4 v8, s[52:55], s58 offen offset:3072 lds
    s_add_u32 m0, s57, 40960
    s_nop 0
    buffer_load_dwordx4 v9, s[52:55], s58 offen lds
    s_waitcnt vmcnt(15)
    s_barrier
    s_mov_b32 s58, 112640
    s_add_u32 m0, s57, 55296
    s_nop 0
    buffer_load_dwordx4 v8, s[52:55], s58 offen offset:0 lds
    buffer_load_dwordx4 v8, s[52:55], s58 offen offset:1024 lds
    buffer_load_dwordx4 v8, s[52:55], s58 offen offset:2048 lds
    buffer_load_dwordx4 v8, s[52:55], s58 offen offset:3072 lds
    s_add_u32 m0, s57, 59392
    s_nop 0
    buffer_load_dwordx4 v9, s[52:55], s58 offen lds
    s_waitcnt vmcnt(15)
    s_barrier
    s_mov_b32 s58, 122880
    s_add_u32 m0, s57, 73728
    s_nop 0
    buffer_load_dwordx4 v8, s[52:55], s58 offen offset:0 lds
    buffer_load_dwordx4 v8, s[52:55], s58 offen offset:1024 lds
    buffer_load_dwordx4 v8, s[52:55], s58 offen offset:2048 lds
    buffer_load_dwordx4 v8, s[52:55], s58 offen offset:3072 lds
    s_add_u32 m0, s57, 77824
    s_nop 0
    buffer_load_dwordx4 v9, s[52:55], s58 offen lds
    s_waitcnt vmcnt(15)
    s_barrier
    s_mov_b32 s58, 133120
    s_add_u32 m0, s57, 92160
    s_nop 0
    buffer_load_dwordx4 v8, s[52:55], s58 offen offset:0 lds
    buffer_load_dwordx4 v8, s[52:55], s58 offen offset:1024 lds
    buffer_load_dwordx4 v8, s[52:55], s58 offen offset:2048 lds
    buffer_load_dwordx4 v8, s[52:55], s58 offen offset:3072 lds
    s_add_u32 m0, s57, 96256
    s_nop 0
    buffer_load_dwordx4 v9, s[52:55], s58 offen lds
    s_waitcnt vmcnt(15)
    s_barrier
    s_mov_b32 s58, 143360
    s_add_u32 m0, s57, 110592
    s_nop 0
    buffer_load_dwordx4 v8, s[52:55], s58 offen offset:0 lds
    buffer_load_dwordx4 v8, s[52:55], s58 offen offset:1024 lds
    buffer_load_dwordx4 v8, s[52:55], s58 offen offset:2048 lds
    buffer_load_dwordx4 v8, s[52:55], s58 offen offset:3072 lds
    s_add_u32 m0, s57, 114688
    s_nop 0
    buffer_load_dwordx4 v9, s[52:55], s58 offen lds
    s_waitcnt vmcnt(15)
    s_barrier
    s_mov_b32 s58, 153600
    s_add_u32 m0, s57, 129024
    s_nop 0
    buffer_load_dwordx4 v8, s[52:55], s58 offen offset:0 lds
    buffer_load_dwordx4 v8, s[52:55], s58 offen offset:1024 lds
    buffer_load_dwordx4 v8, s[52:55], s58 offen offset:2048 lds
    buffer_load_dwordx4 v8, s[52:55], s58 offen offset:3072 lds
    s_add_u32 m0, s57, 133120
    s_nop 0
    buffer_load_dwordx4 v9, s[52:55], s58 offen lds
    s_waitcnt vmcnt(15)
    s_barrier
    s_mov_b32 s58, 163840
    s_add_u32 m0, s57, 0
    s_nop 0
    buffer_load_dwordx4 v8, s[52:55], s58 offen offset:0 lds
    buffer_load_dwordx4 v8, s[52:55], s58 offen offset:1024 lds
    buffer_load_dwordx4 v8, s[52:55], s58 offen offset:2048 lds
    buffer_load_dwordx4 v8, s[52:55], s58 offen offset:3072 lds
    s_add_u32 m0, s57, 4096
    s_nop 0
    buffer_load_dwordx4 v9, s[52:55], s58 offen lds
    s_waitcnt vmcnt(15)
    s_barrier
    s_mov_b32 s58, 174080
    s_add_u32 m0, s57, 18432
    s_nop 0
    buffer_load_dwordx4 v8, s[52:55], s58 offen offset:0 lds
    buffer_load_dwordx4 v8, s[52:55], s58 offen offset:1024 lds
    buffer_load_dwordx4 v8, s[52:55], s58 offen offset:2048 lds
    buffer_load_dwordx4 v8, s[52:55], s58 offen offset:3072 lds
    s_add_u32 m0, s57, 22528
    s_nop 0
    buffer_load_dwordx4 v9, s[52:55], s58 offen lds
    s_waitcnt vmcnt(15)
    s_barrier
    s_mov_b32 s58, 184320
    s_add_u32 m0, s57, 36864
    s_nop 0
    buffer_load_dwordx4 v8, s[52:55], s58 offen offset:0 lds
    buffer_load_dwordx4 v8, s[52:55], s58 offen offset:1024 lds
    buffer_load_dwordx4 v8, s[52:55], s58 offen offset:2048 lds
    buffer_load_dwordx4 v8, s[52:55], s58 offen offset:3072 lds
    s_add_u32 m0, s57, 40960
    s_nop 0
    buffer_load_dwordx4 v9, s[52:55], s58 offen lds
    s_waitcnt vmcnt(15)
    s_barrier
    s_mov_b32 s58, 194560
    s_add_u32 m0, s57, 55296
    s_nop 0
    buffer_load_dwordx4 v8, s[52:55], s58 offen offset:0 lds
    buffer_load_dwordx4 v8, s[52:55], s58 offen offset:1024 lds
    buffer_load_dwordx4 v8, s[52:55], s58 offen offset:2048 lds
    buffer_load_dwordx4 v8, s[52:55], s58 offen offset:3072 lds
    s_add_u32 m0, s57, 59392
    s_nop 0
    buffer_load_dwordx4 v9, s[52:55], s58 offen lds
    s_waitcnt vmcnt(15)
    s_barrier
    s_mov_b32 s58, 204800
    s_add_u32 m0, s57, 73728
    s_nop 0
    buffer_load_dwordx4 v8, s[52:55], s58 offen offset:0 lds
    buffer_load_dwordx4 v8, s[52:55], s58 offen offset:1024 lds
    buffer_load_dwordx4 v8, s[52:55], s58 offen offset:2048 lds
    buffer_load_dwordx4 v8, s[52:55], s58 offen offset:3072 lds
    s_add_u32 m0, s57, 77824
    s_nop 0
    buffer_load_dwordx4 v9, s[52:55], s58 offen lds
    s_waitcnt vmcnt(15)
    s_barrier
    s_mov_b32 s58, 215040
    s_add_u32 m0, s57, 92160
    s_nop 0
    buffer_load_dwordx4 v8, s[52:55], s58 offen offset:0 lds
    buffer_load_dwordx4 v8, s[52:55], s58 offen offset:1024 lds
    buffer_load_dwordx4 v8, s[52:55], s58 offen offset:2048 lds
    buffer_load_dwordx4 v8, s[52:55], s58 offen offset:3072 lds
    s_add_u32 m0, s57, 96256
    s_nop 0
    buffer_load_dwordx4 v9, s[52:55], s58 offen lds
    s_waitcnt vmcnt(15)
    s_barrier
    s_mov_b32 s58, 225280
    s_add_u32 m0, s57, 110592
    s_nop 0
    buffer_load_dwordx4 v8, s[52:55], s58 offen offset:0 lds
    buffer_load_dwordx4 v8, s[52:55], s58 offen offset:1024 lds
    buffer_load_dwordx4 v8, s[52:55], s58 offen offset:2048 lds
    buffer_load_dwordx4 v8, s[52:55], s58 offen offset:3072 lds
    s_add_u32 m0, s57, 114688
    s_nop 0
    buffer_load_dwordx4 v9, s[52:55], s58 offen lds
    s_waitcnt vmcnt(15)
    s_barrier
    s_mov_b32 s58, 235520
    s_add_u32 m0, s57, 129024
    s_nop 0
    buffer_load_dwordx4 v8, s[52:55], s58 offen offset:0 lds
    buffer_load_dwordx4 v8, s[52:55], s58 offen offset:1024 lds
    buffer_load_dwordx4 v8, s[52:55], s58 offen offset:2048 lds
    buffer_load_dwordx4 v8, s[52:55], s58 offen offset:3072 lds
    s_add_u32 m0, s57, 133120
    s_nop 0
    buffer_load_dwordx4 v9, s[52:55], s58 offen lds
    s_waitcnt vmcnt(15)
    s_barrier
    s_waitcnt vmcnt(10)
    s_barrier
    s_waitcnt vmcnt(5)
    s_barrier
    s_waitcnt vmcnt(0)
    s_barrier
    s_barrier
    s_cmp_eq_u32 s98, 1
    s_cbranch_scc1 L_ch_exit
    s_add_u32 s52, s34, 33554432
    s_addc_u32 s53, s35, 0
    s_mov_b32 s54, 2686976
    s_mov_b32 s55, 0x00020000
    s_mul_i32 s10, s37, 167936
    s_mul_i32 s11, s9, 4096
    s_add_u32 s10, s10, s11
    v_lshl_add_u32 v8, v2, 4, s10
    v_add_u32 v9, 4096, v8
    s_add_u32 s57, s11, 8192

    s_mov_b32 s58, 0
    s_add_u32 m0, s57, 0
    s_nop 0
    buffer_load_dwordx4 v8, s[52:55], s58 offen offset:0 lds
    buffer_load_dwordx4 v8, s[52:55], s58 offen offset:1024 lds
    buffer_load_dwordx4 v8, s[52:55], s58 offen offset:2048 lds
    buffer_load_dwordx4 v8, s[52:55], s58 offen offset:3072 lds
    s_mov_b32 s58, 8192
    s_add_u32 m0, s57, 16384
    s_nop 0
    buffer_load_dwordx4 v8, s[52:55], s58 offen offset:0 lds
    buffer_load_dwordx4 v8, s[52:55], s58 offen offset:1024 lds
    buffer_load_dwordx4 v8, s[52:55], s58 offen offset:2048 lds
    buffer_load_dwordx4 v8, s[52:55], s58 offen offset:3072 lds
    s_mov_b32 s58, 16384
    s_add_u32 m0, s57, 32768
    s_nop 0
    buffer_load_dwordx4 v8, s[52:55], s58 offen offset:0 lds
    buffer_load_dwordx4 v8, s[52:55], s58 offen offset:1024 lds
    buffer_load_dwordx4 v8, s[52:55], s58 offen offset:2048 lds
    buffer_load_dwordx4 v8, s[52:55], s58 offen offset:3072 lds
    s_mov_b32 s58, 24576
    s_add_u32 m0, s57, 49152
    s_nop 0
    buffer_load_dwordx4 v8, s[52:55], s58 offen offset:0 lds
    buffer_load_dwordx4 v8, s[52:55], s58 offen offset:1024 lds
    buffer_load_dwordx4 v8, s[52:55], s58 offen offset:2048 lds
    buffer_load_dwordx4 v8, s[52:55], s58 offen offset:3072 lds
    s_barrier
    s_waitcnt vmcnt(12)
    s_barrier
    s_mov_b32 s58, 32768
    s_add_u32 m0, s57, 65536
    s_nop 0
    buffer_load_dwordx4 v8, s[52:55], s58 offen offset:0 lds
    buffer_load_dwordx4 v8, s[52:55], s58 offen offset:1024 lds
    buffer_load_dwordx4 v8, s[52:55], s58 offen offset:2048 lds
    buffer_load_dwordx4 v8, s[52:55], s58 offen offset:3072 lds
    s_waitcnt vmcnt(12)
    s_barrier
    s_mov_b32 s58, 40960
    s_add_u32 m0, s57, 81920
    s_nop 0
    buffer_load_dwordx4 v8, s[52:55], s58 offen offset:0 lds
    buffer_load_dwordx4 v8, s[52:55], s58 offen offset:1024 lds
    buffer_load_dwordx4 v8, s[52:55], s58 offen offset:2048 lds
    buffer_load_dwordx4 v8, s[52:55], s58 offen offset:3072 lds
    s_waitcnt vmcnt(12)
    s_barrier
    s_mov_b32 s58, 49152
    s_add_u32 m0, s57, 98304
    s_nop 0
    buffer_load_dwordx4 v8, s[52:55], s58 offen offset:0 lds
    buffer_load_dwordx4 v8, s[52:55], s58 offen offset:1024 lds
    buffer_load_dwordx4 v8, s[52:55], s58 offen offset:2048 lds
    buffer_load_dwordx4 v8, s[52:55], s58 offen offset:3072 lds
    s_waitcnt vmcnt(12)
    s_barrier
    s_mov_b32 s58, 57344
    s_add_u32 m0, s57, 114688
    s_nop 0
    buffer_load_dwordx4 v8, s[52:55], s58 offen offset:0 lds
    buffer_load_dwordx4 v8, s[52:55], s58 offen offset:1024 lds
    buffer_load_dwordx4 v8, s[52:55], s58 offen offset:2048 lds
    buffer_load_dwordx4 v8, s[52:55], s58 offen offset:3072 lds
    s_waitcnt vmcnt(12)
    s_barrier
    s_mov_b32 s58, 65536
    s_add_u32 m0, s57, 0
    s_nop 0
    buffer_load_dwordx4 v8, s[52:55], s58 offen offset:0 lds
    buffer_load_dwordx4 v8, s[52:55], s58 offen offset:1024 lds
    buffer_load_dwordx4 v8, s[52:55], s58 offen offset:2048 lds
    buffer_load_dwordx4 v8, s[52:55], s58 offen offset:3072 lds
    s_waitcnt vmcnt(12)
    s_barrier
    s_mov_b32 s58, 73728
    s_add_u32 m0, s57, 16384
    s_nop 0
    buffer_load_dwordx4 v8, s[52:55], s58 offen offset:0 lds
    buffer_load_dwordx4 v8, s[52:55], s58 offen offset:1024 lds
    buffer_load_dwordx4 v8, s[52:55], s58 offen offset:2048 lds
    buffer_load_dwordx4 v8, s[52:55], s58 offen offset:3072 lds
    s_waitcnt vmcnt(12)
    s_barrier
    s_mov_b32 s58, 81920
    s_add_u32 m0, s57, 32768
    s_nop 0
    buffer_load_dwordx4 v8, s[52:55], s58 offen offset:0 lds
    buffer_load_dwordx4 v8, s[52:55], s58 offen offset:1024 lds
    buffer_load_dwordx4 v8, s[52:55], s58 offen offset:2048 lds
    buffer_load_dwordx4 v8, s[52:55], s58 offen offset:3072 lds
    s_waitcnt vmcnt(12)
    s_barrier
    s_mov_b32 s58, 90112
    s_add_u32 m0, s57, 49152
    s_nop 0
    buffer_load_dwordx4 v8, s[52:55], s58 offen offset:0 lds
    buffer_load_dwordx4 v8, s[52:55], s58 offen offset:1024 lds
    buffer_load_dwordx4 v8, s[52:55], s58 offen offset:2048 lds
    buffer_load_dwordx4 v8, s[52:55], s58 offen offset:3072 lds
    s_waitcnt vmcnt(12)
    s_barrier
    s_mov_b32 s58, 98304
    s_add_u32 m0, s57, 65536
    s_nop 0
    buffer_load_dwordx4 v8, s[52:55], s58 offen offset:0 lds
    buffer_load_dwordx4 v8, s[52:55], s58 offen offset:1024 lds
    buffer_load_dwordx4 v8, s[52:55], s58 offen offset:2048 lds
    buffer_load_dwordx4 v8, s[52:55], s58 offen offset:3072 lds
    s_waitcnt vmcnt(12)
    s_barrier
    s_mov_b32 s58, 106496
    s_add_u32 m0, s57, 81920
    s_nop 0
    buffer_load_dwordx4 v8, s[52:55], s58 offen offset:0 lds
    buffer_load_dwordx4 v8, s[52:55], s58 offen offset:1024 lds
    buffer_load_dwordx4 v8, s[52:55], s58 offen offset:2048 lds
    buffer_load_dwordx4 v8, s[52:55], s58 offen offset:3072 lds
    s_waitcnt vmcnt(12)
    s_barrier
    s_mov_b32 s58, 114688
    s_add_u32 m0, s57, 98304
    s_nop 0
    buffer_load_dwordx4 v8, s[52:55], s58 offen offset:0 lds
    buffer_load_dwordx4 v8, s[52:55], s58 offen offset:1024 lds
    buffer_load_dwordx4 v8, s[52:55], s58 offen offset:2048 lds
    buffer_load_dwordx4 v8, s[52:55], s58 offen offset:3072 lds
    s_waitcnt vmcnt(12)
    s_barrier
    s_mov_b32 s58, 122880
    s_add_u32 m0, s57, 114688
    s_nop 0
    buffer_load_dwordx4 v8, s[52:55], s58 offen offset:0 lds
    buffer_load_dwordx4 v8, s[52:55], s58 offen offset:1024 lds
    buffer_load_dwordx4 v8, s[52:55], s58 offen offset:2048 lds
    buffer_load_dwordx4 v8, s[52:55], s58 offen offset:3072 lds
    s_waitcnt vmcnt(12)
    s_barrier
    s_mov_b32 s58, 131072
    s_add_u32 m0, s57, 0
    s_nop 0
    buffer_load_dwordx4 v8, s[52:55], s58 offen offset:0 lds
    buffer_load_dwordx4 v8, s[52:55], s58 offen offset:1024 lds
    buffer_load_dwordx4 v8, s[52:55], s58 offen offset:2048 lds
    buffer_load_dwordx4 v8, s[52:55], s58 offen offset:3072 lds
    s_waitcnt vmcnt(12)
    s_barrier
    s_mov_b32 s58, 139264
    s_add_u32 m0, s57, 16384
    s_nop 0
    buffer_load_dwordx4 v8, s[52:55], s58 offen offset:0 lds
    buffer_load_dwordx4 v8, s[52:55], s58 offen offset:1024 lds
    buffer_load_dwordx4 v8, s[52:55], s58 offen offset:2048 lds
    buffer_load_dwordx4 v8, s[52:55], s58 offen offset:3072 lds
    s_waitcnt vmcnt(12)
    s_barrier
    s_mov_b32 s58, 147456
    s_add_u32 m0, s57, 32768
    s_nop 0
    buffer_load_dwordx4 v8, s[52:55], s58 offen offset:0 lds
    buffer_load_dwordx4 v8, s[52:55], s58 offen offset:1024 lds
    buffer_load_dwordx4 v8, s[52:55], s58 offen offset:2048 lds
    buffer_load_dwordx4 v8, s[52:55], s58 offen offset:3072 lds
    s_waitcnt vmcnt(12)
    s_barrier
    s_mov_b32 s58, 155648
    s_add_u32 m0, s57, 49152
    s_nop 0
    buffer_load_dwordx4 v8, s[52:55], s58 offen offset:0 lds
    buffer_load_dwordx4 v8, s[52:55], s58 offen offset:1024 lds
    buffer_load_dwordx4 v8, s[52:55], s58 offen offset:2048 lds
    buffer_load_dwordx4 v8, s[52:55], s58 offen offset:3072 lds
    s_waitcnt vmcnt(12)
    s_barrier
    s_waitcnt vmcnt(8)
    s_barrier
    s_waitcnt vmcnt(4)
    s_barrier
    s_waitcnt vmcnt(0)
    s_barrier
    s_barrier
    s_branch L_ch_att
L_ch_xload:
    s_add_u32 s52, s34, 16777216
    s_addc_u32 s53, s35, 0
    s_mov_b32 s54, 2621440
    s_mov_b32 s55, 0x00020000
    s_lshl_b32 s55, s98, 26
    s_add_u32 s52, s52, s55
    s_addc_u32 s53, s53, 0
    s_mov_b32 s55, 0x00020000
    s_lshl_b32 s57, s9, 12
    s_lshl_b32 s10, s38, 2
    s_lshl_b32 s11, s9, 1
    s_add_u32 s10, s10, s11
    s_mul_i32 s10, s10, 20480
    v_lshl_add_u32 v8, v2, 4, s10
    v_add_u32 v9, 20480, v8

    s_cmp_eq_u32 s98, 0
    s_cbranch_scc1 L_noatt_102
    s_add_u32 s44, s34, 44564480
    s_addc_u32 s45, s35, 0
    s_mov_b32 s46, 46080
    s_mov_b32 s47, 0x00020000
    s_lshl_b32 s12, s38, 8
    s_lshl_b32 s13, s98, 13
    s_add_u32 s12, s12, s13
    s_add_u32 s12, s12, 28672
    v_lshl_add_u32 v10, v2, 2, s12
    s_mov_b32 s13, 200000
L_poll_103:
    buffer_load_dword v148, v10, s[44:47], 0 offen sc1
    s_waitcnt vmcnt(0)
    v_cmp_eq_u32 vcc, 1, v148
    s_nop 3
    s_cmp_eq_u64 vcc, -1
    s_cbranch_scc1 L_polled_104
    s_sleep 2
    s_sub_u32 s13, s13, 1
    s_cmp_lg_u32 s13, 0
    s_cbranch_scc1 L_poll_103

L_polled_104:
L_noatt_102:
    s_mov_b32 s58, 0
    s_add_u32 m0, s57, 0
    s_nop 0
    buffer_load_dwordx4 v8, s[52:55], s58 offen offset:0 sc1 lds
    buffer_load_dwordx4 v8, s[52:55], s58 offen offset:1024 sc1 lds
    s_add_u32 m0, s57, 2048
    s_nop 0
    buffer_load_dwordx4 v9, s[52:55], s58 offen offset:0 sc1 lds
    buffer_load_dwordx4 v9, s[52:55], s58 offen offset:1024 sc1 lds
    s_mov_b32 s58, 2048
    s_add_u32 m0, s57, 18432
    s_nop 0
    buffer_load_dwordx4 v8, s[52:55], s58 offen offset:0 sc1 lds
    buffer_load_dwordx4 v8, s[52:55], s58 offen offset:1024 sc1 lds
    s_add_u32 m0, s57, 20480
    s_nop 0
    buffer_load_dwordx4 v9, s[52:55], s58 offen offset:0 sc1 lds
    buffer_load_dwordx4 v9, s[52:55], s58 offen offset:1024 sc1 lds
    s_mov_b32 s58, 4096
    s_add_u32 m0, s57, 36864
    s_nop 0
    buffer_load_dwordx4 v8, s[52:55], s58 offen offset:0 sc1 lds
    buffer_load_dwordx4 v8, s[52:55], s58 offen offset:1024 sc1 lds
    s_add_u32 m0, s57, 38912
    s_nop 0
    buffer_load_dwordx4 v9, s[52:55], s58 offen offset:0 sc1 lds
    buffer_load_dwordx4 v9, s[52:55], s58 offen offset:1024 sc1 lds
    s_mov_b32 s58, 6144
    s_add_u32 m0, s57, 55296
    s_nop 0
    buffer_load_dwordx4 v8, s[52:55], s58 offen offset:0 sc1 lds
    buffer_load_dwordx4 v8, s[52:55], s58 offen offset:1024 sc1 lds
    s_add_u32 m0, s57, 57344
    s_nop 0
    buffer_load_dwordx4 v9, s[52:55], s58 offen offset:0 sc1 lds
    buffer_load_dwordx4 v9, s[52:55], s58 offen offset:1024 sc1 lds
    s_waitcnt vmcnt(12)
    s_barrier
    s_mov_b32 s58, 8192
    s_add_u32 m0, s57, 73728
    s_nop 0
    buffer_load_dwordx4 v8, s[52:55], s58 offen offset:0 sc1 lds
    buffer_load_dwordx4 v8, s[52:55], s58 offen offset:1024 sc1 lds
    s_add_u32 m0, s57, 75776
    s_nop 0
    buffer_load_dwordx4 v9, s[52:55], s58 offen offset:0 sc1 lds
    buffer_load_dwordx4 v9, s[52:55], s58 offen offset:1024 sc1 lds
    s_waitcnt vmcnt(12)
    s_barrier
    s_mov_b32 s58, 10240
    s_add_u32 m0, s57, 92160
    s_nop 0
    buffer_load_dwordx4 v8, s[52:55], s58 offen offset:0 sc1 lds
    buffer_load_dwordx4 v8, s[52:55], s58 offen offset:1024 sc1 lds
    s_add_u32 m0, s57, 94208
    s_nop 0
    buffer_load_dwordx4 v9, s[52:55], s58 offen offset:0 sc1 lds
    buffer_load_dwordx4 v9, s[52:55], s58 offen offset:1024 sc1 lds
    s_waitcnt vmcnt(12)
    s_barrier
    s_mov_b32 s58, 12288
    s_add_u32 m0, s57, 110592
    s_nop 0
    buffer_load_dwordx4 v8, s[52:55], s58 offen offset:0 sc1 lds
    buffer_load_dwordx4 v8, s[52:55], s58 offen offset:1024 sc1 lds
    s_add_u32 m0, s57, 112640
    s_nop 0
    buffer_load_dwordx4 v9, s[52:55], s58 offen offset:0 sc1 lds
    buffer_load_dwordx4 v9, s[52:55], s58 offen offset:1024 sc1 lds
    s_waitcnt vmcnt(12)
    s_barrier
    s_mov_b32 s58, 14336
    s_add_u32 m0, s57, 129024
    s_nop 0
    buffer_load_dwordx4 v8, s[52:55], s58 offen offset:0 sc1 lds
    buffer_load_dwordx4 v8, s[52:55], s58 offen offset:1024 sc1 lds
    s_add_u32 m0, s57, 131072
    s_nop 0
    buffer_load_dwordx4 v9, s[52:55], s58 offen offset:0 sc1 lds
    buffer_load_dwordx4 v9, s[52:55], s58 offen offset:1024 sc1 lds
    s_waitcnt vmcnt(12)
    s_barrier
    s_mov_b32 s58, 16384
    s_add_u32 m0, s57, 0
    s_nop 0
    buffer_load_dwordx4 v8, s[52:55], s58 offen offset:0 sc1 lds
    buffer_load_dwordx4 v8, s[52:55], s58 offen offset:1024 sc1 lds
    s_add_u32 m0, s57, 2048
    s_nop 0
    buffer_load_dwordx4 v9, s[52:55], s58 offen offset:0 sc1 lds
    buffer_load_dwordx4 v9, s[52:55], s58 offen offset:1024 sc1 lds
    s_waitcnt vmcnt(12)
    s_barrier
    s_mov_b32 s58, 18432
    s_add_u32 m0, s57, 18432
    s_nop 0
    buffer_load_dwordx4 v8, s[52:55], s58 offen offset:0 sc1 lds
    buffer_load_dwordx4 v8, s[52:55], s58 offen offset:1024 sc1 lds
    s_add_u32 m0, s57, 20480
    s_nop 0
    buffer_load_dwordx4 v9, s[52:55], s58 offen offset:0 sc1 lds
    buffer_load_dwordx4 v9, s[52:55], s58 offen offset:1024 sc1 lds
    s_waitcnt vmcnt(12)
    s_barrier
    s_waitcnt vmcnt(8)
    s_barrier
    s_waitcnt vmcnt(4)
    s_barrier
    s_waitcnt vmcnt(0)
    s_barrier
    s_barrier
    s_mov_b32 s52, s34
    s_mov_b32 s53, s35
    s_mov_b32 s54, 2621440
    s_mov_b32 s55, 0x00020000
    s_lshl_b32 s55, s98, 26
    s_add_u32 s52, s52, s55
    s_addc_u32 s53, s53, 0
    s_mov_b32 s55, 0x00020000
    s_lshl_b32 s10, s36, 2
    s_lshl_b32 s11, s9, 1
    s_add_u32 s10, s10, s11
    s_mul_i32 s10, s10, 40960
    v_lshl_add_u32 v8, v2, 4, s10
    v_add_u32 v9, 40960, v8
    s_lshl_b32 s57, s9, 12

    s_barrier
    s_add_u32 s44, s34, 44564480
    s_addc_u32 s45, s35, 0
    s_mov_b32 s46, 46080
    s_mov_b32 s47, 0x00020000
    s_mul_i32 s12, s98, 12288
    s_lshl_b32 s8, s36, 8
    s_add_u32 s12, s12, s8
    v_lshlrev_b32 v10, 2, v2
    s_mov_b32 s13, 200000

L_poll_105:
    buffer_load_dword v11, v10, s[44:47], s12 offen sc1
    s_waitcnt vmcnt(0)
    v_cmp_eq_u32 vcc, 1, v11
    s_nop 3
    s_cmp_eq_u64 vcc, -1
    s_cbranch_scc1 L_polled_106
    s_sleep 2
    s_sub_u32 s13, s13, 1
    s_cmp_lg_u32 s13, 0
    s_cbranch_scc1 L_poll_105

L_polled_106:
    s_mov_b32 s58, 0
    s_add_u32 m0, s57, 0
    s_nop 0
    buffer_load_dwordx4 v8, s[52:55], s58 offen offset:0 sc1 lds
    buffer_load_dwordx4 v8, s[52:55], s58 offen offset:1024 sc1 lds
    s_add_u32 m0, s57, 2048
    s_nop 0
    buffer_load_dwordx4 v9, s[52:55], s58 offen offset:0 sc1 lds
    buffer_load_dwordx4 v9, s[52:55], s58 offen offset:1024 sc1 lds
    s_mov_b32 s58, 2048
    s_add_u32 m0, s57, 20480
    s_nop 0
    buffer_load_dwordx4 v8, s[52:55], s58 offen offset:0 sc1 lds
    buffer_load_dwordx4 v8, s[52:55], s58 offen offset:1024 sc1 lds
    s_add_u32 m0, s57, 22528
    s_nop 0
    buffer_load_dwordx4 v9, s[52:55], s58 offen offset:0 sc1 lds
    buffer_load_dwordx4 v9, s[52:55], s58 offen offset:1024 sc1 lds
    s_mov_b32 s58, 4096
    s_add_u32 m0, s57, 40960
    s_nop 0
    buffer_load_dwordx4 v8, s[52:55], s58 offen offset:0 sc1 lds
    buffer_load_dwordx4 v8, s[52:55], s58 offen offset:1024 sc1 lds
    s_add_u32 m0, s57, 43008
    s_nop 0
    buffer_load_dwordx4 v9, s[52:55], s58 offen offset:0 sc1 lds
    buffer_load_dwordx4 v9, s[52:55], s58 offen offset:1024 sc1 lds
    s_mov_b32 s58, 6144
    s_add_u32 m0, s57, 61440
    s_nop 0
    buffer_load_dwordx4 v8, s[52:55], s58 offen offset:0 sc1 lds
    buffer_load_dwordx4 v8, s[52:55], s58 offen offset:1024 sc1 lds
    s_add_u32 m0, s57, 63488
    s_nop 0
    buffer_load_dwordx4 v9, s[52:55], s58 offen offset:0 sc1 lds
    buffer_load_dwordx4 v9, s[52:55], s58 offen offset:1024 sc1 lds
    s_waitcnt vmcnt(12)
    s_barrier
    s_mov_b32 s58, 8192
    s_add_u32 m0, s57, 81920
    s_nop 0
    buffer_load_dwordx4 v8, s[52:55], s58 offen offset:0 sc1 lds
    buffer_load_dwordx4 v8, s[52:55], s58 offen offset:1024 sc1 lds
    s_add_u32 m0, s57, 83968
    s_nop 0
    buffer_load_dwordx4 v9, s[52:55], s58 offen offset:0 sc1 lds
    buffer_load_dwordx4 v9, s[52:55], s58 offen offset:1024 sc1 lds
    s_waitcnt vmcnt(12)
    s_barrier
    s_mov_b32 s58, 10240
    s_add_u32 m0, s57, 102400
    s_nop 0
    buffer_load_dwordx4 v8, s[52:55], s58 offen offset:0 sc1 lds
    buffer_load_dwordx4 v8, s[52:55], s58 offen offset:1024 sc1 lds
    s_add_u32 m0, s57, 104448
    s_nop 0
    buffer_load_dwordx4 v9, s[52:55], s58 offen offset:0 sc1 lds
    buffer_load_dwordx4 v9, s[52:55], s58 offen offset:1024 sc1 lds
    s_waitcnt vmcnt(12)
    s_barrier
    s_mov_b32 s58, 12288
    s_add_u32 m0, s57, 122880
    s_nop 0
    buffer_load_dwordx4 v8, s[52:55], s58 offen offset:0 sc1 lds
    buffer_load_dwordx4 v8, s[52:55], s58 offen offset:1024 sc1 lds
    s_add_u32 m0, s57, 124928
    s_nop 0
    buffer_load_dwordx4 v9, s[52:55], s58 offen offset:0 sc1 lds
    buffer_load_dwordx4 v9, s[52:55], s58 offen offset:1024 sc1 lds
    s_waitcnt vmcnt(12)
    s_barrier
    s_mov_b32 s58, 14336
    s_add_u32 m0, s57, 143360
    s_nop 0
    buffer_load_dwordx4 v8, s[52:55], s58 offen offset:0 sc1 lds
    buffer_load_dwordx4 v8, s[52:55], s58 offen offset:1024 sc1 lds
    s_add_u32 m0, s57, 145408
    s_nop 0
    buffer_load_dwordx4 v9, s[52:55], s58 offen offset:0 sc1 lds
    buffer_load_dwordx4 v9, s[52:55], s58 offen offset:1024 sc1 lds
    s_waitcnt vmcnt(12)
    s_barrier
    s_mov_b32 s58, 16384
    s_add_u32 m0, s57, 0
    s_nop 0
    buffer_load_dwordx4 v8, s[52:55], s58 offen offset:0 sc1 lds
    buffer_load_dwordx4 v8, s[52:55], s58 offen offset:1024 sc1 lds
    s_add_u32 m0, s57, 2048
    s_nop 0
    buffer_load_dwordx4 v9, s[52:55], s58 offen offset:0 sc1 lds
    buffer_load_dwordx4 v9, s[52:55], s58 offen offset:1024 sc1 lds
    s_waitcnt vmcnt(12)
    s_barrier
    s_mov_b32 s58, 18432
    s_add_u32 m0, s57, 20480
    s_nop 0
    buffer_load_dwordx4 v8, s[52:55], s58 offen offset:0 sc1 lds
    buffer_load_dwordx4 v8, s[52:55], s58 offen offset:1024 sc1 lds
    s_add_u32 m0, s57, 22528
    s_nop 0
    buffer_load_dwordx4 v9, s[52:55], s58 offen offset:0 sc1 lds
    buffer_load_dwordx4 v9, s[52:55], s58 offen offset:1024 sc1 lds
    s_waitcnt vmcnt(12)
    s_barrier
    s_mov_b32 s58, 20480
    s_add_u32 m0, s57, 40960
    s_nop 0
    buffer_load_dwordx4 v8, s[52:55], s58 offen offset:0 sc1 lds
    buffer_load_dwordx4 v8, s[52:55], s58 offen offset:1024 sc1 lds
    s_add_u32 m0, s57, 43008
    s_nop 0
    buffer_load_dwordx4 v9, s[52:55], s58 offen offset:0 sc1 lds
    buffer_load_dwordx4 v9, s[52:55], s58 offen offset:1024 sc1 lds
    s_waitcnt vmcnt(12)
    s_barrier
    s_mov_b32 s58, 22528
    s_add_u32 m0, s57, 61440
    s_nop 0
    buffer_load_dwordx4 v8, s[52:55], s58 offen offset:0 sc1 lds
    buffer_load_dwordx4 v8, s[52:55], s58 offen offset:1024 sc1 lds
    s_add_u32 m0, s57, 63488
    s_nop 0
    buffer_load_dwordx4 v9, s[52:55], s58 offen offset:0 sc1 lds
    buffer_load_dwordx4 v9, s[52:55], s58 offen offset:1024 sc1 lds
    s_waitcnt vmcnt(12)
    s_barrier
    s_mov_b32 s58, 24576
    s_add_u32 m0, s57, 81920
    s_nop 0
    buffer_load_dwordx4 v8, s[52:55], s58 offen offset:0 sc1 lds
    buffer_load_dwordx4 v8, s[52:55], s58 offen offset:1024 sc1 lds
    s_add_u32 m0, s57, 83968
    s_nop 0
    buffer_load_dwordx4 v9, s[52:55], s58 offen offset:0 sc1 lds
    buffer_load_dwordx4 v9, s[52:55], s58 offen offset:1024 sc1 lds
    s_waitcnt vmcnt(12)
    s_barrier
    s_mov_b32 s58, 26624
    s_add_u32 m0, s57, 102400
    s_nop 0
    buffer_load_dwordx4 v8, s[52:55], s58 offen offset:0 sc1 lds
    buffer_load_dwordx4 v8, s[52:55], s58 offen offset:1024 sc1 lds
    s_add_u32 m0, s57, 104448
    s_nop 0
    buffer_load_dwordx4 v9, s[52:55], s58 offen offset:0 sc1 lds
    buffer_load_dwordx4 v9, s[52:55], s58 offen offset:1024 sc1 lds
    s_waitcnt vmcnt(12)
    s_barrier
    s_mov_b32 s58, 28672
    s_add_u32 m0, s57, 122880
    s_nop 0
    buffer_load_dwordx4 v8, s[52:55], s58 offen offset:0 sc1 lds
    buffer_load_dwordx4 v8, s[52:55], s58 offen offset:1024 sc1 lds
    s_add_u32 m0, s57, 124928
    s_nop 0
    buffer_load_dwordx4 v9, s[52:55], s58 offen offset:0 sc1 lds
    buffer_load_dwordx4 v9, s[52:55], s58 offen offset:1024 sc1 lds
    s_waitcnt vmcnt(12)
    s_barrier
    s_mov_b32 s58, 30720
    s_add_u32 m0, s57, 143360
    s_nop 0
    buffer_load_dwordx4 v8, s[52:55], s58 offen offset:0 sc1 lds
    buffer_load_dwordx4 v8, s[52:55], s58 offen offset:1024 sc1 lds
    s_add_u32 m0, s57, 145408
    s_nop 0
    buffer_load_dwordx4 v9, s[52:55], s58 offen offset:0 sc1 lds
    buffer_load_dwordx4 v9, s[52:55], s58 offen offset:1024 sc1 lds
    s_waitcnt vmcnt(12)
    s_barrier
    s_mov_b32 s58, 32768
    s_add_u32 m0, s57, 0
    s_nop 0
    buffer_load_dwordx4 v8, s[52:55], s58 offen offset:0 sc1 lds
    buffer_load_dwordx4 v8, s[52:55], s58 offen offset:1024 sc1 lds
    s_add_u32 m0, s57, 2048
    s_nop 0
    buffer_load_dwordx4 v9, s[52:55], s58 offen offset:0 sc1 lds
    buffer_load_dwordx4 v9, s[52:55], s58 offen offset:1024 sc1 lds
    s_waitcnt vmcnt(12)
    s_barrier
    s_mov_b32 s58, 34816
    s_add_u32 m0, s57, 20480
    s_nop 0
    buffer_load_dwordx4 v8, s[52:55], s58 offen offset:0 sc1 lds
    buffer_load_dwordx4 v8, s[52:55], s58 offen offset:1024 sc1 lds
    s_add_u32 m0, s57, 22528
    s_nop 0
    buffer_load_dwordx4 v9, s[52:55], s58 offen offset:0 sc1 lds
    buffer_load_dwordx4 v9, s[52:55], s58 offen offset:1024 sc1 lds
    s_waitcnt vmcnt(12)
    s_barrier
    s_mov_b32 s58, 36864
    s_add_u32 m0, s57, 40960
    s_nop 0
    buffer_load_dwordx4 v8, s[52:55], s58 offen offset:0 sc1 lds
    buffer_load_dwordx4 v8, s[52:55], s58 offen offset:1024 sc1 lds
    s_add_u32 m0, s57, 43008
    s_nop 0
    buffer_load_dwordx4 v9, s[52:55], s58 offen offset:0 sc1 lds
    buffer_load_dwordx4 v9, s[52:55], s58 offen offset:1024 sc1 lds
    s_waitcnt vmcnt(12)
    s_barrier
    s_mov_b32 s58, 38912
    s_add_u32 m0, s57, 61440
    s_nop 0
    buffer_load_dwordx4 v8, s[52:55], s58 offen offset:0 sc1 lds
    buffer_load_dwordx4 v8, s[52:55], s58 offen offset:1024 sc1 lds
    s_add_u32 m0, s57, 63488
    s_nop 0
    buffer_load_dwordx4 v9, s[52:55], s58 offen offset:0 sc1 lds
    buffer_load_dwordx4 v9, s[52:55], s58 offen offset:1024 sc1 lds
    s_waitcnt vmcnt(12)
    s_barrier
    s_waitcnt vmcnt(8)
    s_barrier
    s_waitcnt vmcnt(4)
    s_barrier
    s_waitcnt vmcnt(0)
    s_barrier
    s_barrier
    s_add_u32 s52, s34, 20971520
    s_addc_u32 s53, s35, 0
    s_mov_b32 s54, 6291456
    s_mov_b32 s55, 0x00020000
    s_lshl_b32 s55, s98, 26
    s_add_u32 s52, s52, s55
    s_addc_u32 s53, s53, 0
    s_mov_b32 s55, 0x00020000
    s_lshl_b32 s57, s9, 12
    s_lshl_b32 s10, s38, 2
    s_lshl_b32 s11, s9, 1
    s_add_u32 s10, s10, s11
    s_mul_i32 s10, s10, 49152
    v_lshl_add_u32 v8, v2, 4, s10
    v_add_u32 v9, 49152, v8

    s_barrier
    s_add_u32 s44, s34, 44564480
    s_addc_u32 s45, s35, 0
    s_mov_b32 s46, 46080
    s_mov_b32 s47, 0x00020000
    s_mul_i32 s12, s98, 12288
    s_lshl_b32 s8, s36, 8
    s_add_u32 s12, s12, s8
    s_add_u32 s12, s12, 4096
    v_lshlrev_b32 v10, 2, v2
    s_mov_b32 s13, 200000

L_poll_107:
    buffer_load_dword v11, v10, s[44:47], s12 offen sc1
    s_waitcnt vmcnt(0)
    v_cmp_eq_u32 vcc, 1, v11
    s_nop 3
    s_cmp_eq_u64 vcc, -1
    s_cbranch_scc1 L_polled_108
    s_sleep 2
    s_sub_u32 s13, s13, 1
    s_cmp_lg_u32 s13, 0
    s_cbranch_scc1 L_poll_107

L_polled_108:
    s_mov_b32 s58, 0
    s_add_u32 m0, s57, 0
    s_nop 0
    buffer_load_dwordx4 v8, s[52:55], s58 offen offset:0 sc1 lds
    buffer_load_dwordx4 v8, s[52:55], s58 offen offset:1024 sc1 lds
    s_add_u32 m0, s57, 2048
    s_nop 0
    buffer_load_dwordx4 v9, s[52:55], s58 offen offset:0 sc1 lds
    buffer_load_dwordx4 v9, s[52:55], s58 offen offset:1024 sc1 lds
    s_mov_b32 s58, 2048
    s_add_u32 m0, s57, 18432
    s_nop 0
    buffer_load_dwordx4 v8, s[52:55], s58 offen offset:0 sc1 lds
    buffer_load_dwordx4 v8, s[52:55], s58 offen offset:1024 sc1 lds
    s_add_u32 m0, s57, 20480
    s_nop 0
    buffer_load_dwordx4 v9, s[52:55], s58 offen offset:0 sc1 lds
    buffer_load_dwordx4 v9, s[52:55], s58 offen offset:1024 sc1 lds
    s_mov_b32 s58, 4096
    s_add_u32 m0, s57, 36864
    s_nop 0
    buffer_load_dwordx4 v8, s[52:55], s58 offen offset:0 sc1 lds
    buffer_load_dwordx4 v8, s[52:55], s58 offen offset:1024 sc1 lds
    s_add_u32 m0, s57, 38912
    s_nop 0
    buffer_load_dwordx4 v9, s[52:55], s58 offen offset:0 sc1 lds
    buffer_load_dwordx4 v9, s[52:55], s58 offen offset:1024 sc1 lds
    s_mov_b32 s58, 6144
    s_add_u32 m0, s57, 55296
    s_nop 0
    buffer_load_dwordx4 v8, s[52:55], s58 offen offset:0 sc1 lds
    buffer_load_dwordx4 v8, s[52:55], s58 offen offset:1024 sc1 lds
    s_add_u32 m0, s57, 57344
    s_nop 0
    buffer_load_dwordx4 v9, s[52:55], s58 offen offset:0 sc1 lds
    buffer_load_dwordx4 v9, s[52:55], s58 offen offset:1024 sc1 lds
    s_waitcnt vmcnt(12)
    s_barrier
    s_mov_b32 s58, 8192
    s_add_u32 m0, s57, 73728
    s_nop 0
    buffer_load_dwordx4 v8, s[52:55], s58 offen offset:0 sc1 lds
    buffer_load_dwordx4 v8, s[52:55], s58 offen offset:1024 sc1 lds
    s_add_u32 m0, s57, 75776
    s_nop 0
    buffer_load_dwordx4 v9, s[52:55], s58 offen offset:0 sc1 lds
    buffer_load_dwordx4 v9, s[52:55], s58 offen offset:1024 sc1 lds
    s_waitcnt vmcnt(12)
    s_barrier
    s_mov_b32 s58, 10240
    s_add_u32 m0, s57, 92160
    s_nop 0
    buffer_load_dwordx4 v8, s[52:55], s58 offen offset:0 sc1 lds
    buffer_load_dwordx4 v8, s[52:55], s58 offen offset:1024 sc1 lds
    s_add_u32 m0, s57, 94208
    s_nop 0
    buffer_load_dwordx4 v9, s[52:55], s58 offen offset:0 sc1 lds
    buffer_load_dwordx4 v9, s[52:55], s58 offen offset:1024 sc1 lds
    s_waitcnt vmcnt(12)
    s_barrier
    s_mov_b32 s58, 12288
    s_add_u32 m0, s57, 110592
    s_nop 0
    buffer_load_dwordx4 v8, s[52:55], s58 offen offset:0 sc1 lds
    buffer_load_dwordx4 v8, s[52:55], s58 offen offset:1024 sc1 lds
    s_add_u32 m0, s57, 112640
    s_nop 0
    buffer_load_dwordx4 v9, s[52:55], s58 offen offset:0 sc1 lds
    buffer_load_dwordx4 v9, s[52:55], s58 offen offset:1024 sc1 lds
    s_waitcnt vmcnt(12)
    s_barrier
    s_mov_b32 s58, 14336
    s_add_u32 m0, s57, 129024
    s_nop 0
    buffer_load_dwordx4 v8, s[52:55], s58 offen offset:0 sc1 lds
    buffer_load_dwordx4 v8, s[52:55], s58 offen offset:1024 sc1 lds
    s_add_u32 m0, s57, 131072
    s_nop 0
    buffer_load_dwordx4 v9, s[52:55], s58 offen offset:0 sc1 lds
    buffer_load_dwordx4 v9, s[52:55], s58 offen offset:1024 sc1 lds
    s_waitcnt vmcnt(12)
    s_barrier
    s_mov_b32 s58, 16384
    s_add_u32 m0, s57, 0
    s_nop 0
    buffer_load_dwordx4 v8, s[52:55], s58 offen offset:0 sc1 lds
    buffer_load_dwordx4 v8, s[52:55], s58 offen offset:1024 sc1 lds
    s_add_u32 m0, s57, 2048
    s_nop 0
    buffer_load_dwordx4 v9, s[52:55], s58 offen offset:0 sc1 lds
    buffer_load_dwordx4 v9, s[52:55], s58 offen offset:1024 sc1 lds
    s_waitcnt vmcnt(12)
    s_barrier
    s_mov_b32 s58, 18432
    s_add_u32 m0, s57, 18432
    s_nop 0
    buffer_load_dwordx4 v8, s[52:55], s58 offen offset:0 sc1 lds
    buffer_load_dwordx4 v8, s[52:55], s58 offen offset:1024 sc1 lds
    s_add_u32 m0, s57, 20480
    s_nop 0
    buffer_load_dwordx4 v9, s[52:55], s58 offen offset:0 sc1 lds
    buffer_load_dwordx4 v9, s[52:55], s58 offen offset:1024 sc1 lds
    s_waitcnt vmcnt(12)
    s_barrier
    s_mov_b32 s58, 20480
    s_add_u32 m0, s57, 36864
    s_nop 0
    buffer_load_dwordx4 v8, s[52:55], s58 offen offset:0 sc1 lds
    buffer_load_dwordx4 v8, s[52:55], s58 offen offset:1024 sc1 lds
    s_add_u32 m0, s57, 38912
    s_nop 0
    buffer_load_dwordx4 v9, s[52:55], s58 offen offset:0 sc1 lds
    buffer_load_dwordx4 v9, s[52:55], s58 offen offset:1024 sc1 lds
    s_waitcnt vmcnt(12)
    s_barrier
    s_mov_b32 s58, 22528
    s_add_u32 m0, s57, 55296
    s_nop 0
    buffer_load_dwordx4 v8, s[52:55], s58 offen offset:0 sc1 lds
    buffer_load_dwordx4 v8, s[52:55], s58 offen offset:1024 sc1 lds
    s_add_u32 m0, s57, 57344
    s_nop 0
    buffer_load_dwordx4 v9, s[52:55], s58 offen offset:0 sc1 lds
    buffer_load_dwordx4 v9, s[52:55], s58 offen offset:1024 sc1 lds
    s_waitcnt vmcnt(12)
    s_barrier
    s_mov_b32 s58, 24576
    s_add_u32 m0, s57, 73728
    s_nop 0
    buffer_load_dwordx4 v8, s[52:55], s58 offen offset:0 sc1 lds
    buffer_load_dwordx4 v8, s[52:55], s58 offen offset:1024 sc1 lds
    s_add_u32 m0, s57, 75776
    s_nop 0
    buffer_load_dwordx4 v9, s[52:55], s58 offen offset:0 sc1 lds
    buffer_load_dwordx4 v9, s[52:55], s58 offen offset:1024 sc1 lds
    s_waitcnt vmcnt(12)
    s_barrier
    s_mov_b32 s58, 26624
    s_add_u32 m0, s57, 92160
    s_nop 0
    buffer_load_dwordx4 v8, s[52:55], s58 offen offset:0 sc1 lds
    buffer_load_dwordx4 v8, s[52:55], s58 offen offset:1024 sc1 lds
    s_add_u32 m0, s57, 94208
    s_nop 0
    buffer_load_dwordx4 v9, s[52:55], s58 offen offset:0 sc1 lds
    buffer_load_dwordx4 v9, s[52:55], s58 offen offset:1024 sc1 lds
    s_waitcnt vmcnt(12)
    s_barrier
    s_mov_b32 s58, 28672
    s_add_u32 m0, s57, 110592
    s_nop 0
    buffer_load_dwordx4 v8, s[52:55], s58 offen offset:0 sc1 lds
    buffer_load_dwordx4 v8, s[52:55], s58 offen offset:1024 sc1 lds
    s_add_u32 m0, s57, 112640
    s_nop 0
    buffer_load_dwordx4 v9, s[52:55], s58 offen offset:0 sc1 lds
    buffer_load_dwordx4 v9, s[52:55], s58 offen offset:1024 sc1 lds
    s_waitcnt vmcnt(12)
    s_barrier
    s_mov_b32 s58, 30720
    s_add_u32 m0, s57, 129024
    s_nop 0
    buffer_load_dwordx4 v8, s[52:55], s58 offen offset:0 sc1 lds
    buffer_load_dwordx4 v8, s[52:55], s58 offen offset:1024 sc1 lds
    s_add_u32 m0, s57, 131072
    s_nop 0
    buffer_load_dwordx4 v9, s[52:55], s58 offen offset:0 sc1 lds
    buffer_load_dwordx4 v9, s[52:55], s58 offen offset:1024 sc1 lds
    s_waitcnt vmcnt(12)
    s_barrier
    s_mov_b32 s58, 32768
    s_add_u32 m0, s57, 0
    s_nop 0
    buffer_load_dwordx4 v8, s[52:55], s58 offen offset:0 sc1 lds
    buffer_load_dwordx4 v8, s[52:55], s58 offen offset:1024 sc1 lds
    s_add_u32 m0, s57, 2048
    s_nop 0
    buffer_load_dwordx4 v9, s[52:55], s58 offen offset:0 sc1 lds
    buffer_load_dwordx4 v9, s[52:55], s58 offen offset:1024 sc1 lds
    s_waitcnt vmcnt(12)
    s_barrier
    s_mov_b32 s58, 34816
    s_add_u32 m0, s57, 18432
    s_nop 0
    buffer_load_dwordx4 v8, s[52:55], s58 offen offset:0 sc1 lds
    buffer_load_dwordx4 v8, s[52:55], s58 offen offset:1024 sc1 lds
    s_add_u32 m0, s57, 20480
    s_nop 0
    buffer_load_dwordx4 v9, s[52:55], s58 offen offset:0 sc1 lds
    buffer_load_dwordx4 v9, s[52:55], s58 offen offset:1024 sc1 lds
    s_waitcnt vmcnt(12)
    s_barrier
    s_mov_b32 s58, 36864
    s_add_u32 m0, s57, 36864
    s_nop 0
    buffer_load_dwordx4 v8, s[52:55], s58 offen offset:0 sc1 lds
    buffer_load_dwordx4 v8, s[52:55], s58 offen offset:1024 sc1 lds
    s_add_u32 m0, s57, 38912
    s_nop 0
    buffer_load_dwordx4 v9, s[52:55], s58 offen offset:0 sc1 lds
    buffer_load_dwordx4 v9, s[52:55], s58 offen offset:1024 sc1 lds
    s_waitcnt vmcnt(12)
    s_barrier
    s_mov_b32 s58, 38912
    s_add_u32 m0, s57, 55296
    s_nop 0
    buffer_load_dwordx4 v8, s[52:55], s58 offen offset:0 sc1 lds
    buffer_load_dwordx4 v8, s[52:55], s58 offen offset:1024 sc1 lds
    s_add_u32 m0, s57, 57344
    s_nop 0
    buffer_load_dwordx4 v9, s[52:55], s58 offen offset:0 sc1 lds
    buffer_load_dwordx4 v9, s[52:55], s58 offen offset:1024 sc1 lds
    s_waitcnt vmcnt(12)
    s_barrier
    s_mov_b32 s58, 40960
    s_add_u32 m0, s57, 73728
    s_nop 0
    buffer_load_dwordx4 v8, s[52:55], s58 offen offset:0 sc1 lds
    buffer_load_dwordx4 v8, s[52:55], s58 offen offset:1024 sc1 lds
    s_add_u32 m0, s57, 75776
    s_nop 0
    buffer_load_dwordx4 v9, s[52:55], s58 offen offset:0 sc1 lds
    buffer_load_dwordx4 v9, s[52:55], s58 offen offset:1024 sc1 lds
    s_waitcnt vmcnt(12)
    s_barrier
    s_mov_b32 s58, 43008
    s_add_u32 m0, s57, 92160
    s_nop 0
    buffer_load_dwordx4 v8, s[52:55], s58 offen offset:0 sc1 lds
    buffer_load_dwordx4 v8, s[52:55], s58 offen offset:1024 sc1 lds
    s_add_u32 m0, s57, 94208
    s_nop 0
    buffer_load_dwordx4 v9, s[52:55], s58 offen offset:0 sc1 lds
    buffer_load_dwordx4 v9, s[52:55], s58 offen offset:1024 sc1 lds
    s_waitcnt vmcnt(12)
    s_barrier
    s_mov_b32 s58, 45056
    s_add_u32 m0, s57, 110592
    s_nop 0
    buffer_load_dwordx4 v8, s[52:55], s58 offen offset:0 sc1 lds
    buffer_load_dwordx4 v8, s[52:55], s58 offen offset:1024 sc1 lds
    s_add_u32 m0, s57, 112640
    s_nop 0
    buffer_load_dwordx4 v9, s[52:55], s58 offen offset:0 sc1 lds
    buffer_load_dwordx4 v9, s[52:55], s58 offen offset:1024 sc1 lds
    s_waitcnt vmcnt(12)
    s_barrier
    s_mov_b32 s58, 47104
    s_add_u32 m0, s57, 129024
    s_nop 0
    buffer_load_dwordx4 v8, s[52:55], s58 offen offset:0 sc1 lds
    buffer_load_dwordx4 v8, s[52:55], s58 offen offset:1024 sc1 lds
    s_add_u32 m0, s57, 131072
    s_nop 0
    buffer_load_dwordx4 v9, s[52:55], s58 offen offset:0 sc1 lds
    buffer_load_dwordx4 v9, s[52:55], s58 offen offset:1024 sc1 lds
    s_waitcnt vmcnt(12)
    s_barrier
    s_waitcnt vmcnt(8)
    s_barrier
    s_waitcnt vmcnt(4)
    s_barrier
    s_waitcnt vmcnt(0)
    s_barrier
    s_barrier
    s_cmp_eq_u32 s98, 1
    s_cbranch_scc1 L_ch_exit
    s_add_u32 s52, s34, 3145728
    s_addc_u32 s53, s35, 0
    s_mov_b32 s54, 2621440
    s_mov_b32 s55, 0x00020000
    s_lshl_b32 s55, s98, 26
    s_add_u32 s52, s52, s55
    s_addc_u32 s53, s53, 0
    s_mov_b32 s55, 0x00020000
    s_lshl_b32 s10, s36, 2
    s_lshl_b32 s11, s9, 1
    s_add_u32 s10, s10, s11
    s_mul_i32 s10, s10, 40960
    v_lshl_add_u32 v8, v2, 4, s10
    v_add_u32 v9, 40960, v8
    s_lshl_b32 s57, s9, 12

    s_barrier
    s_add_u32 s44, s34, 44564480
    s_addc_u32 s45, s35, 0
    s_mov_b32 s46, 46080
    s_mov_b32 s47, 0x00020000
    s_mul_i32 s12, s98, 12288
    s_lshl_b32 s8, s36, 8
    s_add_u32 s12, s12, s8
    s_add_u32 s12, s12, 8192
    v_lshlrev_b32 v10, 2, v2
    s_mov_b32 s13, 200000

L_poll_109:
    buffer_load_dword v11, v10, s[44:47], s12 offen sc1
    s_waitcnt vmcnt(0)
    v_cmp_eq_u32 vcc, 1, v11
    s_nop 3
    s_cmp_eq_u64 vcc, -1
    s_cbranch_scc1 L_polled_110
    s_sleep 2
    s_sub_u32 s13, s13, 1
    s_cmp_lg_u32 s13, 0
    s_cbranch_scc1 L_poll_109

L_polled_110:
    s_mov_b32 s58, 0
    s_add_u32 m0, s57, 0
    s_nop 0
    buffer_load_dwordx4 v8, s[52:55], s58 offen offset:0 sc1 lds
    buffer_load_dwordx4 v8, s[52:55], s58 offen offset:1024 sc1 lds
    s_add_u32 m0, s57, 2048
    s_nop 0
    buffer_load_dwordx4 v9, s[52:55], s58 offen offset:0 sc1 lds
    buffer_load_dwordx4 v9, s[52:55], s58 offen offset:1024 sc1 lds
    s_mov_b32 s58, 2048
    s_add_u32 m0, s57, 16384
    s_nop 0
    buffer_load_dwordx4 v8, s[52:55], s58 offen offset:0 sc1 lds
    buffer_load_dwordx4 v8, s[52:55], s58 offen offset:1024 sc1 lds
    s_add_u32 m0, s57, 18432
    s_nop 0
    buffer_load_dwordx4 v9, s[52:55], s58 offen offset:0 sc1 lds
    buffer_load_dwordx4 v9, s[52:55], s58 offen offset:1024 sc1 lds
    s_mov_b32 s58, 4096
    s_add_u32 m0, s57, 32768
    s_nop 0
    buffer_load_dwordx4 v8, s[52:55], s58 offen offset:0 sc1 lds
    buffer_load_dwordx4 v8, s[52:55], s58 offen offset:1024 sc1 lds
    s_add_u32 m0, s57, 34816
    s_nop 0
    buffer_load_dwordx4 v9, s[52:55], s58 offen offset:0 sc1 lds
    buffer_load_dwordx4 v9, s[52:55], s58 offen offset:1024 sc1 lds
    s_mov_b32 s58, 6144
    s_add_u32 m0, s57, 49152
    s_nop 0
    buffer_load_dwordx4 v8, s[52:55], s58 offen offset:0 sc1 lds
    buffer_load_dwordx4 v8, s[52:55], s58 offen offset:1024 sc1 lds
    s_add_u32 m0, s57, 51200
    s_nop 0
    buffer_load_dwordx4 v9, s[52:55], s58 offen offset:0 sc1 lds
    buffer_load_dwordx4 v9, s[52:55], s58 offen offset:1024 sc1 lds
    s_waitcnt vmcnt(12)
    s_barrier
    s_mov_b32 s58, 8192
    s_add_u32 m0, s57, 65536
    s_nop 0
    buffer_load_dwordx4 v8, s[52:55], s58 offen offset:0 sc1 lds
    buffer_load_dwordx4 v8, s[52:55], s58 offen offset:1024 sc1 lds
    s_add_u32 m0, s57, 67584
    s_nop 0
    buffer_load_dwordx4 v9, s[52:55], s58 offen offset:0 sc1 lds
    buffer_load_dwordx4 v9, s[52:55], s58 offen offset:1024 sc1 lds
    s_waitcnt vmcnt(12)
    s_barrier
    s_mov_b32 s58, 10240
    s_add_u32 m0, s57, 81920
    s_nop 0
    buffer_load_dwordx4 v8, s[52:55], s58 offen offset:0 sc1 lds
    buffer_load_dwordx4 v8, s[52:55], s58 offen offset:1024 sc1 lds
    s_add_u32 m0, s57, 83968
    s_nop 0
    buffer_load_dwordx4 v9, s[52:55], s58 offen offset:0 sc1 lds
    buffer_load_dwordx4 v9, s[52:55], s58 offen offset:1024 sc1 lds
    s_waitcnt vmcnt(12)
    s_barrier
    s_mov_b32 s58, 12288
    s_add_u32 m0, s57, 98304
    s_nop 0
    buffer_load_dwordx4 v8, s[52:55], s58 offen offset:0 sc1 lds
    buffer_load_dwordx4 v8, s[52:55], s58 offen offset:1024 sc1 lds
    s_add_u32 m0, s57, 100352
    s_nop 0
    buffer_load_dwordx4 v9, s[52:55], s58 offen offset:0 sc1 lds
    buffer_load_dwordx4 v9, s[52:55], s58 offen offset:1024 sc1 lds
    s_waitcnt vmcnt(12)
    s_barrier
    s_mov_b32 s58, 14336
    s_add_u32 m0, s57, 114688
    s_nop 0
    buffer_load_dwordx4 v8, s[52:55], s58 offen offset:0 sc1 lds
    buffer_load_dwordx4 v8, s[52:55], s58 offen offset:1024 sc1 lds
    s_add_u32 m0, s57, 116736
    s_nop 0
    buffer_load_dwordx4 v9, s[52:55], s58 offen offset:0 sc1 lds
    buffer_load_dwordx4 v9, s[52:55], s58 offen offset:1024 sc1 lds
    s_waitcnt vmcnt(12)
    s_barrier
    s_mov_b32 s58, 16384
    s_add_u32 m0, s57, 0
    s_nop 0
    buffer_load_dwordx4 v8, s[52:55], s58 offen offset:0 sc1 lds
    buffer_load_dwordx4 v8, s[52:55], s58 offen offset:1024 sc1 lds
    s_add_u32 m0, s57, 2048
    s_nop 0
    buffer_load_dwordx4 v9, s[52:55], s58 offen offset:0 sc1 lds
    buffer_load_dwordx4 v9, s[52:55], s58 offen offset:1024 sc1 lds
    s_waitcnt vmcnt(12)
    s_barrier
    s_mov_b32 s58, 18432
    s_add_u32 m0, s57, 16384
    s_nop 0
    buffer_load_dwordx4 v8, s[52:55], s58 offen offset:0 sc1 lds
    buffer_load_dwordx4 v8, s[52:55], s58 offen offset:1024 sc1 lds
    s_add_u32 m0, s57, 18432
    s_nop 0
    buffer_load_dwordx4 v9, s[52:55], s58 offen offset:0 sc1 lds
    buffer_load_dwordx4 v9, s[52:55], s58 offen offset:1024 sc1 lds
    s_waitcnt vmcnt(12)
    s_barrier
    s_mov_b32 s58, 20480
    s_add_u32 m0, s57, 32768
    s_nop 0
    buffer_load_dwordx4 v8, s[52:55], s58 offen offset:0 sc1 lds
    buffer_load_dwordx4 v8, s[52:55], s58 offen offset:1024 sc1 lds
    s_add_u32 m0, s57, 34816
    s_nop 0
    buffer_load_dwordx4 v9, s[52:55], s58 offen offset:0 sc1 lds
    buffer_load_dwordx4 v9, s[52:55], s58 offen offset:1024 sc1 lds
    s_waitcnt vmcnt(12)
    s_barrier
    s_mov_b32 s58, 22528
    s_add_u32 m0, s57, 49152
    s_nop 0
    buffer_load_dwordx4 v8, s[52:55], s58 offen offset:0 sc1 lds
    buffer_load_dwordx4 v8, s[52:55], s58 offen offset:1024 sc1 lds
    s_add_u32 m0, s57, 51200
    s_nop 0
    buffer_load_dwordx4 v9, s[52:55], s58 offen offset:0 sc1 lds
    buffer_load_dwordx4 v9, s[52:55], s58 offen offset:1024 sc1 lds
    s_waitcnt vmcnt(12)
    s_barrier
    s_mov_b32 s58, 24576
    s_add_u32 m0, s57, 65536
    s_nop 0
    buffer_load_dwordx4 v8, s[52:55], s58 offen offset:0 sc1 lds
    buffer_load_dwordx4 v8, s[52:55], s58 offen offset:1024 sc1 lds
    s_add_u32 m0, s57, 67584
    s_nop 0
    buffer_load_dwordx4 v9, s[52:55], s58 offen offset:0 sc1 lds
    buffer_load_dwordx4 v9, s[52:55], s58 offen offset:1024 sc1 lds
    s_waitcnt vmcnt(12)
    s_barrier
    s_mov_b32 s58, 26624
    s_add_u32 m0, s57, 81920
    s_nop 0
    buffer_load_dwordx4 v8, s[52:55], s58 offen offset:0 sc1 lds
    buffer_load_dwordx4 v8, s[52:55], s58 offen offset:1024 sc1 lds
    s_add_u32 m0, s57, 83968
    s_nop 0
    buffer_load_dwordx4 v9, s[52:55], s58 offen offset:0 sc1 lds
    buffer_load_dwordx4 v9, s[52:55], s58 offen offset:1024 sc1 lds
    s_waitcnt vmcnt(12)
    s_barrier
    s_mov_b32 s58, 28672
    s_add_u32 m0, s57, 98304
    s_nop 0
    buffer_load_dwordx4 v8, s[52:55], s58 offen offset:0 sc1 lds
    buffer_load_dwordx4 v8, s[52:55], s58 offen offset:1024 sc1 lds
    s_add_u32 m0, s57, 100352
    s_nop 0
    buffer_load_dwordx4 v9, s[52:55], s58 offen offset:0 sc1 lds
    buffer_load_dwordx4 v9, s[52:55], s58 offen offset:1024 sc1 lds
    s_waitcnt vmcnt(12)
    s_barrier
    s_mov_b32 s58, 30720
    s_add_u32 m0, s57, 114688
    s_nop 0
    buffer_load_dwordx4 v8, s[52:55], s58 offen offset:0 sc1 lds
    buffer_load_dwordx4 v8, s[52:55], s58 offen offset:1024 sc1 lds
    s_add_u32 m0, s57, 116736
    s_nop 0
    buffer_load_dwordx4 v9, s[52:55], s58 offen offset:0 sc1 lds
    buffer_load_dwordx4 v9, s[52:55], s58 offen offset:1024 sc1 lds
    s_waitcnt vmcnt(12)
    s_barrier
    s_mov_b32 s58, 32768
    s_add_u32 m0, s57, 0
    s_nop 0
    buffer_load_dwordx4 v8, s[52:55], s58 offen offset:0 sc1 lds
    buffer_load_dwordx4 v8, s[52:55], s58 offen offset:1024 sc1 lds
    s_add_u32 m0, s57, 2048
    s_nop 0
    buffer_load_dwordx4 v9, s[52:55], s58 offen offset:0 sc1 lds
    buffer_load_dwordx4 v9, s[52:55], s58 offen offset:1024 sc1 lds
    s_waitcnt vmcnt(12)
    s_barrier
    s_mov_b32 s58, 34816
    s_add_u32 m0, s57, 16384
    s_nop 0
    buffer_load_dwordx4 v8, s[52:55], s58 offen offset:0 sc1 lds
    buffer_load_dwordx4 v8, s[52:55], s58 offen offset:1024 sc1 lds
    s_add_u32 m0, s57, 18432
    s_nop 0
    buffer_load_dwordx4 v9, s[52:55], s58 offen offset:0 sc1 lds
    buffer_load_dwordx4 v9, s[52:55], s58 offen offset:1024 sc1 lds
    s_waitcnt vmcnt(12)
    s_barrier
    s_mov_b32 s58, 36864
    s_add_u32 m0, s57, 32768
    s_nop 0
    buffer_load_dwordx4 v8, s[52:55], s58 offen offset:0 sc1 lds
    buffer_load_dwordx4 v8, s[52:55], s58 offen offset:1024 sc1 lds
    s_add_u32 m0, s57, 34816
    s_nop 0
    buffer_load_dwordx4 v9, s[52:55], s58 offen offset:0 sc1 lds
    buffer_load_dwordx4 v9, s[52:55], s58 offen offset:1024 sc1 lds
    s_waitcnt vmcnt(12)
    s_barrier
    s_mov_b32 s58, 38912
    s_add_u32 m0, s57, 49152
    s_nop 0
    buffer_load_dwordx4 v8, s[52:55], s58 offen offset:0 sc1 lds
    buffer_load_dwordx4 v8, s[52:55], s58 offen offset:1024 sc1 lds
    s_add_u32 m0, s57, 51200
    s_nop 0
    buffer_load_dwordx4 v9, s[52:55], s58 offen offset:0 sc1 lds
    buffer_load_dwordx4 v9, s[52:55], s58 offen offset:1024 sc1 lds
    s_waitcnt vmcnt(12)
    s_barrier
    s_waitcnt vmcnt(8)
    s_barrier
    s_waitcnt vmcnt(4)
    s_barrier
    s_waitcnt vmcnt(0)
    s_barrier
    s_barrier
    s_branch L_ch_att
L_ch_compute:
    s_mov_b32 s40, s94
    s_mov_b32 s41, s95
    s_mov_b32 s42, 2621440
    s_mov_b32 s43, 0x00020000
    s_mov_b32 s48, s34
    s_mov_b32 s49, s35
    s_mov_b32 s50, 2621440
    s_mov_b32 s51, 0x00020000
    s_lshl_b32 s51, s98, 26
    s_add_u32 s48, s48, s51
    s_addc_u32 s49, s49, 0
    s_mov_b32 s51, 0x00020000
    s_add_u32 s56, s34, 44302336
    s_addc_u32 s57, s35, 0
    s_mov_b32 s58, 131072
    s_mov_b32 s59, 0x00020000
    s_lshl_b32 s59, s98, 26
    s_add_u32 s56, s56, s59
    s_addc_u32 s57, s57, 0
    s_mov_b32 s59, 0x00020000
    s_lshl_b32 s10, s38, 6
    s_lshl_b32 s11, s7, 4
    s_add_u32 s10, s10, s11
    v_and_b32 v4, 15, v2
    v_add_u32 v4, s10, v4
    v_and_b32 v9, 63, v4
    v_lshlrev_b32 v9, 3, v9
    v_lshrrev_b32 v1, 4, v2
    s_lshr_b32 s10, s10, 5
    s_mul_i32 s10, s10, 40960
    s_mul_i32 s11, s39, 5120
    s_add_u32 s10, s10, s11
    v_and_b32 v5, 31, v4
    v_lshl_add_u32 v5, v5, 4, s10
    v_lshrrev_b32 v6, 1, v1
    v_lshl_add_u32 v5, v6, 9, v5
    v_and_b32 v6, 1, v1
    v_lshl_add_u32 v3, v6, 3, v5
    v_lshl_add_u32 v112, v6, 10, v5
    s_movk_i32 s62, 0x1000
    v_mul_u32_u24 v4, 1280, v4
    s_mul_i32 s11, s39, 160
    v_add_u32 v4, s11, v4
    v_lshl_add_u32 v8, v1, 3, v4
    v_lshl_add_u32 v113, v6, 5, v4
    v_lshrrev_b32 v6, 1, v1
    v_lshl_add_u32 v113, v6, 4, v113

    s_cmp_eq_u32 s98, 0
    s_cbranch_scc1 L_ch_g2_rres
    buffer_load_dwordx2 v[10:11], v3, s[40:43], 0 offen offset:0 sc1
    buffer_load_dwordx2 v[12:13], v3, s[40:43], 0 offen offset:1024 sc1
    buffer_load_dwordx2 v[14:15], v3, s[40:43], 0 offen offset:2048 sc1
    buffer_load_dwordx2 v[16:17], v3, s[40:43], 0 offen offset:3072 sc1
    buffer_load_dwordx2 v[18:19], v3, s[40:43], s62 offen sc1
    s_branch L_ch_g2_resdone
L_ch_g2_rres:
    buffer_load_dwordx2 v[10:11], v8, s[40:43], 0 offen offset:0
    buffer_load_dwordx2 v[12:13], v8, s[40:43], 0 offen offset:32
    buffer_load_dwordx2 v[14:15], v8, s[40:43], 0 offen offset:64
    buffer_load_dwordx2 v[16:17], v8, s[40:43], 0 offen offset:96
    buffer_load_dwordx2 v[18:19], v8, s[40:43], 0 offen offset:128
L_ch_g2_resdone:
    s_lshl_b32 s10, s7, 11
    v_lshl_add_u32 v4, v2, 4, s10
    v_add_u32 v5, 73728, v4
    v_lshlrev_b32 v6, 4, v2
    v_add_u32 v6, 8192, v6
    v_add_u32 v7, 73728, v6
    s_lshl_b32 s61, s38, 3
    s_add_u32 s61, s61, s39
    s_lshl_b32 s61, s61, 9

    s_barrier
    ds_read_b128 v[20:23], v4 offset:0
    ds_read_b128 v[32:35], v6 offset:0
    ds_read_b128 v[36:39], v6 offset:1024
    ds_read_b128 v[40:43], v6 offset:2048
    ds_read_b128 v[44:47], v6 offset:3072
    ds_read_b128 v[48:51], v6 offset:4096
    ds_read_b128 v[24:27], v4 offset:1024
    ds_read_b128 v[52:55], v6 offset:5120
    ds_read_b128 v[56:59], v6 offset:6144
    ds_read_b128 v[60:63], v6 offset:7168
    ds_read_b128 v[64:67], v6 offset:8192
    ds_read_b128 v[68:71], v6 offset:9216
    s_waitcnt lgkmcnt(6)
    s_barrier
    v_mfma_f32_16x16x32_bf16 v[92:95], v[32:35], v[20:23], 0
    ds_read_b128 v[28:31], v4 offset:18432
    ds_read_b128 v[72:75], v6 offset:18432
    ds_read_b128 v[76:79], v6 offset:19456
    ds_read_b128 v[80:83], v6 offset:20480
    ds_read_b128 v[84:87], v6 offset:21504
    ds_read_b128 v[88:91], v6 offset:22528
    v_mfma_f32_16x16x32_bf16 v[96:99], v[36:39], v[20:23], 0
    v_mfma_f32_16x16x32_bf16 v[100:103], v[40:43], v[20:23], 0
    v_mfma_f32_16x16x32_bf16 v[104:107], v[44:47], v[20:23], 0
    v_mfma_f32_16x16x32_bf16 v[108:111], v[48:51], v[20:23], 0
    s_waitcnt lgkmcnt(6)
    v_mfma_f32_16x16x32_bf16 v[92:95], v[52:55], v[24:27], v[92:95]
    ds_read_b128 v[20:23], v4 offset:19456
    ds_read_b128 v[32:35], v6 offset:23552
    ds_read_b128 v[36:39], v6 offset:24576
    ds_read_b128 v[40:43], v6 offset:25600
    ds_read_b128 v[44:47], v6 offset:26624
    ds_read_b128 v[48:51], v6 offset:27648
    v_mfma_f32_16x16x32_bf16 v[96:99], v[56:59], v[24:27], v[96:99]
    v_mfma_f32_16x16x32_bf16 v[100:103], v[60:63], v[24:27], v[100:103]
    v_mfma_f32_16x16x32_bf16 v[104:107], v[64:67], v[24:27], v[104:107]
    v_mfma_f32_16x16x32_bf16 v[108:111], v[68:71], v[24:27], v[108:111]
    s_waitcnt lgkmcnt(6)
    s_barrier
    v_mfma_f32_16x16x32_bf16 v[92:95], v[72:75], v[28:31], v[92:95]
    ds_read_b128 v[24:27], v4 offset:36864
    ds_read_b128 v[52:55], v6 offset:36864
    ds_read_b128 v[56:59], v6 offset:37888
    ds_read_b128 v[60:63], v6 offset:38912
    ds_read_b128 v[64:67], v6 offset:39936
    ds_read_b128 v[68:71], v6 offset:40960
    v_mfma_f32_16x16x32_bf16 v[96:99], v[76:79], v[28:31], v[96:99]
    v_mfma_f32_16x16x32_bf16 v[100:103], v[80:83], v[28:31], v[100:103]
    v_mfma_f32_16x16x32_bf16 v[104:107], v[84:87], v[28:31], v[104:107]
    v_mfma_f32_16x16x32_bf16 v[108:111], v[88:91], v[28:31], v[108:111]
    s_waitcnt lgkmcnt(6)
    v_mfma_f32_16x16x32_bf16 v[92:95], v[32:35], v[20:23], v[92:95]
    ds_read_b128 v[28:31], v4 offset:37888
    ds_read_b128 v[72:75], v6 offset:41984
    ds_read_b128 v[76:79], v6 offset:43008
    ds_read_b128 v[80:83], v6 offset:44032
    ds_read_b128 v[84:87], v6 offset:45056
    ds_read_b128 v[88:91], v6 offset:46080
    v_mfma_f32_16x16x32_bf16 v[96:99], v[36:39], v[20:23], v[96:99]
    v_mfma_f32_16x16x32_bf16 v[100:103], v[40:43], v[20:23], v[100:103]
    v_mfma_f32_16x16x32_bf16 v[104:107], v[44:47], v[20:23], v[104:107]
    v_mfma_f32_16x16x32_bf16 v[108:111], v[48:51], v[20:23], v[108:111]
    s_waitcnt lgkmcnt(6)
    s_barrier
    v_mfma_f32_16x16x32_bf16 v[92:95], v[52:55], v[24:27], v[92:95]
    ds_read_b128 v[20:23], v4 offset:55296
    ds_read_b128 v[32:35], v6 offset:55296
    ds_read_b128 v[36:39], v6 offset:56320
    ds_read_b128 v[40:43], v6 offset:57344
    ds_read_b128 v[44:47], v6 offset:58368
    ds_read_b128 v[48:51], v6 offset:59392
    v_mfma_f32_16x16x32_bf16 v[96:99], v[56:59], v[24:27], v[96:99]
    v_mfma_f32_16x16x32_bf16 v[100:103], v[60:63], v[24:27], v[100:103]
    v_mfma_f32_16x16x32_bf16 v[104:107], v[64:67], v[24:27], v[104:107]
    v_mfma_f32_16x16x32_bf16 v[108:111], v[68:71], v[24:27], v[108:111]
    s_waitcnt lgkmcnt(6)
    v_mfma_f32_16x16x32_bf16 v[92:95], v[72:75], v[28:31], v[92:95]
    ds_read_b128 v[24:27], v4 offset:56320
    ds_read_b128 v[52:55], v6 offset:60416
    ds_read_b128 v[56:59], v6 offset:61440
    ds_read_b128 v[60:63], v6 offset:62464
    ds_read_b128 v[64:67], v6 offset:63488
    ds_read_b128 v[68:71], v6 offset:64512
    v_mfma_f32_16x16x32_bf16 v[96:99], v[76:79], v[28:31], v[96:99]
    v_mfma_f32_16x16x32_bf16 v[100:103], v[80:83], v[28:31], v[100:103]
    v_mfma_f32_16x16x32_bf16 v[104:107], v[84:87], v[28:31], v[104:107]
    v_mfma_f32_16x16x32_bf16 v[108:111], v[88:91], v[28:31], v[108:111]
    s_waitcnt lgkmcnt(6)
    s_barrier
    v_mfma_f32_16x16x32_bf16 v[92:95], v[32:35], v[20:23], v[92:95]
    ds_read_b128 v[28:31], v5 offset:0
    ds_read_b128 v[72:75], v7 offset:0
    ds_read_b128 v[76:79], v7 offset:1024
    ds_read_b128 v[80:83], v7 offset:2048
    ds_read_b128 v[84:87], v7 offset:3072
    ds_read_b128 v[88:91], v7 offset:4096
    v_mfma_f32_16x16x32_bf16 v[96:99], v[36:39], v[20:23], v[96:99]
    v_mfma_f32_16x16x32_bf16 v[100:103], v[40:43], v[20:23], v[100:103]
    v_mfma_f32_16x16x32_bf16 v[104:107], v[44:47], v[20:23], v[104:107]
    v_mfma_f32_16x16x32_bf16 v[108:111], v[48:51], v[20:23], v[108:111]
    s_waitcnt lgkmcnt(6)
    v_mfma_f32_16x16x32_bf16 v[92:95], v[52:55], v[24:27], v[92:95]
    ds_read_b128 v[20:23], v5 offset:1024
    ds_read_b128 v[32:35], v7 offset:5120
    ds_read_b128 v[36:39], v7 offset:6144
    ds_read_b128 v[40:43], v7 offset:7168
    ds_read_b128 v[44:47], v7 offset:8192
    ds_read_b128 v[48:51], v7 offset:9216
    v_mfma_f32_16x16x32_bf16 v[96:99], v[56:59], v[24:27], v[96:99]
    v_mfma_f32_16x16x32_bf16 v[100:103], v[60:63], v[24:27], v[100:103]
    v_mfma_f32_16x16x32_bf16 v[104:107], v[64:67], v[24:27], v[104:107]
    v_mfma_f32_16x16x32_bf16 v[108:111], v[68:71], v[24:27], v[108:111]
    s_waitcnt lgkmcnt(6)
    s_barrier
    v_mfma_f32_16x16x32_bf16 v[92:95], v[72:75], v[28:31], v[92:95]
    ds_read_b128 v[24:27], v5 offset:18432
    ds_read_b128 v[52:55], v7 offset:18432
    ds_read_b128 v[56:59], v7 offset:19456
    ds_read_b128 v[60:63], v7 offset:20480
    ds_read_b128 v[64:67], v7 offset:21504
    ds_read_b128 v[68:71], v7 offset:22528
    v_mfma_f32_16x16x32_bf16 v[96:99], v[76:79], v[28:31], v[96:99]
    v_mfma_f32_16x16x32_bf16 v[100:103], v[80:83], v[28:31], v[100:103]
    v_mfma_f32_16x16x32_bf16 v[104:107], v[84:87], v[28:31], v[104:107]
    v_mfma_f32_16x16x32_bf16 v[108:111], v[88:91], v[28:31], v[108:111]
    s_waitcnt lgkmcnt(6)
    v_mfma_f32_16x16x32_bf16 v[92:95], v[32:35], v[20:23], v[92:95]
    ds_read_b128 v[28:31], v5 offset:19456
    ds_read_b128 v[72:75], v7 offset:23552
    ds_read_b128 v[76:79], v7 offset:24576
    ds_read_b128 v[80:83], v7 offset:25600
    ds_read_b128 v[84:87], v7 offset:26624
    ds_read_b128 v[88:91], v7 offset:27648
    v_mfma_f32_16x16x32_bf16 v[96:99], v[36:39], v[20:23], v[96:99]
    v_mfma_f32_16x16x32_bf16 v[100:103], v[40:43], v[20:23], v[100:103]
    v_mfma_f32_16x16x32_bf16 v[104:107], v[44:47], v[20:23], v[104:107]
    v_mfma_f32_16x16x32_bf16 v[108:111], v[48:51], v[20:23], v[108:111]
    s_waitcnt lgkmcnt(6)
    s_barrier
    v_mfma_f32_16x16x32_bf16 v[92:95], v[52:55], v[24:27], v[92:95]
    ds_read_b128 v[20:23], v5 offset:36864
    ds_read_b128 v[32:35], v7 offset:36864
    ds_read_b128 v[36:39], v7 offset:37888
    ds_read_b128 v[40:43], v7 offset:38912
    ds_read_b128 v[44:47], v7 offset:39936
    ds_read_b128 v[48:51], v7 offset:40960
    v_mfma_f32_16x16x32_bf16 v[96:99], v[56:59], v[24:27], v[96:99]
    v_mfma_f32_16x16x32_bf16 v[100:103], v[60:63], v[24:27], v[100:103]
    v_mfma_f32_16x16x32_bf16 v[104:107], v[64:67], v[24:27], v[104:107]
    v_mfma_f32_16x16x32_bf16 v[108:111], v[68:71], v[24:27], v[108:111]
    s_waitcnt lgkmcnt(6)
    v_mfma_f32_16x16x32_bf16 v[92:95], v[72:75], v[28:31], v[92:95]
    ds_read_b128 v[24:27], v5 offset:37888
    ds_read_b128 v[52:55], v7 offset:41984
    ds_read_b128 v[56:59], v7 offset:43008
    ds_read_b128 v[60:63], v7 offset:44032
    ds_read_b128 v[64:67], v7 offset:45056
    ds_read_b128 v[68:71], v7 offset:46080
    v_mfma_f32_16x16x32_bf16 v[96:99], v[76:79], v[28:31], v[96:99]
    v_mfma_f32_16x16x32_bf16 v[100:103], v[80:83], v[28:31], v[100:103]
    v_mfma_f32_16x16x32_bf16 v[104:107], v[84:87], v[28:31], v[104:107]
    v_mfma_f32_16x16x32_bf16 v[108:111], v[88:91], v[28:31], v[108:111]
    s_waitcnt lgkmcnt(6)
    s_barrier
    v_mfma_f32_16x16x32_bf16 v[92:95], v[32:35], v[20:23], v[92:95]
    ds_read_b128 v[28:31], v5 offset:55296
    ds_read_b128 v[72:75], v7 offset:55296
    ds_read_b128 v[76:79], v7 offset:56320
    ds_read_b128 v[80:83], v7 offset:57344
    ds_read_b128 v[84:87], v7 offset:58368
    ds_read_b128 v[88:91], v7 offset:59392
    v_mfma_f32_16x16x32_bf16 v[96:99], v[36:39], v[20:23], v[96:99]
    v_mfma_f32_16x16x32_bf16 v[100:103], v[40:43], v[20:23], v[100:103]
    v_mfma_f32_16x16x32_bf16 v[104:107], v[44:47], v[20:23], v[104:107]
    v_mfma_f32_16x16x32_bf16 v[108:111], v[48:51], v[20:23], v[108:111]
    s_waitcnt lgkmcnt(6)
    v_mfma_f32_16x16x32_bf16 v[92:95], v[52:55], v[24:27], v[92:95]
    ds_read_b128 v[20:23], v5 offset:56320
    ds_read_b128 v[32:35], v7 offset:60416
    ds_read_b128 v[36:39], v7 offset:61440
    ds_read_b128 v[40:43], v7 offset:62464
    ds_read_b128 v[44:47], v7 offset:63488
    ds_read_b128 v[48:51], v7 offset:64512
    v_mfma_f32_16x16x32_bf16 v[96:99], v[56:59], v[24:27], v[96:99]
    v_mfma_f32_16x16x32_bf16 v[100:103], v[60:63], v[24:27], v[100:103]
    v_mfma_f32_16x16x32_bf16 v[104:107], v[64:67], v[24:27], v[104:107]
    v_mfma_f32_16x16x32_bf16 v[108:111], v[68:71], v[24:27], v[108:111]
    s_waitcnt lgkmcnt(6)
    s_barrier
    v_mfma_f32_16x16x32_bf16 v[92:95], v[72:75], v[28:31], v[92:95]
    ds_read_b128 v[24:27], v4 offset:0
    ds_read_b128 v[52:55], v6 offset:0
    ds_read_b128 v[56:59], v6 offset:1024
    ds_read_b128 v[60:63], v6 offset:2048
    ds_read_b128 v[64:67], v6 offset:3072
    ds_read_b128 v[68:71], v6 offset:4096
    v_mfma_f32_16x16x32_bf16 v[96:99], v[76:79], v[28:31], v[96:99]
    v_mfma_f32_16x16x32_bf16 v[100:103], v[80:83], v[28:31], v[100:103]
    v_mfma_f32_16x16x32_bf16 v[104:107], v[84:87], v[28:31], v[104:107]
    v_mfma_f32_16x16x32_bf16 v[108:111], v[88:91], v[28:31], v[108:111]
    s_waitcnt lgkmcnt(6)
    v_mfma_f32_16x16x32_bf16 v[92:95], v[32:35], v[20:23], v[92:95]
    ds_read_b128 v[28:31], v4 offset:1024
    ds_read_b128 v[72:75], v6 offset:5120
    ds_read_b128 v[76:79], v6 offset:6144
    ds_read_b128 v[80:83], v6 offset:7168
    ds_read_b128 v[84:87], v6 offset:8192
    ds_read_b128 v[88:91], v6 offset:9216
    v_mfma_f32_16x16x32_bf16 v[96:99], v[36:39], v[20:23], v[96:99]
    v_mfma_f32_16x16x32_bf16 v[100:103], v[40:43], v[20:23], v[100:103]
    v_mfma_f32_16x16x32_bf16 v[104:107], v[44:47], v[20:23], v[104:107]
    v_mfma_f32_16x16x32_bf16 v[108:111], v[48:51], v[20:23], v[108:111]
    s_waitcnt lgkmcnt(6)
    s_barrier
    v_mfma_f32_16x16x32_bf16 v[92:95], v[52:55], v[24:27], v[92:95]
    ds_read_b128 v[20:23], v4 offset:18432
    ds_read_b128 v[32:35], v6 offset:18432
    ds_read_b128 v[36:39], v6 offset:19456
    ds_read_b128 v[40:43], v6 offset:20480
    ds_read_b128 v[44:47], v6 offset:21504
    ds_read_b128 v[48:51], v6 offset:22528
    v_mfma_f32_16x16x32_bf16 v[96:99], v[56:59], v[24:27], v[96:99]
    v_mfma_f32_16x16x32_bf16 v[100:103], v[60:63], v[24:27], v[100:103]
    v_mfma_f32_16x16x32_bf16 v[104:107], v[64:67], v[24:27], v[104:107]
    v_mfma_f32_16x16x32_bf16 v[108:111], v[68:71], v[24:27], v[108:111]
    s_waitcnt lgkmcnt(6)
    v_mfma_f32_16x16x32_bf16 v[92:95], v[72:75], v[28:31], v[92:95]
    ds_read_b128 v[24:27], v4 offset:19456
    ds_read_b128 v[52:55], v6 offset:23552
    ds_read_b128 v[56:59], v6 offset:24576
    ds_read_b128 v[60:63], v6 offset:25600
    ds_read_b128 v[64:67], v6 offset:26624
    ds_read_b128 v[68:71], v6 offset:27648
    v_mfma_f32_16x16x32_bf16 v[96:99], v[76:79], v[28:31], v[96:99]
    v_mfma_f32_16x16x32_bf16 v[100:103], v[80:83], v[28:31], v[100:103]
    v_mfma_f32_16x16x32_bf16 v[104:107], v[84:87], v[28:31], v[104:107]
    v_mfma_f32_16x16x32_bf16 v[108:111], v[88:91], v[28:31], v[108:111]
    s_waitcnt lgkmcnt(6)
    v_mfma_f32_16x16x32_bf16 v[92:95], v[32:35], v[20:23], v[92:95]
    v_mfma_f32_16x16x32_bf16 v[96:99], v[36:39], v[20:23], v[96:99]
    v_mfma_f32_16x16x32_bf16 v[100:103], v[40:43], v[20:23], v[100:103]
    v_mfma_f32_16x16x32_bf16 v[104:107], v[44:47], v[20:23], v[104:107]
    v_mfma_f32_16x16x32_bf16 v[108:111], v[48:51], v[20:23], v[108:111]
    s_waitcnt lgkmcnt(0)
    s_barrier
    v_mfma_f32_16x16x32_bf16 v[92:95], v[52:55], v[24:27], v[92:95]
    v_mfma_f32_16x16x32_bf16 v[96:99], v[56:59], v[24:27], v[96:99]
    v_mfma_f32_16x16x32_bf16 v[100:103], v[60:63], v[24:27], v[100:103]
    v_mfma_f32_16x16x32_bf16 v[104:107], v[64:67], v[24:27], v[104:107]
    v_mfma_f32_16x16x32_bf16 v[108:111], v[68:71], v[24:27], v[108:111]
    s_waitcnt vmcnt(0)
    s_nop 7
    v_lshlrev_b32 v20, 16, v10
    v_and_b32 v21, 0xffff0000, v10
    v_lshlrev_b32 v22, 16, v11
    v_and_b32 v23, 0xffff0000, v11
    v_pk_add_f32 v[20:21], v[20:21], v[92:93]
    v_pk_add_f32 v[22:23], v[22:23], v[94:95]
    v_cvt_pk_bf16_f32 v10, v20, v21
    v_cvt_pk_bf16_f32 v11, v22, v23

    v_lshlrev_b32 v24, 16, v12
    v_and_b32 v25, 0xffff0000, v12
    v_lshlrev_b32 v26, 16, v13
    v_and_b32 v27, 0xffff0000, v13
    v_pk_add_f32 v[24:25], v[24:25], v[96:97]
    v_pk_add_f32 v[26:27], v[26:27], v[98:99]
    v_cvt_pk_bf16_f32 v12, v24, v25
    v_cvt_pk_bf16_f32 v13, v26, v27

    v_lshlrev_b32 v20, 16, v14
    v_and_b32 v21, 0xffff0000, v14
    v_lshlrev_b32 v22, 16, v15
    v_and_b32 v23, 0xffff0000, v15
    v_pk_add_f32 v[20:21], v[20:21], v[100:101]
    v_pk_add_f32 v[22:23], v[22:23], v[102:103]
    v_cvt_pk_bf16_f32 v14, v20, v21
    v_cvt_pk_bf16_f32 v15, v22, v23

    v_lshlrev_b32 v24, 16, v16
    v_and_b32 v25, 0xffff0000, v16
    v_lshlrev_b32 v26, 16, v17
    v_and_b32 v27, 0xffff0000, v17
    v_pk_add_f32 v[24:25], v[24:25], v[104:105]
    v_pk_add_f32 v[26:27], v[26:27], v[106:107]
    v_cvt_pk_bf16_f32 v16, v24, v25
    v_cvt_pk_bf16_f32 v17, v26, v27

    v_lshlrev_b32 v20, 16, v18
    v_and_b32 v21, 0xffff0000, v18
    v_lshlrev_b32 v22, 16, v19
    v_and_b32 v23, 0xffff0000, v19
    v_pk_add_f32 v[20:21], v[20:21], v[108:109]
    v_pk_add_f32 v[22:23], v[22:23], v[110:111]
    v_cvt_pk_bf16_f32 v18, v20, v21
    v_cvt_pk_bf16_f32 v19, v22, v23

    s_nop 0
    v_permlane16_swap_b32 v10, v12
    v_permlane16_swap_b32 v11, v13
    v_permlane16_swap_b32 v14, v16
    v_permlane16_swap_b32 v15, v17
    s_nop 0
    buffer_store_dwordx4 v[10:13], v112, s[48:51], 0 offen offset:0 sc1
    buffer_store_dwordx4 v[14:17], v112, s[48:51], 0 offen offset:2048 sc1
    buffer_store_dwordx2 v[18:19], v3, s[48:51], s62 offen sc1
    v_mov_b32 v4, 0
    v_mov_b32 v5, 0
    s_mov_b32 s60, 0x3f803f80
    v_dot2_f32_bf16 v4, v10, s60, v4
    v_dot2_f32_bf16 v5, v10, v10, v5
    v_dot2_f32_bf16 v4, v11, s60, v4
    v_dot2_f32_bf16 v5, v11, v11, v5
    v_dot2_f32_bf16 v4, v12, s60, v4
    v_dot2_f32_bf16 v5, v12, v12, v5
    v_dot2_f32_bf16 v4, v13, s60, v4
    v_dot2_f32_bf16 v5, v13, v13, v5
    v_dot2_f32_bf16 v4, v14, s60, v4
    v_dot2_f32_bf16 v5, v14, v14, v5
    v_dot2_f32_bf16 v4, v15, s60, v4
    v_dot2_f32_bf16 v5, v15, v15, v5
    v_dot2_f32_bf16 v4, v16, s60, v4
    v_dot2_f32_bf16 v5, v16, v16, v5
    v_dot2_f32_bf16 v4, v17, s60, v4
    v_dot2_f32_bf16 v5, v17, v17, v5
    v_dot2_f32_bf16 v4, v18, s60, v4
    v_dot2_f32_bf16 v5, v18, v18, v5
    v_dot2_f32_bf16 v4, v19, s60, v4
    v_dot2_f32_bf16 v5, v19, v19, v5
    s_nop 2
    v_mov_b32 v6, v4
    v_mov_b32 v7, v5
    s_nop 1
    v_permlane16_swap_b32 v4, v6
    v_permlane16_swap_b32 v5, v7
    s_nop 1
    v_add_f32 v4, v4, v6
    v_add_f32 v5, v5, v7

    v_mov_b32 v6, v4
    v_mov_b32 v7, v5
    s_nop 1
    v_permlane32_swap_b32 v4, v6
    v_permlane32_swap_b32 v5, v7
    s_nop 1
    v_add_f32 v4, v4, v6
    v_add_f32 v5, v5, v7

    s_mov_b64 exec, 0xffff
    buffer_store_dwordx2 v[4:5], v9, s[56:59], s61 offen sc1
    s_mov_b64 exec, -1

    s_add_u32 s44, s34, 44564480
    s_addc_u32 s45, s35, 0
    s_mov_b32 s46, 46080
    s_mov_b32 s47, 0x00020000
    s_mul_i32 s12, s98, 12288
    s_lshl_b32 s8, s36, 8
    s_add_u32 s12, s12, s8
    s_lshl_b32 s13, s37, 4
    s_add_u32 s12, s12, s13
    s_lshl_b32 s13, s7, 2
    s_add_u32 s12, s12, s13
    v_mov_b32 v1, 1
    s_mov_b64 exec, 1
    s_waitcnt vmcnt(0)
    buffer_store_dword v1, off, s[44:47], s12 sc1
    s_mov_b64 exec, -1
    s_barrier

    s_mov_b32 s5, s36
    s_mov_b32 s6, s37
    s_lshr_b32 s8, s7, 1
    s_and_b32 s9, s7, 1
    v_and_b32 v3, 31, v2
    v_lshrrev_b32 v4, 5, v2

    s_add_u32 s52, s34, 36700160
    s_addc_u32 s53, s35, 0
    s_mov_b32 s54, 4030464
    s_mov_b32 s55, 0x00020000
    s_add_u32 s56, s34, 44302336
    s_addc_u32 s57, s35, 0
    s_mov_b32 s58, 131072
    s_mov_b32 s59, 0x00020000
    s_lshl_b32 s59, s98, 26
    s_add_u32 s56, s56, s59
    s_addc_u32 s57, s57, 0
    s_mov_b32 s59, 0x00020000
    s_mul_i32 s10, s6, 251904
    s_mul_i32 s11, s9, 3072
    s_add_u32 s10, s10, s11
    s_add_u32 s10, s10, 245760
    v_lshlrev_b32 v5, 4, v2
    s_lshl_b32 s13, s5, 7
    s_lshl_b32 s14, s8, 6
    s_add_u32 s12, s13, s14
    s_lshl_b32 s13, s12, 6
    v_lshl_add_u32 v6, v3, 3, s13
    v_lshl_add_u32 v6, v4, 11, v6

    buffer_load_dwordx4 v[180:183], v5, s[52:55], s10 offen offset:0
    buffer_load_dwordx4 v[184:187], v5, s[52:55], s10 offen offset:1024
    buffer_load_dwordx4 v[188:191], v5, s[52:55], s10 offen offset:2048
    s_add_u32 s11, s11, 8192
    v_add_u32 v12, s11, v5
    s_lshl_b32 s14, s8, 12
    v_add_u32 v8, s14, v5

    v_add_u32 v13, 61440, v12
    v_add_u32 v9, 61440, v8
    v_add_u32 v14, 122880, v12
    v_add_u32 v10, 122880, v8
    s_add_u32 s48, s34, 20971520
    s_addc_u32 s49, s35, 0
    s_mov_b32 s50, 6291456
    s_mov_b32 s51, 0x00020000
    s_lshl_b32 s51, s98, 26
    s_add_u32 s48, s48, s51
    s_addc_u32 s49, s49, 0
    s_mov_b32 s51, 0x00020000
    v_add_u32 v21, s12, v3
    v_lshrrev_b32 v22, 4, v21
    v_mul_u32_u24 v22, 49152, v22
    v_and_b32 v21, 15, v21
    v_lshl_add_u32 v22, v21, 4, v22
    v_lshl_add_u32 v22, v4, 8, v22
    v_add_u32 v23, 98304, v22
    s_mul_i32 s10, s6, 6
    s_mul_i32 s11, s9, 3
    s_add_u32 s10, s10, s11
    s_lshl_b32 s61, s10, 9

    s_barrier
    ds_read_b128 v[24:27], v8 offset:0
    ds_read_b128 v[28:31], v8 offset:2048
    ds_read_b128 v[48:51], v12 offset:0
    ds_read_b128 v[52:55], v12 offset:1024
    ds_read_b128 v[56:59], v12 offset:2048
    ds_read_b128 v[32:35], v8 offset:1024
    ds_read_b128 v[36:39], v8 offset:3072
    ds_read_b128 v[60:63], v12 offset:6144
    ds_read_b128 v[64:67], v12 offset:7168
    ds_read_b128 v[68:71], v12 offset:8192
    buffer_load_dwordx2 v[192:193], v6, s[56:59], 0 offen offset:0 sc1
    buffer_load_dwordx2 v[194:195], v6, s[56:59], 0 offen offset:512 sc1
    buffer_load_dwordx2 v[196:197], v6, s[56:59], 0 offen offset:1024 sc1
    buffer_load_dwordx2 v[198:199], v6, s[56:59], 0 offen offset:1536 sc1
    buffer_load_dwordx2 v[200:201], v6, s[56:59], 0 offen offset:256 sc1
    buffer_load_dwordx2 v[202:203], v6, s[56:59], 0 offen offset:768 sc1
    buffer_load_dwordx2 v[204:205], v6, s[56:59], 0 offen offset:1280 sc1
    buffer_load_dwordx2 v[206:207], v6, s[56:59], 0 offen offset:1792 sc1
    s_waitcnt lgkmcnt(5)
    s_barrier
    v_mfma_f32_32x32x16_bf16 v[84:99], v[48:51], v[24:27], 0
    ds_read_b128 v[40:43], v8 offset:20480
    ds_read_b128 v[44:47], v8 offset:22528
    ds_read_b128 v[72:75], v12 offset:20480
    ds_read_b128 v[76:79], v12 offset:21504
    ds_read_b128 v[80:83], v12 offset:22528
    v_mfma_f32_32x32x16_bf16 v[100:115], v[48:51], v[28:31], 0
    v_mfma_f32_32x32x16_bf16 v[116:131], v[52:55], v[24:27], 0
    v_mfma_f32_32x32x16_bf16 v[132:147], v[52:55], v[28:31], 0
    v_mfma_f32_32x32x16_bf16 v[148:163], v[56:59], v[24:27], 0
    v_mfma_f32_32x32x16_bf16 v[164:179], v[56:59], v[28:31], 0
    s_waitcnt lgkmcnt(5)
    v_mfma_f32_32x32x16_bf16 v[84:99], v[60:63], v[32:35], v[84:99]
    ds_read_b128 v[24:27], v8 offset:21504
    ds_read_b128 v[28:31], v8 offset:23552
    ds_read_b128 v[48:51], v12 offset:26624
    ds_read_b128 v[52:55], v12 offset:27648
    ds_read_b128 v[56:59], v12 offset:28672
    v_mfma_f32_32x32x16_bf16 v[100:115], v[60:63], v[36:39], v[100:115]
    v_mfma_f32_32x32x16_bf16 v[116:131], v[64:67], v[32:35], v[116:131]
    v_mfma_f32_32x32x16_bf16 v[132:147], v[64:67], v[36:39], v[132:147]
    v_mfma_f32_32x32x16_bf16 v[148:163], v[68:71], v[32:35], v[148:163]
    v_mfma_f32_32x32x16_bf16 v[164:179], v[68:71], v[36:39], v[164:179]
    s_waitcnt lgkmcnt(5)
    s_barrier
    v_mfma_f32_32x32x16_bf16 v[84:99], v[72:75], v[40:43], v[84:99]
    ds_read_b128 v[32:35], v8 offset:40960
    ds_read_b128 v[36:39], v8 offset:43008
    ds_read_b128 v[60:63], v12 offset:40960
    ds_read_b128 v[64:67], v12 offset:41984
    ds_read_b128 v[68:71], v12 offset:43008
    v_mfma_f32_32x32x16_bf16 v[100:115], v[72:75], v[44:47], v[100:115]
    v_mfma_f32_32x32x16_bf16 v[116:131], v[76:79], v[40:43], v[116:131]
    v_mfma_f32_32x32x16_bf16 v[132:147], v[76:79], v[44:47], v[132:147]
    v_mfma_f32_32x32x16_bf16 v[148:163], v[80:83], v[40:43], v[148:163]
    v_mfma_f32_32x32x16_bf16 v[164:179], v[80:83], v[44:47], v[164:179]
    s_waitcnt lgkmcnt(5)
    v_mfma_f32_32x32x16_bf16 v[84:99], v[48:51], v[24:27], v[84:99]
    ds_read_b128 v[40:43], v8 offset:41984
    ds_read_b128 v[44:47], v8 offset:44032
    ds_read_b128 v[72:75], v12 offset:47104
    ds_read_b128 v[76:79], v12 offset:48128
    ds_read_b128 v[80:83], v12 offset:49152
    v_mfma_f32_32x32x16_bf16 v[100:115], v[48:51], v[28:31], v[100:115]
    v_mfma_f32_32x32x16_bf16 v[116:131], v[52:55], v[24:27], v[116:131]
    v_mfma_f32_32x32x16_bf16 v[132:147], v[52:55], v[28:31], v[132:147]
    v_mfma_f32_32x32x16_bf16 v[148:163], v[56:59], v[24:27], v[148:163]
    v_mfma_f32_32x32x16_bf16 v[164:179], v[56:59], v[28:31], v[164:179]
    s_waitcnt lgkmcnt(5)
    s_barrier
    v_mfma_f32_32x32x16_bf16 v[84:99], v[60:63], v[32:35], v[84:99]
    ds_read_b128 v[24:27], v9 offset:0
    ds_read_b128 v[28:31], v9 offset:2048
    ds_read_b128 v[48:51], v13 offset:0
    ds_read_b128 v[52:55], v13 offset:1024
    ds_read_b128 v[56:59], v13 offset:2048
    v_mfma_f32_32x32x16_bf16 v[100:115], v[60:63], v[36:39], v[100:115]
    v_mfma_f32_32x32x16_bf16 v[116:131], v[64:67], v[32:35], v[116:131]
    v_mfma_f32_32x32x16_bf16 v[132:147], v[64:67], v[36:39], v[132:147]
    v_mfma_f32_32x32x16_bf16 v[148:163], v[68:71], v[32:35], v[148:163]
    v_mfma_f32_32x32x16_bf16 v[164:179], v[68:71], v[36:39], v[164:179]
    s_waitcnt lgkmcnt(5)
    v_mfma_f32_32x32x16_bf16 v[84:99], v[72:75], v[40:43], v[84:99]
    ds_read_b128 v[32:35], v9 offset:1024
    ds_read_b128 v[36:39], v9 offset:3072
    ds_read_b128 v[60:63], v13 offset:6144
    ds_read_b128 v[64:67], v13 offset:7168
    ds_read_b128 v[68:71], v13 offset:8192
    v_mfma_f32_32x32x16_bf16 v[100:115], v[72:75], v[44:47], v[100:115]
    v_mfma_f32_32x32x16_bf16 v[116:131], v[76:79], v[40:43], v[116:131]
    v_mfma_f32_32x32x16_bf16 v[132:147], v[76:79], v[44:47], v[132:147]
    v_mfma_f32_32x32x16_bf16 v[148:163], v[80:83], v[40:43], v[148:163]
    v_mfma_f32_32x32x16_bf16 v[164:179], v[80:83], v[44:47], v[164:179]
    s_waitcnt lgkmcnt(5)
    s_barrier
    v_mfma_f32_32x32x16_bf16 v[84:99], v[48:51], v[24:27], v[84:99]
    ds_read_b128 v[40:43], v9 offset:20480
    ds_read_b128 v[44:47], v9 offset:22528
    ds_read_b128 v[72:75], v13 offset:20480
    ds_read_b128 v[76:79], v13 offset:21504
    ds_read_b128 v[80:83], v13 offset:22528
    v_mfma_f32_32x32x16_bf16 v[100:115], v[48:51], v[28:31], v[100:115]
    v_mfma_f32_32x32x16_bf16 v[116:131], v[52:55], v[24:27], v[116:131]
    v_mfma_f32_32x32x16_bf16 v[132:147], v[52:55], v[28:31], v[132:147]
    v_mfma_f32_32x32x16_bf16 v[148:163], v[56:59], v[24:27], v[148:163]
    v_mfma_f32_32x32x16_bf16 v[164:179], v[56:59], v[28:31], v[164:179]
    s_waitcnt lgkmcnt(5)
    v_mfma_f32_32x32x16_bf16 v[84:99], v[60:63], v[32:35], v[84:99]
    ds_read_b128 v[24:27], v9 offset:21504
    ds_read_b128 v[28:31], v9 offset:23552
    ds_read_b128 v[48:51], v13 offset:26624
    ds_read_b128 v[52:55], v13 offset:27648
    ds_read_b128 v[56:59], v13 offset:28672
    v_mfma_f32_32x32x16_bf16 v[100:115], v[60:63], v[36:39], v[100:115]
    v_mfma_f32_32x32x16_bf16 v[116:131], v[64:67], v[32:35], v[116:131]
    v_mfma_f32_32x32x16_bf16 v[132:147], v[64:67], v[36:39], v[132:147]
    v_mfma_f32_32x32x16_bf16 v[148:163], v[68:71], v[32:35], v[148:163]
    v_mfma_f32_32x32x16_bf16 v[164:179], v[68:71], v[36:39], v[164:179]
    s_waitcnt lgkmcnt(5)
    s_barrier
    v_mfma_f32_32x32x16_bf16 v[84:99], v[72:75], v[40:43], v[84:99]
    ds_read_b128 v[32:35], v9 offset:40960
    ds_read_b128 v[36:39], v9 offset:43008
    ds_read_b128 v[60:63], v13 offset:40960
    ds_read_b128 v[64:67], v13 offset:41984
    ds_read_b128 v[68:71], v13 offset:43008
    v_mfma_f32_32x32x16_bf16 v[100:115], v[72:75], v[44:47], v[100:115]
    v_mfma_f32_32x32x16_bf16 v[116:131], v[76:79], v[40:43], v[116:131]
    v_mfma_f32_32x32x16_bf16 v[132:147], v[76:79], v[44:47], v[132:147]
    v_mfma_f32_32x32x16_bf16 v[148:163], v[80:83], v[40:43], v[148:163]
    v_mfma_f32_32x32x16_bf16 v[164:179], v[80:83], v[44:47], v[164:179]
    s_waitcnt lgkmcnt(5)
    v_mfma_f32_32x32x16_bf16 v[84:99], v[48:51], v[24:27], v[84:99]
    ds_read_b128 v[40:43], v9 offset:41984
    ds_read_b128 v[44:47], v9 offset:44032
    ds_read_b128 v[72:75], v13 offset:47104
    ds_read_b128 v[76:79], v13 offset:48128
    ds_read_b128 v[80:83], v13 offset:49152
    v_mfma_f32_32x32x16_bf16 v[100:115], v[48:51], v[28:31], v[100:115]
    v_mfma_f32_32x32x16_bf16 v[116:131], v[52:55], v[24:27], v[116:131]
    v_mfma_f32_32x32x16_bf16 v[132:147], v[52:55], v[28:31], v[132:147]
    v_mfma_f32_32x32x16_bf16 v[148:163], v[56:59], v[24:27], v[148:163]
    v_mfma_f32_32x32x16_bf16 v[164:179], v[56:59], v[28:31], v[164:179]
    s_waitcnt lgkmcnt(5)
    s_barrier
    v_mfma_f32_32x32x16_bf16 v[84:99], v[60:63], v[32:35], v[84:99]
    ds_read_b128 v[24:27], v10 offset:0
    ds_read_b128 v[28:31], v10 offset:2048
    ds_read_b128 v[48:51], v14 offset:0
    ds_read_b128 v[52:55], v14 offset:1024
    ds_read_b128 v[56:59], v14 offset:2048
    v_mfma_f32_32x32x16_bf16 v[100:115], v[60:63], v[36:39], v[100:115]
    v_mfma_f32_32x32x16_bf16 v[116:131], v[64:67], v[32:35], v[116:131]
    v_mfma_f32_32x32x16_bf16 v[132:147], v[64:67], v[36:39], v[132:147]
    v_mfma_f32_32x32x16_bf16 v[148:163], v[68:71], v[32:35], v[148:163]
    v_mfma_f32_32x32x16_bf16 v[164:179], v[68:71], v[36:39], v[164:179]
    s_waitcnt lgkmcnt(5)
    v_mfma_f32_32x32x16_bf16 v[84:99], v[72:75], v[40:43], v[84:99]
    ds_read_b128 v[32:35], v10 offset:1024
    ds_read_b128 v[36:39], v10 offset:3072
    ds_read_b128 v[60:63], v14 offset:6144
    ds_read_b128 v[64:67], v14 offset:7168
    ds_read_b128 v[68:71], v14 offset:8192
    v_mfma_f32_32x32x16_bf16 v[100:115], v[72:75], v[44:47], v[100:115]
    v_mfma_f32_32x32x16_bf16 v[116:131], v[76:79], v[40:43], v[116:131]
    v_mfma_f32_32x32x16_bf16 v[132:147], v[76:79], v[44:47], v[132:147]
    v_mfma_f32_32x32x16_bf16 v[148:163], v[80:83], v[40:43], v[148:163]
    v_mfma_f32_32x32x16_bf16 v[164:179], v[80:83], v[44:47], v[164:179]
    s_waitcnt lgkmcnt(5)
    s_barrier
    v_mfma_f32_32x32x16_bf16 v[84:99], v[48:51], v[24:27], v[84:99]
    ds_read_b128 v[40:43], v10 offset:20480
    ds_read_b128 v[44:47], v10 offset:22528
    ds_read_b128 v[72:75], v14 offset:20480
    ds_read_b128 v[76:79], v14 offset:21504
    ds_read_b128 v[80:83], v14 offset:22528
    v_mfma_f32_32x32x16_bf16 v[100:115], v[48:51], v[28:31], v[100:115]
    v_mfma_f32_32x32x16_bf16 v[116:131], v[52:55], v[24:27], v[116:131]
    v_mfma_f32_32x32x16_bf16 v[132:147], v[52:55], v[28:31], v[132:147]
    v_mfma_f32_32x32x16_bf16 v[148:163], v[56:59], v[24:27], v[148:163]
    v_mfma_f32_32x32x16_bf16 v[164:179], v[56:59], v[28:31], v[164:179]
    s_waitcnt lgkmcnt(5)
    v_mfma_f32_32x32x16_bf16 v[84:99], v[60:63], v[32:35], v[84:99]
    ds_read_b128 v[24:27], v10 offset:21504
    ds_read_b128 v[28:31], v10 offset:23552
    ds_read_b128 v[48:51], v14 offset:26624
    ds_read_b128 v[52:55], v14 offset:27648
    ds_read_b128 v[56:59], v14 offset:28672
    v_mfma_f32_32x32x16_bf16 v[100:115], v[60:63], v[36:39], v[100:115]
    v_mfma_f32_32x32x16_bf16 v[116:131], v[64:67], v[32:35], v[116:131]
    v_mfma_f32_32x32x16_bf16 v[132:147], v[64:67], v[36:39], v[132:147]
    v_mfma_f32_32x32x16_bf16 v[148:163], v[68:71], v[32:35], v[148:163]
    v_mfma_f32_32x32x16_bf16 v[164:179], v[68:71], v[36:39], v[164:179]
    s_waitcnt lgkmcnt(5)
    s_barrier
    v_mfma_f32_32x32x16_bf16 v[84:99], v[72:75], v[40:43], v[84:99]
    ds_read_b128 v[32:35], v8 offset:0
    ds_read_b128 v[36:39], v8 offset:2048
    ds_read_b128 v[60:63], v12 offset:0
    ds_read_b128 v[64:67], v12 offset:1024
    ds_read_b128 v[68:71], v12 offset:2048
    v_mfma_f32_32x32x16_bf16 v[100:115], v[72:75], v[44:47], v[100:115]
    v_mfma_f32_32x32x16_bf16 v[116:131], v[76:79], v[40:43], v[116:131]
    v_mfma_f32_32x32x16_bf16 v[132:147], v[76:79], v[44:47], v[132:147]
    v_mfma_f32_32x32x16_bf16 v[148:163], v[80:83], v[40:43], v[148:163]
    v_mfma_f32_32x32x16_bf16 v[164:179], v[80:83], v[44:47], v[164:179]
    s_waitcnt lgkmcnt(5)
    v_mfma_f32_32x32x16_bf16 v[84:99], v[48:51], v[24:27], v[84:99]
    ds_read_b128 v[40:43], v8 offset:1024
    ds_read_b128 v[44:47], v8 offset:3072
    ds_read_b128 v[72:75], v12 offset:6144
    ds_read_b128 v[76:79], v12 offset:7168
    ds_read_b128 v[80:83], v12 offset:8192
    v_mfma_f32_32x32x16_bf16 v[100:115], v[48:51], v[28:31], v[100:115]
    v_mfma_f32_32x32x16_bf16 v[116:131], v[52:55], v[24:27], v[116:131]
    v_mfma_f32_32x32x16_bf16 v[132:147], v[52:55], v[28:31], v[132:147]
    v_mfma_f32_32x32x16_bf16 v[148:163], v[56:59], v[24:27], v[148:163]
    v_mfma_f32_32x32x16_bf16 v[164:179], v[56:59], v[28:31], v[164:179]
    s_waitcnt lgkmcnt(5)
    s_barrier
    v_mfma_f32_32x32x16_bf16 v[84:99], v[60:63], v[32:35], v[84:99]
    ds_read_b128 v[24:27], v8 offset:20480
    ds_read_b128 v[28:31], v8 offset:22528
    ds_read_b128 v[48:51], v12 offset:20480
    ds_read_b128 v[52:55], v12 offset:21504
    ds_read_b128 v[56:59], v12 offset:22528
    v_mfma_f32_32x32x16_bf16 v[100:115], v[60:63], v[36:39], v[100:115]
    v_mfma_f32_32x32x16_bf16 v[116:131], v[64:67], v[32:35], v[116:131]
    v_mfma_f32_32x32x16_bf16 v[132:147], v[64:67], v[36:39], v[132:147]
    v_mfma_f32_32x32x16_bf16 v[148:163], v[68:71], v[32:35], v[148:163]
    v_mfma_f32_32x32x16_bf16 v[164:179], v[68:71], v[36:39], v[164:179]
    s_waitcnt lgkmcnt(5)
    v_mfma_f32_32x32x16_bf16 v[84:99], v[72:75], v[40:43], v[84:99]
    ds_read_b128 v[32:35], v8 offset:21504
    ds_read_b128 v[36:39], v8 offset:23552
    ds_read_b128 v[60:63], v12 offset:26624
    ds_read_b128 v[64:67], v12 offset:27648
    ds_read_b128 v[68:71], v12 offset:28672
    v_mfma_f32_32x32x16_bf16 v[100:115], v[72:75], v[44:47], v[100:115]
    v_mfma_f32_32x32x16_bf16 v[116:131], v[76:79], v[40:43], v[116:131]
    v_mfma_f32_32x32x16_bf16 v[132:147], v[76:79], v[44:47], v[132:147]
    v_mfma_f32_32x32x16_bf16 v[148:163], v[80:83], v[40:43], v[148:163]
    v_mfma_f32_32x32x16_bf16 v[164:179], v[80:83], v[44:47], v[164:179]
    s_waitcnt lgkmcnt(5)
    s_barrier
    v_mfma_f32_32x32x16_bf16 v[84:99], v[48:51], v[24:27], v[84:99]
    ds_read_b128 v[40:43], v8 offset:40960
    ds_read_b128 v[44:47], v8 offset:43008
    ds_read_b128 v[72:75], v12 offset:40960
    ds_read_b128 v[76:79], v12 offset:41984
    ds_read_b128 v[80:83], v12 offset:43008
    v_mfma_f32_32x32x16_bf16 v[100:115], v[48:51], v[28:31], v[100:115]
    v_mfma_f32_32x32x16_bf16 v[116:131], v[52:55], v[24:27], v[116:131]
    v_mfma_f32_32x32x16_bf16 v[132:147], v[52:55], v[28:31], v[132:147]
    v_mfma_f32_32x32x16_bf16 v[148:163], v[56:59], v[24:27], v[148:163]
    v_mfma_f32_32x32x16_bf16 v[164:179], v[56:59], v[28:31], v[164:179]
    s_waitcnt lgkmcnt(5)
    v_mfma_f32_32x32x16_bf16 v[84:99], v[60:63], v[32:35], v[84:99]
    ds_read_b128 v[24:27], v8 offset:41984
    ds_read_b128 v[28:31], v8 offset:44032
    ds_read_b128 v[48:51], v12 offset:47104
    ds_read_b128 v[52:55], v12 offset:48128
    ds_read_b128 v[56:59], v12 offset:49152
    v_mfma_f32_32x32x16_bf16 v[100:115], v[60:63], v[36:39], v[100:115]
    v_mfma_f32_32x32x16_bf16 v[116:131], v[64:67], v[32:35], v[116:131]
    v_mfma_f32_32x32x16_bf16 v[132:147], v[64:67], v[36:39], v[132:147]
    v_mfma_f32_32x32x16_bf16 v[148:163], v[68:71], v[32:35], v[148:163]
    v_mfma_f32_32x32x16_bf16 v[164:179], v[68:71], v[36:39], v[164:179]
    s_waitcnt lgkmcnt(5)
    s_barrier
    v_mfma_f32_32x32x16_bf16 v[84:99], v[72:75], v[40:43], v[84:99]
    ds_read_b128 v[32:35], v9 offset:0
    ds_read_b128 v[36:39], v9 offset:2048
    ds_read_b128 v[60:63], v13 offset:0
    ds_read_b128 v[64:67], v13 offset:1024
    ds_read_b128 v[68:71], v13 offset:2048
    v_mfma_f32_32x32x16_bf16 v[100:115], v[72:75], v[44:47], v[100:115]
    v_mfma_f32_32x32x16_bf16 v[116:131], v[76:79], v[40:43], v[116:131]
    v_mfma_f32_32x32x16_bf16 v[132:147], v[76:79], v[44:47], v[132:147]
    v_mfma_f32_32x32x16_bf16 v[148:163], v[80:83], v[40:43], v[148:163]
    v_mfma_f32_32x32x16_bf16 v[164:179], v[80:83], v[44:47], v[164:179]
    s_waitcnt vmcnt(0)
    s_mov_b32 s10, 0x3acccccd
    v_pk_add_f32 v[192:193], v[192:193], v[194:195]
    v_pk_add_f32 v[196:197], v[196:197], v[198:199]
    v_pk_add_f32 v[192:193], v[192:193], v[196:197]

    v_mov_b32 v20, v192
    s_nop 1
    v_permlane32_swap_b32 v192, v20
    s_nop 1
    v_add_f32 v192, v192, v20
    v_mov_b32 v20, v193
    s_nop 1
    v_permlane32_swap_b32 v193, v20
    s_nop 1
    v_add_f32 v193, v193, v20
    v_mul_f32 v192, s10, v192
    v_mul_f32 v193, s10, v193
    v_fma_f32 v193, -v192, v192, v193
    v_max_f32 v193, 0, v193
    v_add_f32 v193, 0x3727c5ac, v193
    v_rsq_f32 v18, v193
    v_xor_b32 v192, 0x80000000, v192
    v_and_b32 v194, 0xffff0000, v192
    v_sub_f32 v192, v192, v194
    v_lshrrev_b32 v209, 16, v194
    v_cvt_pk_bf16_f32 v195, 0, v192
    v_or_b32 v208, v209, v195
    v_mov_b32 v211, v209
    v_mov_b32 v210, v208

    v_pk_add_f32 v[200:201], v[200:201], v[202:203]
    v_pk_add_f32 v[204:205], v[204:205], v[206:207]
    v_pk_add_f32 v[200:201], v[200:201], v[204:205]

    v_mov_b32 v20, v200
    s_nop 1
    v_permlane32_swap_b32 v200, v20
    s_nop 1
    v_add_f32 v200, v200, v20
    v_mov_b32 v20, v201
    s_nop 1
    v_permlane32_swap_b32 v201, v20
    s_nop 1
    v_add_f32 v201, v201, v20
    v_mul_f32 v200, s10, v200
    v_mul_f32 v201, s10, v201
    v_fma_f32 v201, -v200, v200, v201
    v_max_f32 v201, 0, v201
    v_add_f32 v201, 0x3727c5ac, v201
    v_rsq_f32 v19, v201
    v_xor_b32 v200, 0x80000000, v200
    v_and_b32 v202, 0xffff0000, v200
    v_sub_f32 v200, v200, v202
    v_lshrrev_b32 v213, 16, v202
    v_cvt_pk_bf16_f32 v203, 0, v200
    v_or_b32 v212, v213, v203
    v_mov_b32 v215, v213
    v_mov_b32 v214, v212

    s_nop 1
    v_mfma_f32_32x32x16_bf16 v[84:99], v[180:183], v[208:211], v[84:99]
    v_mfma_f32_32x32x16_bf16 v[100:115], v[180:183], v[212:215], v[100:115]
    v_mfma_f32_32x32x16_bf16 v[116:131], v[184:187], v[208:211], v[116:131]
    v_mfma_f32_32x32x16_bf16 v[132:147], v[184:187], v[212:215], v[132:147]
    v_mfma_f32_32x32x16_bf16 v[148:163], v[188:191], v[208:211], v[148:163]
    v_mfma_f32_32x32x16_bf16 v[164:179], v[188:191], v[212:215], v[164:179]
    s_waitcnt lgkmcnt(5)
    v_mfma_f32_32x32x16_bf16 v[84:99], v[48:51], v[24:27], v[84:99]
    ds_read_b128 v[40:43], v9 offset:1024
    ds_read_b128 v[44:47], v9 offset:3072
    ds_read_b128 v[72:75], v13 offset:6144
    ds_read_b128 v[76:79], v13 offset:7168
    ds_read_b128 v[80:83], v13 offset:8192
    v_mfma_f32_32x32x16_bf16 v[100:115], v[48:51], v[28:31], v[100:115]
    v_mfma_f32_32x32x16_bf16 v[116:131], v[52:55], v[24:27], v[116:131]
    v_mfma_f32_32x32x16_bf16 v[132:147], v[52:55], v[28:31], v[132:147]
    v_mfma_f32_32x32x16_bf16 v[148:163], v[56:59], v[24:27], v[148:163]
    v_mfma_f32_32x32x16_bf16 v[164:179], v[56:59], v[28:31], v[164:179]
    s_waitcnt lgkmcnt(5)
    s_barrier
    v_mfma_f32_32x32x16_bf16 v[84:99], v[60:63], v[32:35], v[84:99]
    ds_read_b128 v[24:27], v9 offset:20480
    ds_read_b128 v[28:31], v9 offset:22528
    ds_read_b128 v[48:51], v13 offset:20480
    ds_read_b128 v[52:55], v13 offset:21504
    ds_read_b128 v[56:59], v13 offset:22528
    v_mfma_f32_32x32x16_bf16 v[100:115], v[60:63], v[36:39], v[100:115]
    v_mfma_f32_32x32x16_bf16 v[116:131], v[64:67], v[32:35], v[116:131]
    v_mfma_f32_32x32x16_bf16 v[132:147], v[64:67], v[36:39], v[132:147]
    v_mfma_f32_32x32x16_bf16 v[148:163], v[68:71], v[32:35], v[148:163]
    v_mfma_f32_32x32x16_bf16 v[164:179], v[68:71], v[36:39], v[164:179]
    s_waitcnt lgkmcnt(5)
    v_mfma_f32_32x32x16_bf16 v[84:99], v[72:75], v[40:43], v[84:99]
    ds_read_b128 v[32:35], v9 offset:21504
    ds_read_b128 v[36:39], v9 offset:23552
    ds_read_b128 v[60:63], v13 offset:26624
    ds_read_b128 v[64:67], v13 offset:27648
    ds_read_b128 v[68:71], v13 offset:28672
    v_mfma_f32_32x32x16_bf16 v[100:115], v[72:75], v[44:47], v[100:115]
    v_mfma_f32_32x32x16_bf16 v[116:131], v[76:79], v[40:43], v[116:131]
    v_mfma_f32_32x32x16_bf16 v[132:147], v[76:79], v[44:47], v[132:147]
    v_mfma_f32_32x32x16_bf16 v[148:163], v[80:83], v[40:43], v[148:163]
    v_mfma_f32_32x32x16_bf16 v[164:179], v[80:83], v[44:47], v[164:179]
    s_waitcnt lgkmcnt(5)
    s_barrier
    v_mfma_f32_32x32x16_bf16 v[84:99], v[48:51], v[24:27], v[84:99]
    ds_read_b128 v[40:43], v9 offset:40960
    ds_read_b128 v[44:47], v9 offset:43008
    ds_read_b128 v[72:75], v13 offset:40960
    ds_read_b128 v[76:79], v13 offset:41984
    ds_read_b128 v[80:83], v13 offset:43008
    v_mfma_f32_32x32x16_bf16 v[100:115], v[48:51], v[28:31], v[100:115]
    v_mfma_f32_32x32x16_bf16 v[116:131], v[52:55], v[24:27], v[116:131]
    v_mfma_f32_32x32x16_bf16 v[132:147], v[52:55], v[28:31], v[132:147]
    v_mfma_f32_32x32x16_bf16 v[148:163], v[56:59], v[24:27], v[148:163]
    v_mfma_f32_32x32x16_bf16 v[164:179], v[56:59], v[28:31], v[164:179]
    s_waitcnt lgkmcnt(5)
    v_mfma_f32_32x32x16_bf16 v[84:99], v[60:63], v[32:35], v[84:99]
    ds_read_b128 v[24:27], v9 offset:41984
    ds_read_b128 v[28:31], v9 offset:44032
    ds_read_b128 v[48:51], v13 offset:47104
    ds_read_b128 v[52:55], v13 offset:48128
    ds_read_b128 v[56:59], v13 offset:49152
    v_mfma_f32_32x32x16_bf16 v[100:115], v[60:63], v[36:39], v[100:115]
    v_mfma_f32_32x32x16_bf16 v[116:131], v[64:67], v[32:35], v[116:131]
    v_mfma_f32_32x32x16_bf16 v[132:147], v[64:67], v[36:39], v[132:147]
    v_mfma_f32_32x32x16_bf16 v[148:163], v[68:71], v[32:35], v[148:163]
    v_mfma_f32_32x32x16_bf16 v[164:179], v[68:71], v[36:39], v[164:179]
    s_waitcnt lgkmcnt(5)
    s_barrier
    v_mfma_f32_32x32x16_bf16 v[84:99], v[72:75], v[40:43], v[84:99]
    ds_read_b128 v[32:35], v10 offset:0
    ds_read_b128 v[36:39], v10 offset:2048
    ds_read_b128 v[60:63], v14 offset:0
    ds_read_b128 v[64:67], v14 offset:1024
    ds_read_b128 v[68:71], v14 offset:2048
    v_mfma_f32_32x32x16_bf16 v[100:115], v[72:75], v[44:47], v[100:115]
    v_mfma_f32_32x32x16_bf16 v[116:131], v[76:79], v[40:43], v[116:131]
    v_mfma_f32_32x32x16_bf16 v[132:147], v[76:79], v[44:47], v[132:147]
    v_mfma_f32_32x32x16_bf16 v[148:163], v[80:83], v[40:43], v[148:163]
    v_mfma_f32_32x32x16_bf16 v[164:179], v[80:83], v[44:47], v[164:179]
    s_waitcnt lgkmcnt(5)
    v_mfma_f32_32x32x16_bf16 v[84:99], v[48:51], v[24:27], v[84:99]
    ds_read_b128 v[40:43], v10 offset:1024
    ds_read_b128 v[44:47], v10 offset:3072
    ds_read_b128 v[72:75], v14 offset:6144
    ds_read_b128 v[76:79], v14 offset:7168
    ds_read_b128 v[80:83], v14 offset:8192
    v_mfma_f32_32x32x16_bf16 v[100:115], v[48:51], v[28:31], v[100:115]
    v_mfma_f32_32x32x16_bf16 v[116:131], v[52:55], v[24:27], v[116:131]
    v_mfma_f32_32x32x16_bf16 v[132:147], v[52:55], v[28:31], v[132:147]
    v_mfma_f32_32x32x16_bf16 v[148:163], v[56:59], v[24:27], v[148:163]
    v_mfma_f32_32x32x16_bf16 v[164:179], v[56:59], v[28:31], v[164:179]
    s_waitcnt lgkmcnt(5)
    s_barrier
    v_mfma_f32_32x32x16_bf16 v[84:99], v[60:63], v[32:35], v[84:99]
    ds_read_b128 v[24:27], v10 offset:20480
    ds_read_b128 v[28:31], v10 offset:22528
    ds_read_b128 v[48:51], v14 offset:20480
    ds_read_b128 v[52:55], v14 offset:21504
    ds_read_b128 v[56:59], v14 offset:22528
    v_mfma_f32_32x32x16_bf16 v[100:115], v[60:63], v[36:39], v[100:115]
    v_mfma_f32_32x32x16_bf16 v[116:131], v[64:67], v[32:35], v[116:131]
    v_mfma_f32_32x32x16_bf16 v[132:147], v[64:67], v[36:39], v[132:147]
    v_mfma_f32_32x32x16_bf16 v[148:163], v[68:71], v[32:35], v[148:163]
    v_mfma_f32_32x32x16_bf16 v[164:179], v[68:71], v[36:39], v[164:179]
    s_waitcnt lgkmcnt(5)
    v_mfma_f32_32x32x16_bf16 v[84:99], v[72:75], v[40:43], v[84:99]
    ds_read_b128 v[32:35], v10 offset:21504
    ds_read_b128 v[36:39], v10 offset:23552
    ds_read_b128 v[60:63], v14 offset:26624
    ds_read_b128 v[64:67], v14 offset:27648
    ds_read_b128 v[68:71], v14 offset:28672
    v_mfma_f32_32x32x16_bf16 v[100:115], v[72:75], v[44:47], v[100:115]
    v_mfma_f32_32x32x16_bf16 v[116:131], v[76:79], v[40:43], v[116:131]
    v_mfma_f32_32x32x16_bf16 v[132:147], v[76:79], v[44:47], v[132:147]
    v_mfma_f32_32x32x16_bf16 v[148:163], v[80:83], v[40:43], v[148:163]
    v_mfma_f32_32x32x16_bf16 v[164:179], v[80:83], v[44:47], v[164:179]
    s_waitcnt lgkmcnt(5)
    s_barrier
    v_mfma_f32_32x32x16_bf16 v[84:99], v[48:51], v[24:27], v[84:99]
    ds_read_b128 v[40:43], v8 offset:0
    ds_read_b128 v[44:47], v8 offset:2048
    ds_read_b128 v[72:75], v12 offset:0
    ds_read_b128 v[76:79], v12 offset:1024
    ds_read_b128 v[80:83], v12 offset:2048
    v_mfma_f32_32x32x16_bf16 v[100:115], v[48:51], v[28:31], v[100:115]
    v_mfma_f32_32x32x16_bf16 v[116:131], v[52:55], v[24:27], v[116:131]
    v_mfma_f32_32x32x16_bf16 v[132:147], v[52:55], v[28:31], v[132:147]
    v_mfma_f32_32x32x16_bf16 v[148:163], v[56:59], v[24:27], v[148:163]
    v_mfma_f32_32x32x16_bf16 v[164:179], v[56:59], v[28:31], v[164:179]
    s_waitcnt lgkmcnt(5)
    v_mfma_f32_32x32x16_bf16 v[84:99], v[60:63], v[32:35], v[84:99]
    ds_read_b128 v[24:27], v8 offset:1024
    ds_read_b128 v[28:31], v8 offset:3072
    ds_read_b128 v[48:51], v12 offset:6144
    ds_read_b128 v[52:55], v12 offset:7168
    ds_read_b128 v[56:59], v12 offset:8192
    v_mfma_f32_32x32x16_bf16 v[100:115], v[60:63], v[36:39], v[100:115]
    v_mfma_f32_32x32x16_bf16 v[116:131], v[64:67], v[32:35], v[116:131]
    v_mfma_f32_32x32x16_bf16 v[132:147], v[64:67], v[36:39], v[132:147]
    v_mfma_f32_32x32x16_bf16 v[148:163], v[68:71], v[32:35], v[148:163]
    v_mfma_f32_32x32x16_bf16 v[164:179], v[68:71], v[36:39], v[164:179]
    s_waitcnt lgkmcnt(5)
    s_barrier
    v_mfma_f32_32x32x16_bf16 v[84:99], v[72:75], v[40:43], v[84:99]
    ds_read_b128 v[32:35], v8 offset:20480
    ds_read_b128 v[36:39], v8 offset:22528
    ds_read_b128 v[60:63], v12 offset:20480
    ds_read_b128 v[64:67], v12 offset:21504
    ds_read_b128 v[68:71], v12 offset:22528
    v_mfma_f32_32x32x16_bf16 v[100:115], v[72:75], v[44:47], v[100:115]
    v_mfma_f32_32x32x16_bf16 v[116:131], v[76:79], v[40:43], v[116:131]
    v_mfma_f32_32x32x16_bf16 v[132:147], v[76:79], v[44:47], v[132:147]
    v_mfma_f32_32x32x16_bf16 v[148:163], v[80:83], v[40:43], v[148:163]
    v_mfma_f32_32x32x16_bf16 v[164:179], v[80:83], v[44:47], v[164:179]
    s_waitcnt lgkmcnt(5)
    v_mfma_f32_32x32x16_bf16 v[84:99], v[48:51], v[24:27], v[84:99]
    ds_read_b128 v[40:43], v8 offset:21504
    ds_read_b128 v[44:47], v8 offset:23552
    ds_read_b128 v[72:75], v12 offset:26624
    ds_read_b128 v[76:79], v12 offset:27648
    ds_read_b128 v[80:83], v12 offset:28672
    v_mfma_f32_32x32x16_bf16 v[100:115], v[48:51], v[28:31], v[100:115]
    v_mfma_f32_32x32x16_bf16 v[116:131], v[52:55], v[24:27], v[116:131]
    v_mfma_f32_32x32x16_bf16 v[132:147], v[52:55], v[28:31], v[132:147]
    v_mfma_f32_32x32x16_bf16 v[148:163], v[56:59], v[24:27], v[148:163]
    v_mfma_f32_32x32x16_bf16 v[164:179], v[56:59], v[28:31], v[164:179]
    s_waitcnt lgkmcnt(5)
    s_barrier
    v_mfma_f32_32x32x16_bf16 v[84:99], v[60:63], v[32:35], v[84:99]
    ds_read_b128 v[24:27], v8 offset:40960
    ds_read_b128 v[28:31], v8 offset:43008
    ds_read_b128 v[48:51], v12 offset:40960
    ds_read_b128 v[52:55], v12 offset:41984
    ds_read_b128 v[56:59], v12 offset:43008
    v_mfma_f32_32x32x16_bf16 v[100:115], v[60:63], v[36:39], v[100:115]
    v_mfma_f32_32x32x16_bf16 v[116:131], v[64:67], v[32:35], v[116:131]
    v_mfma_f32_32x32x16_bf16 v[132:147], v[64:67], v[36:39], v[132:147]
    v_mfma_f32_32x32x16_bf16 v[148:163], v[68:71], v[32:35], v[148:163]
    v_mfma_f32_32x32x16_bf16 v[164:179], v[68:71], v[36:39], v[164:179]
    s_waitcnt lgkmcnt(5)
    v_mfma_f32_32x32x16_bf16 v[84:99], v[72:75], v[40:43], v[84:99]
    ds_read_b128 v[32:35], v8 offset:41984
    ds_read_b128 v[36:39], v8 offset:44032
    ds_read_b128 v[60:63], v12 offset:47104
    ds_read_b128 v[64:67], v12 offset:48128
    ds_read_b128 v[68:71], v12 offset:49152
    v_mfma_f32_32x32x16_bf16 v[100:115], v[72:75], v[44:47], v[100:115]
    v_mfma_f32_32x32x16_bf16 v[116:131], v[76:79], v[40:43], v[116:131]
    v_mfma_f32_32x32x16_bf16 v[132:147], v[76:79], v[44:47], v[132:147]
    v_mfma_f32_32x32x16_bf16 v[148:163], v[80:83], v[40:43], v[148:163]
    v_mfma_f32_32x32x16_bf16 v[164:179], v[80:83], v[44:47], v[164:179]
    s_waitcnt lgkmcnt(5)
    s_barrier
    v_mfma_f32_32x32x16_bf16 v[84:99], v[48:51], v[24:27], v[84:99]
    ds_read_b128 v[40:43], v9 offset:0
    ds_read_b128 v[44:47], v9 offset:2048
    ds_read_b128 v[72:75], v13 offset:0
    ds_read_b128 v[76:79], v13 offset:1024
    ds_read_b128 v[80:83], v13 offset:2048
    v_mfma_f32_32x32x16_bf16 v[100:115], v[48:51], v[28:31], v[100:115]
    v_mfma_f32_32x32x16_bf16 v[116:131], v[52:55], v[24:27], v[116:131]
    v_mfma_f32_32x32x16_bf16 v[132:147], v[52:55], v[28:31], v[132:147]
    v_mfma_f32_32x32x16_bf16 v[148:163], v[56:59], v[24:27], v[148:163]
    v_mfma_f32_32x32x16_bf16 v[164:179], v[56:59], v[28:31], v[164:179]
    s_waitcnt lgkmcnt(5)
    v_mfma_f32_32x32x16_bf16 v[84:99], v[60:63], v[32:35], v[84:99]
    ds_read_b128 v[24:27], v9 offset:1024
    ds_read_b128 v[28:31], v9 offset:3072
    ds_read_b128 v[48:51], v13 offset:6144
    ds_read_b128 v[52:55], v13 offset:7168
    ds_read_b128 v[56:59], v13 offset:8192
    v_mfma_f32_32x32x16_bf16 v[100:115], v[60:63], v[36:39], v[100:115]
    v_mfma_f32_32x32x16_bf16 v[116:131], v[64:67], v[32:35], v[116:131]
    v_mfma_f32_32x32x16_bf16 v[132:147], v[64:67], v[36:39], v[132:147]
    v_mfma_f32_32x32x16_bf16 v[148:163], v[68:71], v[32:35], v[148:163]
    v_mfma_f32_32x32x16_bf16 v[164:179], v[68:71], v[36:39], v[164:179]
    s_waitcnt lgkmcnt(5)
    v_mfma_f32_32x32x16_bf16 v[84:99], v[72:75], v[40:43], v[84:99]
    v_mfma_f32_32x32x16_bf16 v[100:115], v[72:75], v[44:47], v[100:115]
    v_mfma_f32_32x32x16_bf16 v[116:131], v[76:79], v[40:43], v[116:131]
    v_mfma_f32_32x32x16_bf16 v[132:147], v[76:79], v[44:47], v[132:147]
    v_mfma_f32_32x32x16_bf16 v[148:163], v[80:83], v[40:43], v[148:163]
    v_mfma_f32_32x32x16_bf16 v[164:179], v[80:83], v[44:47], v[164:179]
    s_waitcnt lgkmcnt(0)
    s_barrier
    v_mfma_f32_32x32x16_bf16 v[84:99], v[48:51], v[24:27], v[84:99]
    v_mfma_f32_32x32x16_bf16 v[100:115], v[48:51], v[28:31], v[100:115]
    v_mfma_f32_32x32x16_bf16 v[116:131], v[52:55], v[24:27], v[116:131]
    v_mfma_f32_32x32x16_bf16 v[132:147], v[52:55], v[28:31], v[132:147]
    v_mfma_f32_32x32x16_bf16 v[148:163], v[56:59], v[24:27], v[148:163]
    v_mfma_f32_32x32x16_bf16 v[164:179], v[56:59], v[28:31], v[164:179]
    v_mul_f32 v8, v18, v18
    v_mul_f32 v9, v18, v18
    v_mul_f32 v10, v19, v19
    v_mul_f32 v11, v19, v19
    s_nop 7
    v_max_f32 v84, 0, v84
    v_max_f32 v85, 0, v85
    v_max_f32 v86, 0, v86
    v_max_f32 v87, 0, v87
    v_max_f32 v88, 0, v88
    v_max_f32 v89, 0, v89
    v_max_f32 v90, 0, v90
    v_max_f32 v91, 0, v91
    v_pk_mul_f32 v[92:93], v[92:93], v[8:9]
    v_pk_mul_f32 v[94:95], v[94:95], v[8:9]
    v_pk_mul_f32 v[96:97], v[96:97], v[8:9]
    v_pk_mul_f32 v[98:99], v[98:99], v[8:9]
    v_pk_mul_f32 v[84:85], v[84:85], v[92:93]
    v_pk_mul_f32 v[86:87], v[86:87], v[94:95]
    v_pk_mul_f32 v[88:89], v[88:89], v[96:97]
    v_pk_mul_f32 v[90:91], v[90:91], v[98:99]
    v_cvt_pk_bf16_f32 v24, v84, v85
    v_cvt_pk_bf16_f32 v25, v86, v87
    v_cvt_pk_bf16_f32 v26, v88, v89
    v_cvt_pk_bf16_f32 v27, v90, v91
    buffer_store_dwordx4 v[24:27], v22, s[48:51], s61 offen offset:0 sc1
    v_max_f32 v100, 0, v100
    v_max_f32 v101, 0, v101
    v_max_f32 v102, 0, v102
    v_max_f32 v103, 0, v103
    v_max_f32 v104, 0, v104
    v_max_f32 v105, 0, v105
    v_max_f32 v106, 0, v106
    v_max_f32 v107, 0, v107
    v_pk_mul_f32 v[108:109], v[108:109], v[10:11]
    v_pk_mul_f32 v[110:111], v[110:111], v[10:11]
    v_pk_mul_f32 v[112:113], v[112:113], v[10:11]
    v_pk_mul_f32 v[114:115], v[114:115], v[10:11]
    v_pk_mul_f32 v[100:101], v[100:101], v[108:109]
    v_pk_mul_f32 v[102:103], v[102:103], v[110:111]
    v_pk_mul_f32 v[104:105], v[104:105], v[112:113]
    v_pk_mul_f32 v[106:107], v[106:107], v[114:115]
    v_cvt_pk_bf16_f32 v36, v100, v101
    v_cvt_pk_bf16_f32 v37, v102, v103
    v_cvt_pk_bf16_f32 v38, v104, v105
    v_cvt_pk_bf16_f32 v39, v106, v107
    buffer_store_dwordx4 v[36:39], v23, s[48:51], s61 offen offset:0 sc1
    v_max_f32 v116, 0, v116
    v_max_f32 v117, 0, v117
    v_max_f32 v118, 0, v118
    v_max_f32 v119, 0, v119
    v_max_f32 v120, 0, v120
    v_max_f32 v121, 0, v121
    v_max_f32 v122, 0, v122
    v_max_f32 v123, 0, v123
    v_pk_mul_f32 v[124:125], v[124:125], v[8:9]
    v_pk_mul_f32 v[126:127], v[126:127], v[8:9]
    v_pk_mul_f32 v[128:129], v[128:129], v[8:9]
    v_pk_mul_f32 v[130:131], v[130:131], v[8:9]
    v_pk_mul_f32 v[116:117], v[116:117], v[124:125]
    v_pk_mul_f32 v[118:119], v[118:119], v[126:127]
    v_pk_mul_f32 v[120:121], v[120:121], v[128:129]
    v_pk_mul_f32 v[122:123], v[122:123], v[130:131]
    v_cvt_pk_bf16_f32 v28, v116, v117
    v_cvt_pk_bf16_f32 v29, v118, v119
    v_cvt_pk_bf16_f32 v30, v120, v121
    v_cvt_pk_bf16_f32 v31, v122, v123
    buffer_store_dwordx4 v[28:31], v22, s[48:51], s61 offen offset:512 sc1
    v_max_f32 v132, 0, v132
    v_max_f32 v133, 0, v133
    v_max_f32 v134, 0, v134
    v_max_f32 v135, 0, v135
    v_max_f32 v136, 0, v136
    v_max_f32 v137, 0, v137
    v_max_f32 v138, 0, v138
    v_max_f32 v139, 0, v139
    v_pk_mul_f32 v[140:141], v[140:141], v[10:11]
    v_pk_mul_f32 v[142:143], v[142:143], v[10:11]
    v_pk_mul_f32 v[144:145], v[144:145], v[10:11]
    v_pk_mul_f32 v[146:147], v[146:147], v[10:11]
    v_pk_mul_f32 v[132:133], v[132:133], v[140:141]
    v_pk_mul_f32 v[134:135], v[134:135], v[142:143]
    v_pk_mul_f32 v[136:137], v[136:137], v[144:145]
    v_pk_mul_f32 v[138:139], v[138:139], v[146:147]
    v_cvt_pk_bf16_f32 v40, v132, v133
    v_cvt_pk_bf16_f32 v41, v134, v135
    v_cvt_pk_bf16_f32 v42, v136, v137
    v_cvt_pk_bf16_f32 v43, v138, v139
    buffer_store_dwordx4 v[40:43], v23, s[48:51], s61 offen offset:512 sc1
    v_max_f32 v148, 0, v148
    v_max_f32 v149, 0, v149
    v_max_f32 v150, 0, v150
    v_max_f32 v151, 0, v151
    v_max_f32 v152, 0, v152
    v_max_f32 v153, 0, v153
    v_max_f32 v154, 0, v154
    v_max_f32 v155, 0, v155
    v_pk_mul_f32 v[156:157], v[156:157], v[8:9]
    v_pk_mul_f32 v[158:159], v[158:159], v[8:9]
    v_pk_mul_f32 v[160:161], v[160:161], v[8:9]
    v_pk_mul_f32 v[162:163], v[162:163], v[8:9]
    v_pk_mul_f32 v[148:149], v[148:149], v[156:157]
    v_pk_mul_f32 v[150:151], v[150:151], v[158:159]
    v_pk_mul_f32 v[152:153], v[152:153], v[160:161]
    v_pk_mul_f32 v[154:155], v[154:155], v[162:163]
    v_cvt_pk_bf16_f32 v32, v148, v149
    v_cvt_pk_bf16_f32 v33, v150, v151
    v_cvt_pk_bf16_f32 v34, v152, v153
    v_cvt_pk_bf16_f32 v35, v154, v155
    buffer_store_dwordx4 v[32:35], v22, s[48:51], s61 offen offset:1024 sc1
    v_max_f32 v164, 0, v164
    v_max_f32 v165, 0, v165
    v_max_f32 v166, 0, v166
    v_max_f32 v167, 0, v167
    v_max_f32 v168, 0, v168
    v_max_f32 v169, 0, v169
    v_max_f32 v170, 0, v170
    v_max_f32 v171, 0, v171
    v_pk_mul_f32 v[172:173], v[172:173], v[10:11]
    v_pk_mul_f32 v[174:175], v[174:175], v[10:11]
    v_pk_mul_f32 v[176:177], v[176:177], v[10:11]
    v_pk_mul_f32 v[178:179], v[178:179], v[10:11]
    v_pk_mul_f32 v[164:165], v[164:165], v[172:173]
    v_pk_mul_f32 v[166:167], v[166:167], v[174:175]
    v_pk_mul_f32 v[168:169], v[168:169], v[176:177]
    v_pk_mul_f32 v[170:171], v[170:171], v[178:179]
    v_cvt_pk_bf16_f32 v44, v164, v165
    v_cvt_pk_bf16_f32 v45, v166, v167
    v_cvt_pk_bf16_f32 v46, v168, v169
    v_cvt_pk_bf16_f32 v47, v170, v171
    buffer_store_dwordx4 v[44:47], v23, s[48:51], s61 offen offset:1024 sc1
    s_add_u32 s44, s34, 44564480
    s_addc_u32 s45, s35, 0
    s_mov_b32 s46, 46080
    s_mov_b32 s47, 0x00020000
    s_mul_i32 s12, s98, 12288
    s_lshl_b32 s8, s36, 8
    s_add_u32 s12, s12, s8
    s_add_u32 s12, s12, 4096
    s_lshl_b32 s13, s37, 4
    s_add_u32 s12, s12, s13
    s_lshl_b32 s13, s7, 2
    s_add_u32 s12, s12, s13
    v_mov_b32 v1, 1
    s_mov_b64 exec, 1
    s_waitcnt vmcnt(0)
    buffer_store_dword v1, off, s[44:47], s12 sc1
    s_mov_b64 exec, -1
    s_barrier

    s_mov_b32 s40, s34
    s_mov_b32 s41, s35
    s_mov_b32 s42, 2621440
    s_mov_b32 s43, 0x00020000
    s_lshl_b32 s43, s98, 26
    s_add_u32 s40, s40, s43
    s_addc_u32 s41, s41, 0
    s_mov_b32 s43, 0x00020000
    s_mov_b32 s48, s96
    s_mov_b32 s49, s97
    s_mov_b32 s50, 2621440
    s_mov_b32 s51, 0x00020000
    s_add_u32 s56, s34, 44040192
    s_addc_u32 s57, s35, 0
    s_mov_b32 s58, 131072
    s_mov_b32 s59, 0x00020000
    s_lshl_b32 s59, s98, 26
    s_add_u32 s56, s56, s59
    s_addc_u32 s57, s57, 0
    s_mov_b32 s59, 0x00020000
    s_lshl_b32 s10, s38, 6
    s_lshl_b32 s11, s7, 4
    s_add_u32 s10, s10, s11
    v_and_b32 v4, 15, v2
    v_add_u32 v4, s10, v4
    v_and_b32 v9, 63, v4
    v_lshlrev_b32 v9, 3, v9
    v_lshrrev_b32 v1, 4, v2
    s_lshr_b32 s10, s10, 5
    s_mul_i32 s10, s10, 40960
    s_mul_i32 s11, s39, 5120
    s_add_u32 s10, s10, s11
    v_and_b32 v5, 31, v4
    v_lshl_add_u32 v5, v5, 4, s10
    v_lshrrev_b32 v6, 1, v1
    v_lshl_add_u32 v5, v6, 9, v5
    v_and_b32 v6, 1, v1
    v_lshl_add_u32 v3, v6, 3, v5
    v_lshl_add_u32 v112, v6, 10, v5
    s_movk_i32 s62, 0x1000
    v_mul_u32_u24 v4, 1280, v4
    s_mul_i32 s11, s39, 160
    v_add_u32 v4, s11, v4
    v_lshl_add_u32 v8, v1, 3, v4
    v_lshl_add_u32 v113, v6, 5, v4
    v_lshrrev_b32 v6, 1, v1
    v_lshl_add_u32 v113, v6, 4, v113

    buffer_load_dwordx2 v[10:11], v3, s[40:43], 0 offen offset:0 sc1
    buffer_load_dwordx2 v[12:13], v3, s[40:43], 0 offen offset:1024 sc1
    buffer_load_dwordx2 v[14:15], v3, s[40:43], 0 offen offset:2048 sc1
    buffer_load_dwordx2 v[16:17], v3, s[40:43], 0 offen offset:3072 sc1
    buffer_load_dwordx2 v[18:19], v3, s[40:43], s62 offen sc1
    s_lshl_b32 s10, s7, 11
    v_lshl_add_u32 v4, v2, 4, s10
    v_add_u32 v5, 73728, v4
    v_lshlrev_b32 v6, 4, v2
    v_add_u32 v6, 8192, v6
    v_add_u32 v7, 73728, v6
    s_lshl_b32 s61, s38, 3
    s_add_u32 s61, s61, s39
    s_lshl_b32 s61, s61, 9

    s_barrier
    ds_read_b128 v[20:23], v4 offset:0
    ds_read_b128 v[32:35], v6 offset:0
    ds_read_b128 v[36:39], v6 offset:1024
    ds_read_b128 v[40:43], v6 offset:2048
    ds_read_b128 v[44:47], v6 offset:3072
    ds_read_b128 v[48:51], v6 offset:4096
    ds_read_b128 v[24:27], v4 offset:1024
    ds_read_b128 v[52:55], v6 offset:5120
    ds_read_b128 v[56:59], v6 offset:6144
    ds_read_b128 v[60:63], v6 offset:7168
    ds_read_b128 v[64:67], v6 offset:8192
    ds_read_b128 v[68:71], v6 offset:9216
    s_waitcnt lgkmcnt(6)
    s_barrier
    v_mfma_f32_16x16x32_bf16 v[92:95], v[32:35], v[20:23], 0
    ds_read_b128 v[28:31], v4 offset:18432
    ds_read_b128 v[72:75], v6 offset:18432
    ds_read_b128 v[76:79], v6 offset:19456
    ds_read_b128 v[80:83], v6 offset:20480
    ds_read_b128 v[84:87], v6 offset:21504
    ds_read_b128 v[88:91], v6 offset:22528
    v_mfma_f32_16x16x32_bf16 v[96:99], v[36:39], v[20:23], 0
    v_mfma_f32_16x16x32_bf16 v[100:103], v[40:43], v[20:23], 0
    v_mfma_f32_16x16x32_bf16 v[104:107], v[44:47], v[20:23], 0
    v_mfma_f32_16x16x32_bf16 v[108:111], v[48:51], v[20:23], 0
    s_waitcnt lgkmcnt(6)
    v_mfma_f32_16x16x32_bf16 v[92:95], v[52:55], v[24:27], v[92:95]
    ds_read_b128 v[20:23], v4 offset:19456
    ds_read_b128 v[32:35], v6 offset:23552
    ds_read_b128 v[36:39], v6 offset:24576
    ds_read_b128 v[40:43], v6 offset:25600
    ds_read_b128 v[44:47], v6 offset:26624
    ds_read_b128 v[48:51], v6 offset:27648
    v_mfma_f32_16x16x32_bf16 v[96:99], v[56:59], v[24:27], v[96:99]
    v_mfma_f32_16x16x32_bf16 v[100:103], v[60:63], v[24:27], v[100:103]
    v_mfma_f32_16x16x32_bf16 v[104:107], v[64:67], v[24:27], v[104:107]
    v_mfma_f32_16x16x32_bf16 v[108:111], v[68:71], v[24:27], v[108:111]
    s_waitcnt lgkmcnt(6)
    s_barrier
    v_mfma_f32_16x16x32_bf16 v[92:95], v[72:75], v[28:31], v[92:95]
    ds_read_b128 v[24:27], v4 offset:36864
    ds_read_b128 v[52:55], v6 offset:36864
    ds_read_b128 v[56:59], v6 offset:37888
    ds_read_b128 v[60:63], v6 offset:38912
    ds_read_b128 v[64:67], v6 offset:39936
    ds_read_b128 v[68:71], v6 offset:40960
    v_mfma_f32_16x16x32_bf16 v[96:99], v[76:79], v[28:31], v[96:99]
    v_mfma_f32_16x16x32_bf16 v[100:103], v[80:83], v[28:31], v[100:103]
    v_mfma_f32_16x16x32_bf16 v[104:107], v[84:87], v[28:31], v[104:107]
    v_mfma_f32_16x16x32_bf16 v[108:111], v[88:91], v[28:31], v[108:111]
    s_waitcnt lgkmcnt(6)
    v_mfma_f32_16x16x32_bf16 v[92:95], v[32:35], v[20:23], v[92:95]
    ds_read_b128 v[28:31], v4 offset:37888
    ds_read_b128 v[72:75], v6 offset:41984
    ds_read_b128 v[76:79], v6 offset:43008
    ds_read_b128 v[80:83], v6 offset:44032
    ds_read_b128 v[84:87], v6 offset:45056
    ds_read_b128 v[88:91], v6 offset:46080
    v_mfma_f32_16x16x32_bf16 v[96:99], v[36:39], v[20:23], v[96:99]
    v_mfma_f32_16x16x32_bf16 v[100:103], v[40:43], v[20:23], v[100:103]
    v_mfma_f32_16x16x32_bf16 v[104:107], v[44:47], v[20:23], v[104:107]
    v_mfma_f32_16x16x32_bf16 v[108:111], v[48:51], v[20:23], v[108:111]
    s_waitcnt lgkmcnt(6)
    s_barrier
    v_mfma_f32_16x16x32_bf16 v[92:95], v[52:55], v[24:27], v[92:95]
    ds_read_b128 v[20:23], v4 offset:55296
    ds_read_b128 v[32:35], v6 offset:55296
    ds_read_b128 v[36:39], v6 offset:56320
    ds_read_b128 v[40:43], v6 offset:57344
    ds_read_b128 v[44:47], v6 offset:58368
    ds_read_b128 v[48:51], v6 offset:59392
    v_mfma_f32_16x16x32_bf16 v[96:99], v[56:59], v[24:27], v[96:99]
    v_mfma_f32_16x16x32_bf16 v[100:103], v[60:63], v[24:27], v[100:103]
    v_mfma_f32_16x16x32_bf16 v[104:107], v[64:67], v[24:27], v[104:107]
    v_mfma_f32_16x16x32_bf16 v[108:111], v[68:71], v[24:27], v[108:111]
    s_waitcnt lgkmcnt(6)
    v_mfma_f32_16x16x32_bf16 v[92:95], v[72:75], v[28:31], v[92:95]
    ds_read_b128 v[24:27], v4 offset:56320
    ds_read_b128 v[52:55], v6 offset:60416
    ds_read_b128 v[56:59], v6 offset:61440
    ds_read_b128 v[60:63], v6 offset:62464
    ds_read_b128 v[64:67], v6 offset:63488
    ds_read_b128 v[68:71], v6 offset:64512
    v_mfma_f32_16x16x32_bf16 v[96:99], v[76:79], v[28:31], v[96:99]
    v_mfma_f32_16x16x32_bf16 v[100:103], v[80:83], v[28:31], v[100:103]
    v_mfma_f32_16x16x32_bf16 v[104:107], v[84:87], v[28:31], v[104:107]
    v_mfma_f32_16x16x32_bf16 v[108:111], v[88:91], v[28:31], v[108:111]
    s_waitcnt lgkmcnt(6)
    s_barrier
    v_mfma_f32_16x16x32_bf16 v[92:95], v[32:35], v[20:23], v[92:95]
    ds_read_b128 v[28:31], v5 offset:0
    ds_read_b128 v[72:75], v7 offset:0
    ds_read_b128 v[76:79], v7 offset:1024
    ds_read_b128 v[80:83], v7 offset:2048
    ds_read_b128 v[84:87], v7 offset:3072
    ds_read_b128 v[88:91], v7 offset:4096
    v_mfma_f32_16x16x32_bf16 v[96:99], v[36:39], v[20:23], v[96:99]
    v_mfma_f32_16x16x32_bf16 v[100:103], v[40:43], v[20:23], v[100:103]
    v_mfma_f32_16x16x32_bf16 v[104:107], v[44:47], v[20:23], v[104:107]
    v_mfma_f32_16x16x32_bf16 v[108:111], v[48:51], v[20:23], v[108:111]
    s_waitcnt lgkmcnt(6)
    v_mfma_f32_16x16x32_bf16 v[92:95], v[52:55], v[24:27], v[92:95]
    ds_read_b128 v[20:23], v5 offset:1024
    ds_read_b128 v[32:35], v7 offset:5120
    ds_read_b128 v[36:39], v7 offset:6144
    ds_read_b128 v[40:43], v7 offset:7168
    ds_read_b128 v[44:47], v7 offset:8192
    ds_read_b128 v[48:51], v7 offset:9216
    v_mfma_f32_16x16x32_bf16 v[96:99], v[56:59], v[24:27], v[96:99]
    v_mfma_f32_16x16x32_bf16 v[100:103], v[60:63], v[24:27], v[100:103]
    v_mfma_f32_16x16x32_bf16 v[104:107], v[64:67], v[24:27], v[104:107]
    v_mfma_f32_16x16x32_bf16 v[108:111], v[68:71], v[24:27], v[108:111]
    s_waitcnt lgkmcnt(6)
    s_barrier
    v_mfma_f32_16x16x32_bf16 v[92:95], v[72:75], v[28:31], v[92:95]
    ds_read_b128 v[24:27], v5 offset:18432
    ds_read_b128 v[52:55], v7 offset:18432
    ds_read_b128 v[56:59], v7 offset:19456
    ds_read_b128 v[60:63], v7 offset:20480
    ds_read_b128 v[64:67], v7 offset:21504
    ds_read_b128 v[68:71], v7 offset:22528
    v_mfma_f32_16x16x32_bf16 v[96:99], v[76:79], v[28:31], v[96:99]
    v_mfma_f32_16x16x32_bf16 v[100:103], v[80:83], v[28:31], v[100:103]
    v_mfma_f32_16x16x32_bf16 v[104:107], v[84:87], v[28:31], v[104:107]
    v_mfma_f32_16x16x32_bf16 v[108:111], v[88:91], v[28:31], v[108:111]
    s_waitcnt lgkmcnt(6)
    v_mfma_f32_16x16x32_bf16 v[92:95], v[32:35], v[20:23], v[92:95]
    ds_read_b128 v[28:31], v5 offset:19456
    ds_read_b128 v[72:75], v7 offset:23552
    ds_read_b128 v[76:79], v7 offset:24576
    ds_read_b128 v[80:83], v7 offset:25600
    ds_read_b128 v[84:87], v7 offset:26624
    ds_read_b128 v[88:91], v7 offset:27648
    v_mfma_f32_16x16x32_bf16 v[96:99], v[36:39], v[20:23], v[96:99]
    v_mfma_f32_16x16x32_bf16 v[100:103], v[40:43], v[20:23], v[100:103]
    v_mfma_f32_16x16x32_bf16 v[104:107], v[44:47], v[20:23], v[104:107]
    v_mfma_f32_16x16x32_bf16 v[108:111], v[48:51], v[20:23], v[108:111]
    s_waitcnt lgkmcnt(6)
    s_barrier
    v_mfma_f32_16x16x32_bf16 v[92:95], v[52:55], v[24:27], v[92:95]
    ds_read_b128 v[20:23], v5 offset:36864
    ds_read_b128 v[32:35], v7 offset:36864
    ds_read_b128 v[36:39], v7 offset:37888
    ds_read_b128 v[40:43], v7 offset:38912
    ds_read_b128 v[44:47], v7 offset:39936
    ds_read_b128 v[48:51], v7 offset:40960
    v_mfma_f32_16x16x32_bf16 v[96:99], v[56:59], v[24:27], v[96:99]
    v_mfma_f32_16x16x32_bf16 v[100:103], v[60:63], v[24:27], v[100:103]
    v_mfma_f32_16x16x32_bf16 v[104:107], v[64:67], v[24:27], v[104:107]
    v_mfma_f32_16x16x32_bf16 v[108:111], v[68:71], v[24:27], v[108:111]
    s_waitcnt lgkmcnt(6)
    v_mfma_f32_16x16x32_bf16 v[92:95], v[72:75], v[28:31], v[92:95]
    ds_read_b128 v[24:27], v5 offset:37888
    ds_read_b128 v[52:55], v7 offset:41984
    ds_read_b128 v[56:59], v7 offset:43008
    ds_read_b128 v[60:63], v7 offset:44032
    ds_read_b128 v[64:67], v7 offset:45056
    ds_read_b128 v[68:71], v7 offset:46080
    v_mfma_f32_16x16x32_bf16 v[96:99], v[76:79], v[28:31], v[96:99]
    v_mfma_f32_16x16x32_bf16 v[100:103], v[80:83], v[28:31], v[100:103]
    v_mfma_f32_16x16x32_bf16 v[104:107], v[84:87], v[28:31], v[104:107]
    v_mfma_f32_16x16x32_bf16 v[108:111], v[88:91], v[28:31], v[108:111]
    s_waitcnt lgkmcnt(6)
    s_barrier
    v_mfma_f32_16x16x32_bf16 v[92:95], v[32:35], v[20:23], v[92:95]
    ds_read_b128 v[28:31], v5 offset:55296
    ds_read_b128 v[72:75], v7 offset:55296
    ds_read_b128 v[76:79], v7 offset:56320
    ds_read_b128 v[80:83], v7 offset:57344
    ds_read_b128 v[84:87], v7 offset:58368
    ds_read_b128 v[88:91], v7 offset:59392
    v_mfma_f32_16x16x32_bf16 v[96:99], v[36:39], v[20:23], v[96:99]
    v_mfma_f32_16x16x32_bf16 v[100:103], v[40:43], v[20:23], v[100:103]
    v_mfma_f32_16x16x32_bf16 v[104:107], v[44:47], v[20:23], v[104:107]
    v_mfma_f32_16x16x32_bf16 v[108:111], v[48:51], v[20:23], v[108:111]
    s_waitcnt lgkmcnt(6)
    v_mfma_f32_16x16x32_bf16 v[92:95], v[52:55], v[24:27], v[92:95]
    ds_read_b128 v[20:23], v5 offset:56320
    ds_read_b128 v[32:35], v7 offset:60416
    ds_read_b128 v[36:39], v7 offset:61440
    ds_read_b128 v[40:43], v7 offset:62464
    ds_read_b128 v[44:47], v7 offset:63488
    ds_read_b128 v[48:51], v7 offset:64512
    v_mfma_f32_16x16x32_bf16 v[96:99], v[56:59], v[24:27], v[96:99]
    v_mfma_f32_16x16x32_bf16 v[100:103], v[60:63], v[24:27], v[100:103]
    v_mfma_f32_16x16x32_bf16 v[104:107], v[64:67], v[24:27], v[104:107]
    v_mfma_f32_16x16x32_bf16 v[108:111], v[68:71], v[24:27], v[108:111]
    s_waitcnt lgkmcnt(6)
    s_barrier
    v_mfma_f32_16x16x32_bf16 v[92:95], v[72:75], v[28:31], v[92:95]
    ds_read_b128 v[24:27], v4 offset:0
    ds_read_b128 v[52:55], v6 offset:0
    ds_read_b128 v[56:59], v6 offset:1024
    ds_read_b128 v[60:63], v6 offset:2048
    ds_read_b128 v[64:67], v6 offset:3072
    ds_read_b128 v[68:71], v6 offset:4096
    v_mfma_f32_16x16x32_bf16 v[96:99], v[76:79], v[28:31], v[96:99]
    v_mfma_f32_16x16x32_bf16 v[100:103], v[80:83], v[28:31], v[100:103]
    v_mfma_f32_16x16x32_bf16 v[104:107], v[84:87], v[28:31], v[104:107]
    v_mfma_f32_16x16x32_bf16 v[108:111], v[88:91], v[28:31], v[108:111]
    s_waitcnt lgkmcnt(6)
    v_mfma_f32_16x16x32_bf16 v[92:95], v[32:35], v[20:23], v[92:95]
    ds_read_b128 v[28:31], v4 offset:1024
    ds_read_b128 v[72:75], v6 offset:5120
    ds_read_b128 v[76:79], v6 offset:6144
    ds_read_b128 v[80:83], v6 offset:7168
    ds_read_b128 v[84:87], v6 offset:8192
    ds_read_b128 v[88:91], v6 offset:9216
    v_mfma_f32_16x16x32_bf16 v[96:99], v[36:39], v[20:23], v[96:99]
    v_mfma_f32_16x16x32_bf16 v[100:103], v[40:43], v[20:23], v[100:103]
    v_mfma_f32_16x16x32_bf16 v[104:107], v[44:47], v[20:23], v[104:107]
    v_mfma_f32_16x16x32_bf16 v[108:111], v[48:51], v[20:23], v[108:111]
    s_waitcnt lgkmcnt(6)
    s_barrier
    v_mfma_f32_16x16x32_bf16 v[92:95], v[52:55], v[24:27], v[92:95]
    ds_read_b128 v[20:23], v4 offset:18432
    ds_read_b128 v[32:35], v6 offset:18432
    ds_read_b128 v[36:39], v6 offset:19456
    ds_read_b128 v[40:43], v6 offset:20480
    ds_read_b128 v[44:47], v6 offset:21504
    ds_read_b128 v[48:51], v6 offset:22528
    v_mfma_f32_16x16x32_bf16 v[96:99], v[56:59], v[24:27], v[96:99]
    v_mfma_f32_16x16x32_bf16 v[100:103], v[60:63], v[24:27], v[100:103]
    v_mfma_f32_16x16x32_bf16 v[104:107], v[64:67], v[24:27], v[104:107]
    v_mfma_f32_16x16x32_bf16 v[108:111], v[68:71], v[24:27], v[108:111]
    s_waitcnt lgkmcnt(6)
    v_mfma_f32_16x16x32_bf16 v[92:95], v[72:75], v[28:31], v[92:95]
    ds_read_b128 v[24:27], v4 offset:19456
    ds_read_b128 v[52:55], v6 offset:23552
    ds_read_b128 v[56:59], v6 offset:24576
    ds_read_b128 v[60:63], v6 offset:25600
    ds_read_b128 v[64:67], v6 offset:26624
    ds_read_b128 v[68:71], v6 offset:27648
    v_mfma_f32_16x16x32_bf16 v[96:99], v[76:79], v[28:31], v[96:99]
    v_mfma_f32_16x16x32_bf16 v[100:103], v[80:83], v[28:31], v[100:103]
    v_mfma_f32_16x16x32_bf16 v[104:107], v[84:87], v[28:31], v[104:107]
    v_mfma_f32_16x16x32_bf16 v[108:111], v[88:91], v[28:31], v[108:111]
    s_waitcnt lgkmcnt(6)
    s_barrier
    v_mfma_f32_16x16x32_bf16 v[92:95], v[32:35], v[20:23], v[92:95]
    ds_read_b128 v[28:31], v4 offset:36864
    ds_read_b128 v[72:75], v6 offset:36864
    ds_read_b128 v[76:79], v6 offset:37888
    ds_read_b128 v[80:83], v6 offset:38912
    ds_read_b128 v[84:87], v6 offset:39936
    ds_read_b128 v[88:91], v6 offset:40960
    v_mfma_f32_16x16x32_bf16 v[96:99], v[36:39], v[20:23], v[96:99]
    v_mfma_f32_16x16x32_bf16 v[100:103], v[40:43], v[20:23], v[100:103]
    v_mfma_f32_16x16x32_bf16 v[104:107], v[44:47], v[20:23], v[104:107]
    v_mfma_f32_16x16x32_bf16 v[108:111], v[48:51], v[20:23], v[108:111]
    s_waitcnt lgkmcnt(6)
    v_mfma_f32_16x16x32_bf16 v[92:95], v[52:55], v[24:27], v[92:95]
    ds_read_b128 v[20:23], v4 offset:37888
    ds_read_b128 v[32:35], v6 offset:41984
    ds_read_b128 v[36:39], v6 offset:43008
    ds_read_b128 v[40:43], v6 offset:44032
    ds_read_b128 v[44:47], v6 offset:45056
    ds_read_b128 v[48:51], v6 offset:46080
    v_mfma_f32_16x16x32_bf16 v[96:99], v[56:59], v[24:27], v[96:99]
    v_mfma_f32_16x16x32_bf16 v[100:103], v[60:63], v[24:27], v[100:103]
    v_mfma_f32_16x16x32_bf16 v[104:107], v[64:67], v[24:27], v[104:107]
    v_mfma_f32_16x16x32_bf16 v[108:111], v[68:71], v[24:27], v[108:111]
    s_waitcnt lgkmcnt(6)
    s_barrier
    v_mfma_f32_16x16x32_bf16 v[92:95], v[72:75], v[28:31], v[92:95]
    ds_read_b128 v[24:27], v4 offset:55296
    ds_read_b128 v[52:55], v6 offset:55296
    ds_read_b128 v[56:59], v6 offset:56320
    ds_read_b128 v[60:63], v6 offset:57344
    ds_read_b128 v[64:67], v6 offset:58368
    ds_read_b128 v[68:71], v6 offset:59392
    v_mfma_f32_16x16x32_bf16 v[96:99], v[76:79], v[28:31], v[96:99]
    v_mfma_f32_16x16x32_bf16 v[100:103], v[80:83], v[28:31], v[100:103]
    v_mfma_f32_16x16x32_bf16 v[104:107], v[84:87], v[28:31], v[104:107]
    v_mfma_f32_16x16x32_bf16 v[108:111], v[88:91], v[28:31], v[108:111]
    s_waitcnt lgkmcnt(6)
    v_mfma_f32_16x16x32_bf16 v[92:95], v[32:35], v[20:23], v[92:95]
    ds_read_b128 v[28:31], v4 offset:56320
    ds_read_b128 v[72:75], v6 offset:60416
    ds_read_b128 v[76:79], v6 offset:61440
    ds_read_b128 v[80:83], v6 offset:62464
    ds_read_b128 v[84:87], v6 offset:63488
    ds_read_b128 v[88:91], v6 offset:64512
    v_mfma_f32_16x16x32_bf16 v[96:99], v[36:39], v[20:23], v[96:99]
    v_mfma_f32_16x16x32_bf16 v[100:103], v[40:43], v[20:23], v[100:103]
    v_mfma_f32_16x16x32_bf16 v[104:107], v[44:47], v[20:23], v[104:107]
    v_mfma_f32_16x16x32_bf16 v[108:111], v[48:51], v[20:23], v[108:111]
    s_waitcnt lgkmcnt(6)
    s_barrier
    v_mfma_f32_16x16x32_bf16 v[92:95], v[52:55], v[24:27], v[92:95]
    ds_read_b128 v[20:23], v5 offset:0
    ds_read_b128 v[32:35], v7 offset:0
    ds_read_b128 v[36:39], v7 offset:1024
    ds_read_b128 v[40:43], v7 offset:2048
    ds_read_b128 v[44:47], v7 offset:3072
    ds_read_b128 v[48:51], v7 offset:4096
    v_mfma_f32_16x16x32_bf16 v[96:99], v[56:59], v[24:27], v[96:99]
    v_mfma_f32_16x16x32_bf16 v[100:103], v[60:63], v[24:27], v[100:103]
    v_mfma_f32_16x16x32_bf16 v[104:107], v[64:67], v[24:27], v[104:107]
    v_mfma_f32_16x16x32_bf16 v[108:111], v[68:71], v[24:27], v[108:111]
    s_waitcnt lgkmcnt(6)
    v_mfma_f32_16x16x32_bf16 v[92:95], v[72:75], v[28:31], v[92:95]
    ds_read_b128 v[24:27], v5 offset:1024
    ds_read_b128 v[52:55], v7 offset:5120
    ds_read_b128 v[56:59], v7 offset:6144
    ds_read_b128 v[60:63], v7 offset:7168
    ds_read_b128 v[64:67], v7 offset:8192
    ds_read_b128 v[68:71], v7 offset:9216
    v_mfma_f32_16x16x32_bf16 v[96:99], v[76:79], v[28:31], v[96:99]
    v_mfma_f32_16x16x32_bf16 v[100:103], v[80:83], v[28:31], v[100:103]
    v_mfma_f32_16x16x32_bf16 v[104:107], v[84:87], v[28:31], v[104:107]
    v_mfma_f32_16x16x32_bf16 v[108:111], v[88:91], v[28:31], v[108:111]
    s_waitcnt lgkmcnt(6)
    s_barrier
    v_mfma_f32_16x16x32_bf16 v[92:95], v[32:35], v[20:23], v[92:95]
    ds_read_b128 v[28:31], v5 offset:18432
    ds_read_b128 v[72:75], v7 offset:18432
    ds_read_b128 v[76:79], v7 offset:19456
    ds_read_b128 v[80:83], v7 offset:20480
    ds_read_b128 v[84:87], v7 offset:21504
    ds_read_b128 v[88:91], v7 offset:22528
    v_mfma_f32_16x16x32_bf16 v[96:99], v[36:39], v[20:23], v[96:99]
    v_mfma_f32_16x16x32_bf16 v[100:103], v[40:43], v[20:23], v[100:103]
    v_mfma_f32_16x16x32_bf16 v[104:107], v[44:47], v[20:23], v[104:107]
    v_mfma_f32_16x16x32_bf16 v[108:111], v[48:51], v[20:23], v[108:111]
    s_waitcnt lgkmcnt(6)
    v_mfma_f32_16x16x32_bf16 v[92:95], v[52:55], v[24:27], v[92:95]
    ds_read_b128 v[20:23], v5 offset:19456
    ds_read_b128 v[32:35], v7 offset:23552
    ds_read_b128 v[36:39], v7 offset:24576
    ds_read_b128 v[40:43], v7 offset:25600
    ds_read_b128 v[44:47], v7 offset:26624
    ds_read_b128 v[48:51], v7 offset:27648
    v_mfma_f32_16x16x32_bf16 v[96:99], v[56:59], v[24:27], v[96:99]
    v_mfma_f32_16x16x32_bf16 v[100:103], v[60:63], v[24:27], v[100:103]
    v_mfma_f32_16x16x32_bf16 v[104:107], v[64:67], v[24:27], v[104:107]
    v_mfma_f32_16x16x32_bf16 v[108:111], v[68:71], v[24:27], v[108:111]
    s_waitcnt lgkmcnt(6)
    s_barrier
    v_mfma_f32_16x16x32_bf16 v[92:95], v[72:75], v[28:31], v[92:95]
    ds_read_b128 v[24:27], v5 offset:36864
    ds_read_b128 v[52:55], v7 offset:36864
    ds_read_b128 v[56:59], v7 offset:37888
    ds_read_b128 v[60:63], v7 offset:38912
    ds_read_b128 v[64:67], v7 offset:39936
    ds_read_b128 v[68:71], v7 offset:40960
    v_mfma_f32_16x16x32_bf16 v[96:99], v[76:79], v[28:31], v[96:99]
    v_mfma_f32_16x16x32_bf16 v[100:103], v[80:83], v[28:31], v[100:103]
    v_mfma_f32_16x16x32_bf16 v[104:107], v[84:87], v[28:31], v[104:107]
    v_mfma_f32_16x16x32_bf16 v[108:111], v[88:91], v[28:31], v[108:111]
    s_waitcnt lgkmcnt(6)
    v_mfma_f32_16x16x32_bf16 v[92:95], v[32:35], v[20:23], v[92:95]
    ds_read_b128 v[28:31], v5 offset:37888
    ds_read_b128 v[72:75], v7 offset:41984
    ds_read_b128 v[76:79], v7 offset:43008
    ds_read_b128 v[80:83], v7 offset:44032
    ds_read_b128 v[84:87], v7 offset:45056
    ds_read_b128 v[88:91], v7 offset:46080
    v_mfma_f32_16x16x32_bf16 v[96:99], v[36:39], v[20:23], v[96:99]
    v_mfma_f32_16x16x32_bf16 v[100:103], v[40:43], v[20:23], v[100:103]
    v_mfma_f32_16x16x32_bf16 v[104:107], v[44:47], v[20:23], v[104:107]
    v_mfma_f32_16x16x32_bf16 v[108:111], v[48:51], v[20:23], v[108:111]
    s_waitcnt lgkmcnt(6)
    s_barrier
    v_mfma_f32_16x16x32_bf16 v[92:95], v[52:55], v[24:27], v[92:95]
    ds_read_b128 v[20:23], v5 offset:55296
    ds_read_b128 v[32:35], v7 offset:55296
    ds_read_b128 v[36:39], v7 offset:56320
    ds_read_b128 v[40:43], v7 offset:57344
    ds_read_b128 v[44:47], v7 offset:58368
    ds_read_b128 v[48:51], v7 offset:59392
    v_mfma_f32_16x16x32_bf16 v[96:99], v[56:59], v[24:27], v[96:99]
    v_mfma_f32_16x16x32_bf16 v[100:103], v[60:63], v[24:27], v[100:103]
    v_mfma_f32_16x16x32_bf16 v[104:107], v[64:67], v[24:27], v[104:107]
    v_mfma_f32_16x16x32_bf16 v[108:111], v[68:71], v[24:27], v[108:111]
    s_waitcnt lgkmcnt(6)
    v_mfma_f32_16x16x32_bf16 v[92:95], v[72:75], v[28:31], v[92:95]
    ds_read_b128 v[24:27], v5 offset:56320
    ds_read_b128 v[52:55], v7 offset:60416
    ds_read_b128 v[56:59], v7 offset:61440
    ds_read_b128 v[60:63], v7 offset:62464
    ds_read_b128 v[64:67], v7 offset:63488
    ds_read_b128 v[68:71], v7 offset:64512
    v_mfma_f32_16x16x32_bf16 v[96:99], v[76:79], v[28:31], v[96:99]
    v_mfma_f32_16x16x32_bf16 v[100:103], v[80:83], v[28:31], v[100:103]
    v_mfma_f32_16x16x32_bf16 v[104:107], v[84:87], v[28:31], v[104:107]
    v_mfma_f32_16x16x32_bf16 v[108:111], v[88:91], v[28:31], v[108:111]
    s_waitcnt lgkmcnt(6)
    s_barrier
    v_mfma_f32_16x16x32_bf16 v[92:95], v[32:35], v[20:23], v[92:95]
    ds_read_b128 v[28:31], v4 offset:0
    ds_read_b128 v[72:75], v6 offset:0
    ds_read_b128 v[76:79], v6 offset:1024
    ds_read_b128 v[80:83], v6 offset:2048
    ds_read_b128 v[84:87], v6 offset:3072
    ds_read_b128 v[88:91], v6 offset:4096
    v_mfma_f32_16x16x32_bf16 v[96:99], v[36:39], v[20:23], v[96:99]
    v_mfma_f32_16x16x32_bf16 v[100:103], v[40:43], v[20:23], v[100:103]
    v_mfma_f32_16x16x32_bf16 v[104:107], v[44:47], v[20:23], v[104:107]
    v_mfma_f32_16x16x32_bf16 v[108:111], v[48:51], v[20:23], v[108:111]
    s_waitcnt lgkmcnt(6)
    v_mfma_f32_16x16x32_bf16 v[92:95], v[52:55], v[24:27], v[92:95]
    ds_read_b128 v[20:23], v4 offset:1024
    ds_read_b128 v[32:35], v6 offset:5120
    ds_read_b128 v[36:39], v6 offset:6144
    ds_read_b128 v[40:43], v6 offset:7168
    ds_read_b128 v[44:47], v6 offset:8192
    ds_read_b128 v[48:51], v6 offset:9216
    v_mfma_f32_16x16x32_bf16 v[96:99], v[56:59], v[24:27], v[96:99]
    v_mfma_f32_16x16x32_bf16 v[100:103], v[60:63], v[24:27], v[100:103]
    v_mfma_f32_16x16x32_bf16 v[104:107], v[64:67], v[24:27], v[104:107]
    v_mfma_f32_16x16x32_bf16 v[108:111], v[68:71], v[24:27], v[108:111]
    s_waitcnt lgkmcnt(6)
    s_barrier
    v_mfma_f32_16x16x32_bf16 v[92:95], v[72:75], v[28:31], v[92:95]
    ds_read_b128 v[24:27], v4 offset:18432
    ds_read_b128 v[52:55], v6 offset:18432
    ds_read_b128 v[56:59], v6 offset:19456
    ds_read_b128 v[60:63], v6 offset:20480
    ds_read_b128 v[64:67], v6 offset:21504
    ds_read_b128 v[68:71], v6 offset:22528
    v_mfma_f32_16x16x32_bf16 v[96:99], v[76:79], v[28:31], v[96:99]
    v_mfma_f32_16x16x32_bf16 v[100:103], v[80:83], v[28:31], v[100:103]
    v_mfma_f32_16x16x32_bf16 v[104:107], v[84:87], v[28:31], v[104:107]
    v_mfma_f32_16x16x32_bf16 v[108:111], v[88:91], v[28:31], v[108:111]
    s_waitcnt lgkmcnt(6)
    v_mfma_f32_16x16x32_bf16 v[92:95], v[32:35], v[20:23], v[92:95]
    ds_read_b128 v[28:31], v4 offset:19456
    ds_read_b128 v[72:75], v6 offset:23552
    ds_read_b128 v[76:79], v6 offset:24576
    ds_read_b128 v[80:83], v6 offset:25600
    ds_read_b128 v[84:87], v6 offset:26624
    ds_read_b128 v[88:91], v6 offset:27648
    v_mfma_f32_16x16x32_bf16 v[96:99], v[36:39], v[20:23], v[96:99]
    v_mfma_f32_16x16x32_bf16 v[100:103], v[40:43], v[20:23], v[100:103]
    v_mfma_f32_16x16x32_bf16 v[104:107], v[44:47], v[20:23], v[104:107]
    v_mfma_f32_16x16x32_bf16 v[108:111], v[48:51], v[20:23], v[108:111]
    s_waitcnt lgkmcnt(6)
    s_barrier
    v_mfma_f32_16x16x32_bf16 v[92:95], v[52:55], v[24:27], v[92:95]
    ds_read_b128 v[20:23], v4 offset:36864
    ds_read_b128 v[32:35], v6 offset:36864
    ds_read_b128 v[36:39], v6 offset:37888
    ds_read_b128 v[40:43], v6 offset:38912
    ds_read_b128 v[44:47], v6 offset:39936
    ds_read_b128 v[48:51], v6 offset:40960
    v_mfma_f32_16x16x32_bf16 v[96:99], v[56:59], v[24:27], v[96:99]
    v_mfma_f32_16x16x32_bf16 v[100:103], v[60:63], v[24:27], v[100:103]
    v_mfma_f32_16x16x32_bf16 v[104:107], v[64:67], v[24:27], v[104:107]
    v_mfma_f32_16x16x32_bf16 v[108:111], v[68:71], v[24:27], v[108:111]
    s_waitcnt lgkmcnt(6)
    v_mfma_f32_16x16x32_bf16 v[92:95], v[72:75], v[28:31], v[92:95]
    ds_read_b128 v[24:27], v4 offset:37888
    ds_read_b128 v[52:55], v6 offset:41984
    ds_read_b128 v[56:59], v6 offset:43008
    ds_read_b128 v[60:63], v6 offset:44032
    ds_read_b128 v[64:67], v6 offset:45056
    ds_read_b128 v[68:71], v6 offset:46080
    v_mfma_f32_16x16x32_bf16 v[96:99], v[76:79], v[28:31], v[96:99]
    v_mfma_f32_16x16x32_bf16 v[100:103], v[80:83], v[28:31], v[100:103]
    v_mfma_f32_16x16x32_bf16 v[104:107], v[84:87], v[28:31], v[104:107]
    v_mfma_f32_16x16x32_bf16 v[108:111], v[88:91], v[28:31], v[108:111]
    s_waitcnt lgkmcnt(6)
    s_barrier
    v_mfma_f32_16x16x32_bf16 v[92:95], v[32:35], v[20:23], v[92:95]
    ds_read_b128 v[28:31], v4 offset:55296
    ds_read_b128 v[72:75], v6 offset:55296
    ds_read_b128 v[76:79], v6 offset:56320
    ds_read_b128 v[80:83], v6 offset:57344
    ds_read_b128 v[84:87], v6 offset:58368
    ds_read_b128 v[88:91], v6 offset:59392
    v_mfma_f32_16x16x32_bf16 v[96:99], v[36:39], v[20:23], v[96:99]
    v_mfma_f32_16x16x32_bf16 v[100:103], v[40:43], v[20:23], v[100:103]
    v_mfma_f32_16x16x32_bf16 v[104:107], v[44:47], v[20:23], v[104:107]
    v_mfma_f32_16x16x32_bf16 v[108:111], v[48:51], v[20:23], v[108:111]
    s_waitcnt lgkmcnt(6)
    v_mfma_f32_16x16x32_bf16 v[92:95], v[52:55], v[24:27], v[92:95]
    ds_read_b128 v[20:23], v4 offset:56320
    ds_read_b128 v[32:35], v6 offset:60416
    ds_read_b128 v[36:39], v6 offset:61440
    ds_read_b128 v[40:43], v6 offset:62464
    ds_read_b128 v[44:47], v6 offset:63488
    ds_read_b128 v[48:51], v6 offset:64512
    v_mfma_f32_16x16x32_bf16 v[96:99], v[56:59], v[24:27], v[96:99]
    v_mfma_f32_16x16x32_bf16 v[100:103], v[60:63], v[24:27], v[100:103]
    v_mfma_f32_16x16x32_bf16 v[104:107], v[64:67], v[24:27], v[104:107]
    v_mfma_f32_16x16x32_bf16 v[108:111], v[68:71], v[24:27], v[108:111]
    s_waitcnt lgkmcnt(6)
    s_barrier
    v_mfma_f32_16x16x32_bf16 v[92:95], v[72:75], v[28:31], v[92:95]
    ds_read_b128 v[24:27], v5 offset:0
    ds_read_b128 v[52:55], v7 offset:0
    ds_read_b128 v[56:59], v7 offset:1024
    ds_read_b128 v[60:63], v7 offset:2048
    ds_read_b128 v[64:67], v7 offset:3072
    ds_read_b128 v[68:71], v7 offset:4096
    v_mfma_f32_16x16x32_bf16 v[96:99], v[76:79], v[28:31], v[96:99]
    v_mfma_f32_16x16x32_bf16 v[100:103], v[80:83], v[28:31], v[100:103]
    v_mfma_f32_16x16x32_bf16 v[104:107], v[84:87], v[28:31], v[104:107]
    v_mfma_f32_16x16x32_bf16 v[108:111], v[88:91], v[28:31], v[108:111]
    s_waitcnt lgkmcnt(6)
    v_mfma_f32_16x16x32_bf16 v[92:95], v[32:35], v[20:23], v[92:95]
    ds_read_b128 v[28:31], v5 offset:1024
    ds_read_b128 v[72:75], v7 offset:5120
    ds_read_b128 v[76:79], v7 offset:6144
    ds_read_b128 v[80:83], v7 offset:7168
    ds_read_b128 v[84:87], v7 offset:8192
    ds_read_b128 v[88:91], v7 offset:9216
    v_mfma_f32_16x16x32_bf16 v[96:99], v[36:39], v[20:23], v[96:99]
    v_mfma_f32_16x16x32_bf16 v[100:103], v[40:43], v[20:23], v[100:103]
    v_mfma_f32_16x16x32_bf16 v[104:107], v[44:47], v[20:23], v[104:107]
    v_mfma_f32_16x16x32_bf16 v[108:111], v[48:51], v[20:23], v[108:111]
    s_waitcnt lgkmcnt(6)
    s_barrier
    v_mfma_f32_16x16x32_bf16 v[92:95], v[52:55], v[24:27], v[92:95]
    ds_read_b128 v[20:23], v5 offset:18432
    ds_read_b128 v[32:35], v7 offset:18432
    ds_read_b128 v[36:39], v7 offset:19456
    ds_read_b128 v[40:43], v7 offset:20480
    ds_read_b128 v[44:47], v7 offset:21504
    ds_read_b128 v[48:51], v7 offset:22528
    v_mfma_f32_16x16x32_bf16 v[96:99], v[56:59], v[24:27], v[96:99]
    v_mfma_f32_16x16x32_bf16 v[100:103], v[60:63], v[24:27], v[100:103]
    v_mfma_f32_16x16x32_bf16 v[104:107], v[64:67], v[24:27], v[104:107]
    v_mfma_f32_16x16x32_bf16 v[108:111], v[68:71], v[24:27], v[108:111]
    s_waitcnt lgkmcnt(6)
    v_mfma_f32_16x16x32_bf16 v[92:95], v[72:75], v[28:31], v[92:95]
    ds_read_b128 v[24:27], v5 offset:19456
    ds_read_b128 v[52:55], v7 offset:23552
    ds_read_b128 v[56:59], v7 offset:24576
    ds_read_b128 v[60:63], v7 offset:25600
    ds_read_b128 v[64:67], v7 offset:26624
    ds_read_b128 v[68:71], v7 offset:27648
    v_mfma_f32_16x16x32_bf16 v[96:99], v[76:79], v[28:31], v[96:99]
    v_mfma_f32_16x16x32_bf16 v[100:103], v[80:83], v[28:31], v[100:103]
    v_mfma_f32_16x16x32_bf16 v[104:107], v[84:87], v[28:31], v[104:107]
    v_mfma_f32_16x16x32_bf16 v[108:111], v[88:91], v[28:31], v[108:111]
    s_waitcnt lgkmcnt(6)
    s_barrier
    v_mfma_f32_16x16x32_bf16 v[92:95], v[32:35], v[20:23], v[92:95]
    ds_read_b128 v[28:31], v5 offset:36864
    ds_read_b128 v[72:75], v7 offset:36864
    ds_read_b128 v[76:79], v7 offset:37888
    ds_read_b128 v[80:83], v7 offset:38912
    ds_read_b128 v[84:87], v7 offset:39936
    ds_read_b128 v[88:91], v7 offset:40960
    v_mfma_f32_16x16x32_bf16 v[96:99], v[36:39], v[20:23], v[96:99]
    v_mfma_f32_16x16x32_bf16 v[100:103], v[40:43], v[20:23], v[100:103]
    v_mfma_f32_16x16x32_bf16 v[104:107], v[44:47], v[20:23], v[104:107]
    v_mfma_f32_16x16x32_bf16 v[108:111], v[48:51], v[20:23], v[108:111]
    s_waitcnt lgkmcnt(6)
    v_mfma_f32_16x16x32_bf16 v[92:95], v[52:55], v[24:27], v[92:95]
    ds_read_b128 v[20:23], v5 offset:37888
    ds_read_b128 v[32:35], v7 offset:41984
    ds_read_b128 v[36:39], v7 offset:43008
    ds_read_b128 v[40:43], v7 offset:44032
    ds_read_b128 v[44:47], v7 offset:45056
    ds_read_b128 v[48:51], v7 offset:46080
    v_mfma_f32_16x16x32_bf16 v[96:99], v[56:59], v[24:27], v[96:99]
    v_mfma_f32_16x16x32_bf16 v[100:103], v[60:63], v[24:27], v[100:103]
    v_mfma_f32_16x16x32_bf16 v[104:107], v[64:67], v[24:27], v[104:107]
    v_mfma_f32_16x16x32_bf16 v[108:111], v[68:71], v[24:27], v[108:111]
    s_waitcnt lgkmcnt(6)
    s_barrier
    v_mfma_f32_16x16x32_bf16 v[92:95], v[72:75], v[28:31], v[92:95]
    ds_read_b128 v[24:27], v5 offset:55296
    ds_read_b128 v[52:55], v7 offset:55296
    ds_read_b128 v[56:59], v7 offset:56320
    ds_read_b128 v[60:63], v7 offset:57344
    ds_read_b128 v[64:67], v7 offset:58368
    ds_read_b128 v[68:71], v7 offset:59392
    v_mfma_f32_16x16x32_bf16 v[96:99], v[76:79], v[28:31], v[96:99]
    v_mfma_f32_16x16x32_bf16 v[100:103], v[80:83], v[28:31], v[100:103]
    v_mfma_f32_16x16x32_bf16 v[104:107], v[84:87], v[28:31], v[104:107]
    v_mfma_f32_16x16x32_bf16 v[108:111], v[88:91], v[28:31], v[108:111]
    s_waitcnt lgkmcnt(6)
    v_mfma_f32_16x16x32_bf16 v[92:95], v[32:35], v[20:23], v[92:95]
    ds_read_b128 v[28:31], v5 offset:56320
    ds_read_b128 v[72:75], v7 offset:60416
    ds_read_b128 v[76:79], v7 offset:61440
    ds_read_b128 v[80:83], v7 offset:62464
    ds_read_b128 v[84:87], v7 offset:63488
    ds_read_b128 v[88:91], v7 offset:64512
    v_mfma_f32_16x16x32_bf16 v[96:99], v[36:39], v[20:23], v[96:99]
    v_mfma_f32_16x16x32_bf16 v[100:103], v[40:43], v[20:23], v[100:103]
    v_mfma_f32_16x16x32_bf16 v[104:107], v[44:47], v[20:23], v[104:107]
    v_mfma_f32_16x16x32_bf16 v[108:111], v[48:51], v[20:23], v[108:111]
    s_waitcnt lgkmcnt(6)
    v_mfma_f32_16x16x32_bf16 v[92:95], v[52:55], v[24:27], v[92:95]
    v_mfma_f32_16x16x32_bf16 v[96:99], v[56:59], v[24:27], v[96:99]
    v_mfma_f32_16x16x32_bf16 v[100:103], v[60:63], v[24:27], v[100:103]
    v_mfma_f32_16x16x32_bf16 v[104:107], v[64:67], v[24:27], v[104:107]
    v_mfma_f32_16x16x32_bf16 v[108:111], v[68:71], v[24:27], v[108:111]
    s_waitcnt lgkmcnt(0)
    s_barrier
    v_mfma_f32_16x16x32_bf16 v[92:95], v[72:75], v[28:31], v[92:95]
    v_mfma_f32_16x16x32_bf16 v[96:99], v[76:79], v[28:31], v[96:99]
    v_mfma_f32_16x16x32_bf16 v[100:103], v[80:83], v[28:31], v[100:103]
    v_mfma_f32_16x16x32_bf16 v[104:107], v[84:87], v[28:31], v[104:107]
    v_mfma_f32_16x16x32_bf16 v[108:111], v[88:91], v[28:31], v[108:111]
    s_waitcnt vmcnt(0)
    s_nop 7
    v_lshlrev_b32 v20, 16, v10
    v_and_b32 v21, 0xffff0000, v10
    v_lshlrev_b32 v22, 16, v11
    v_and_b32 v23, 0xffff0000, v11
    v_pk_add_f32 v[20:21], v[20:21], v[92:93]
    v_pk_add_f32 v[22:23], v[22:23], v[94:95]
    v_cvt_pk_bf16_f32 v10, v20, v21
    v_cvt_pk_bf16_f32 v11, v22, v23

    v_lshlrev_b32 v24, 16, v12
    v_and_b32 v25, 0xffff0000, v12
    v_lshlrev_b32 v26, 16, v13
    v_and_b32 v27, 0xffff0000, v13
    v_pk_add_f32 v[24:25], v[24:25], v[96:97]
    v_pk_add_f32 v[26:27], v[26:27], v[98:99]
    v_cvt_pk_bf16_f32 v12, v24, v25
    v_cvt_pk_bf16_f32 v13, v26, v27

    v_lshlrev_b32 v20, 16, v14
    v_and_b32 v21, 0xffff0000, v14
    v_lshlrev_b32 v22, 16, v15
    v_and_b32 v23, 0xffff0000, v15
    v_pk_add_f32 v[20:21], v[20:21], v[100:101]
    v_pk_add_f32 v[22:23], v[22:23], v[102:103]
    v_cvt_pk_bf16_f32 v14, v20, v21
    v_cvt_pk_bf16_f32 v15, v22, v23

    v_lshlrev_b32 v24, 16, v16
    v_and_b32 v25, 0xffff0000, v16
    v_lshlrev_b32 v26, 16, v17
    v_and_b32 v27, 0xffff0000, v17
    v_pk_add_f32 v[24:25], v[24:25], v[104:105]
    v_pk_add_f32 v[26:27], v[26:27], v[106:107]
    v_cvt_pk_bf16_f32 v16, v24, v25
    v_cvt_pk_bf16_f32 v17, v26, v27

    v_lshlrev_b32 v20, 16, v18
    v_and_b32 v21, 0xffff0000, v18
    v_lshlrev_b32 v22, 16, v19
    v_and_b32 v23, 0xffff0000, v19
    v_pk_add_f32 v[20:21], v[20:21], v[108:109]
    v_pk_add_f32 v[22:23], v[22:23], v[110:111]
    v_cvt_pk_bf16_f32 v18, v20, v21
    v_cvt_pk_bf16_f32 v19, v22, v23

    s_nop 0
    v_permlane16_swap_b32 v10, v12
    v_permlane16_swap_b32 v11, v13
    v_permlane16_swap_b32 v14, v16
    v_permlane16_swap_b32 v15, v17
    s_cmp_eq_u32 s98, 0
    s_cbranch_scc1 L_ch_g4_frag
    buffer_store_dwordx4 v[10:13], v113, s[48:51], 0 offen offset:0
    buffer_store_dwordx4 v[14:17], v113, s[48:51], 0 offen offset:64
    buffer_store_dwordx2 v[18:19], v8, s[48:51], 0 offen offset:128
    s_endpgm
L_ch_g4_frag:
    buffer_store_dwordx4 v[10:13], v112, s[48:51], 0 offen offset:0 sc1
    buffer_store_dwordx4 v[14:17], v112, s[48:51], 0 offen offset:2048 sc1
    buffer_store_dwordx2 v[18:19], v3, s[48:51], s62 offen sc1
    v_mov_b32 v4, 0
    v_mov_b32 v5, 0
    s_mov_b32 s60, 0x3f803f80
    v_dot2_f32_bf16 v4, v10, s60, v4
    v_dot2_f32_bf16 v5, v10, v10, v5
    v_dot2_f32_bf16 v4, v11, s60, v4
    v_dot2_f32_bf16 v5, v11, v11, v5
    v_dot2_f32_bf16 v4, v12, s60, v4
    v_dot2_f32_bf16 v5, v12, v12, v5
    v_dot2_f32_bf16 v4, v13, s60, v4
    v_dot2_f32_bf16 v5, v13, v13, v5
    v_dot2_f32_bf16 v4, v14, s60, v4
    v_dot2_f32_bf16 v5, v14, v14, v5
    v_dot2_f32_bf16 v4, v15, s60, v4
    v_dot2_f32_bf16 v5, v15, v15, v5
    v_dot2_f32_bf16 v4, v16, s60, v4
    v_dot2_f32_bf16 v5, v16, v16, v5
    v_dot2_f32_bf16 v4, v17, s60, v4
    v_dot2_f32_bf16 v5, v17, v17, v5
    v_dot2_f32_bf16 v4, v18, s60, v4
    v_dot2_f32_bf16 v5, v18, v18, v5
    v_dot2_f32_bf16 v4, v19, s60, v4
    v_dot2_f32_bf16 v5, v19, v19, v5
    s_nop 2
    v_mov_b32 v6, v4
    v_mov_b32 v7, v5
    s_nop 1
    v_permlane16_swap_b32 v4, v6
    v_permlane16_swap_b32 v5, v7
    s_nop 1
    v_add_f32 v4, v4, v6
    v_add_f32 v5, v5, v7

    v_mov_b32 v6, v4
    v_mov_b32 v7, v5
    s_nop 1
    v_permlane32_swap_b32 v4, v6
    v_permlane32_swap_b32 v5, v7
    s_nop 1
    v_add_f32 v4, v4, v6
    v_add_f32 v5, v5, v7

    s_mov_b64 exec, 0xffff
    buffer_store_dwordx2 v[4:5], v9, s[56:59], s61 offen sc1
    s_mov_b64 exec, -1

    s_add_u32 s44, s34, 44564480
    s_addc_u32 s45, s35, 0
    s_mov_b32 s46, 46080
    s_mov_b32 s47, 0x00020000
    s_mul_i32 s12, s98, 12288
    s_lshl_b32 s8, s36, 8
    s_add_u32 s12, s12, s8
    s_add_u32 s12, s12, 8192
    s_lshl_b32 s13, s37, 4
    s_add_u32 s12, s12, s13
    s_lshl_b32 s13, s7, 2
    s_add_u32 s12, s12, s13
    v_mov_b32 v1, 1
    s_mov_b64 exec, 1
    s_waitcnt vmcnt(0)
    buffer_store_dword v1, off, s[44:47], s12 sc1
    s_mov_b64 exec, -1
    s_barrier

    s_mov_b32 s5, s36
    s_mov_b32 s6, s37
    s_lshr_b32 s8, s7, 1
    s_and_b32 s9, s7, 1
    v_and_b32 v3, 31, v2
    v_lshrrev_b32 v4, 5, v2

    s_add_u32 s52, s34, 33554432
    s_addc_u32 s53, s35, 0
    s_mov_b32 s54, 2686976
    s_mov_b32 s55, 0x00020000
    s_add_u32 s56, s34, 44040192
    s_addc_u32 s57, s35, 0
    s_mov_b32 s58, 131072
    s_mov_b32 s59, 0x00020000
    s_lshl_b32 s59, s98, 26
    s_add_u32 s56, s56, s59
    s_addc_u32 s57, s57, 0
    s_mov_b32 s59, 0x00020000
    s_mul_i32 s10, s6, 167936
    s_mul_i32 s11, s9, 2048
    s_add_u32 s10, s10, s11
    s_add_u32 s10, s10, 163840
    v_lshlrev_b32 v5, 4, v2
    s_lshl_b32 s13, s5, 7
    s_lshl_b32 s14, s8, 6
    s_add_u32 s12, s13, s14
    s_lshl_b32 s13, s12, 6
    v_lshl_add_u32 v6, v3, 3, s13
    v_lshl_add_u32 v6, v4, 11, v6

    buffer_load_dwordx4 v[144:147], v5, s[52:55], s10 offen offset:0
    buffer_load_dwordx4 v[148:151], v5, s[52:55], s10 offen offset:1024
    s_add_u32 s11, s11, 8192
    v_add_u32 v12, s11, v5
    s_lshl_b32 s14, s8, 12
    v_add_u32 v8, s14, v5

    v_add_u32 v13, 65536, v12
    v_add_u32 v9, 65536, v8
    s_add_u32 s48, s34, 73400320
    s_addc_u32 s49, s35, 0
    s_mov_b32 s50, 9437184
    s_mov_b32 s51, 0x00020000
    s_lshr_b32 s68, s12, 5
    s_mul_i32 s68, s68, 1536
    s_mul_i32 s10, s6, 6
    s_mul_i32 s11, s9, 3
    s_add_u32 s10, s10, s11
    s_mov_b32 s15, 0x3ea52b5c

    s_add_u32 s11, s10, 0
    s_mul_i32 s61, s11, 98304
    s_add_u32 s61, s61, s68
    s_cmp_lt_u32 s11, 32
    s_cselect_b32 s12, s15, 1.0
    s_cmp_lt_u32 s11, 64
    s_movk_i32 s88, 0x3f80
    s_cselect_b32 s88, 0x3f803f80, s88
    s_cselect_b32 s89, 0x3f80, 0

    s_add_u32 s11, s10, 1
    s_mul_i32 s62, s11, 98304
    s_add_u32 s62, s62, s68
    s_cmp_lt_u32 s11, 32
    s_cselect_b32 s13, s15, 1.0
    s_cmp_lt_u32 s11, 64
    s_movk_i32 s90, 0x3f80
    s_cselect_b32 s90, 0x3f803f80, s90
    s_cselect_b32 s91, 0x3f80, 0

    s_add_u32 s11, s10, 2
    s_mul_i32 s63, s11, 98304
    s_add_u32 s63, s63, s68
    s_cmp_lt_u32 s11, 32
    s_cselect_b32 s14, s15, 1.0
    s_cmp_lt_u32 s11, 64
    s_movk_i32 s92, 0x3f80
    s_cselect_b32 s92, 0x3f803f80, s92
    s_cselect_b32 s93, 0x3f80, 0

    s_mov_b32 s64, -1
    s_mov_b32 s65, 0
    s_mov_b32 s66, 0
    s_mov_b32 s67, -1
    v_lshlrev_b32 v26, 4, v3
    v_xor_b32 v27, 128, v26
    v_add_u32 v27, 1024, v27
    v_mov_b32 v21, s13
    v_mov_b32 v22, s14
    v_mov_b32 v23, v26
    v_add_u32 v24, 98304, v26
    v_mov_b32 v25, v27
    s_mov_b64 exec, s[66:67]
    v_mov_b32 v21, s12
    v_mov_b32 v22, s13
    v_xor_b32 v23, 64, v26
    v_add_u32 v23, 512, v23
    v_mov_b32 v24, v27
    v_mov_b32 v25, v23
    s_mov_b64 exec, -1

    s_barrier
    ds_read_b128 v[32:35], v8 offset:0
    ds_read_b128 v[36:39], v8 offset:2048
    ds_read_b128 v[56:59], v12 offset:0
    ds_read_b128 v[60:63], v12 offset:1024
    ds_read_b128 v[40:43], v8 offset:1024
    ds_read_b128 v[44:47], v8 offset:3072
    ds_read_b128 v[64:67], v12 offset:4096
    ds_read_b128 v[68:71], v12 offset:5120
    buffer_load_dwordx2 v[152:153], v6, s[56:59], 0 offen offset:0 sc1
    buffer_load_dwordx2 v[154:155], v6, s[56:59], 0 offen offset:512 sc1
    buffer_load_dwordx2 v[156:157], v6, s[56:59], 0 offen offset:1024 sc1
    buffer_load_dwordx2 v[158:159], v6, s[56:59], 0 offen offset:1536 sc1
    buffer_load_dwordx2 v[160:161], v6, s[56:59], 0 offen offset:256 sc1
    buffer_load_dwordx2 v[162:163], v6, s[56:59], 0 offen offset:768 sc1
    buffer_load_dwordx2 v[164:165], v6, s[56:59], 0 offen offset:1280 sc1
    buffer_load_dwordx2 v[166:167], v6, s[56:59], 0 offen offset:1792 sc1
    s_waitcnt lgkmcnt(4)
    s_barrier
    v_mfma_f32_32x32x16_bf16 v[80:95], v[56:59], v[32:35], 0
    ds_read_b128 v[48:51], v8 offset:16384
    ds_read_b128 v[52:55], v8 offset:18432
    ds_read_b128 v[72:75], v12 offset:16384
    ds_read_b128 v[76:79], v12 offset:17408
    v_mfma_f32_32x32x16_bf16 v[96:111], v[56:59], v[36:39], 0
    v_mfma_f32_32x32x16_bf16 v[112:127], v[60:63], v[32:35], 0
    v_mfma_f32_32x32x16_bf16 v[128:143], v[60:63], v[36:39], 0
    s_waitcnt lgkmcnt(4)
    v_mfma_f32_32x32x16_bf16 v[80:95], v[64:67], v[40:43], v[80:95]
    ds_read_b128 v[32:35], v8 offset:17408
    ds_read_b128 v[36:39], v8 offset:19456
    ds_read_b128 v[56:59], v12 offset:20480
    ds_read_b128 v[60:63], v12 offset:21504
    v_mfma_f32_32x32x16_bf16 v[96:111], v[64:67], v[44:47], v[96:111]
    v_mfma_f32_32x32x16_bf16 v[112:127], v[68:71], v[40:43], v[112:127]
    v_mfma_f32_32x32x16_bf16 v[128:143], v[68:71], v[44:47], v[128:143]
    s_waitcnt lgkmcnt(4)
    s_barrier
    v_mfma_f32_32x32x16_bf16 v[80:95], v[72:75], v[48:51], v[80:95]
    ds_read_b128 v[40:43], v8 offset:32768
    ds_read_b128 v[44:47], v8 offset:34816
    ds_read_b128 v[64:67], v12 offset:32768
    ds_read_b128 v[68:71], v12 offset:33792
    v_mfma_f32_32x32x16_bf16 v[96:111], v[72:75], v[52:55], v[96:111]
    v_mfma_f32_32x32x16_bf16 v[112:127], v[76:79], v[48:51], v[112:127]
    v_mfma_f32_32x32x16_bf16 v[128:143], v[76:79], v[52:55], v[128:143]
    s_waitcnt lgkmcnt(4)
    v_mfma_f32_32x32x16_bf16 v[80:95], v[56:59], v[32:35], v[80:95]
    ds_read_b128 v[48:51], v8 offset:33792
    ds_read_b128 v[52:55], v8 offset:35840
    ds_read_b128 v[72:75], v12 offset:36864
    ds_read_b128 v[76:79], v12 offset:37888
    v_mfma_f32_32x32x16_bf16 v[96:111], v[56:59], v[36:39], v[96:111]
    v_mfma_f32_32x32x16_bf16 v[112:127], v[60:63], v[32:35], v[112:127]
    v_mfma_f32_32x32x16_bf16 v[128:143], v[60:63], v[36:39], v[128:143]
    s_waitcnt lgkmcnt(4)
    s_barrier
    v_mfma_f32_32x32x16_bf16 v[80:95], v[64:67], v[40:43], v[80:95]
    ds_read_b128 v[32:35], v8 offset:49152
    ds_read_b128 v[36:39], v8 offset:51200
    ds_read_b128 v[56:59], v12 offset:49152
    ds_read_b128 v[60:63], v12 offset:50176
    v_mfma_f32_32x32x16_bf16 v[96:111], v[64:67], v[44:47], v[96:111]
    v_mfma_f32_32x32x16_bf16 v[112:127], v[68:71], v[40:43], v[112:127]
    v_mfma_f32_32x32x16_bf16 v[128:143], v[68:71], v[44:47], v[128:143]
    s_waitcnt lgkmcnt(4)
    v_mfma_f32_32x32x16_bf16 v[80:95], v[72:75], v[48:51], v[80:95]
    ds_read_b128 v[40:43], v8 offset:50176
    ds_read_b128 v[44:47], v8 offset:52224
    ds_read_b128 v[64:67], v12 offset:53248
    ds_read_b128 v[68:71], v12 offset:54272
    v_mfma_f32_32x32x16_bf16 v[96:111], v[72:75], v[52:55], v[96:111]
    v_mfma_f32_32x32x16_bf16 v[112:127], v[76:79], v[48:51], v[112:127]
    v_mfma_f32_32x32x16_bf16 v[128:143], v[76:79], v[52:55], v[128:143]
    s_waitcnt lgkmcnt(4)
    s_barrier
    v_mfma_f32_32x32x16_bf16 v[80:95], v[56:59], v[32:35], v[80:95]
    ds_read_b128 v[48:51], v9 offset:0
    ds_read_b128 v[52:55], v9 offset:2048
    ds_read_b128 v[72:75], v13 offset:0
    ds_read_b128 v[76:79], v13 offset:1024
    v_mfma_f32_32x32x16_bf16 v[96:111], v[56:59], v[36:39], v[96:111]
    v_mfma_f32_32x32x16_bf16 v[112:127], v[60:63], v[32:35], v[112:127]
    v_mfma_f32_32x32x16_bf16 v[128:143], v[60:63], v[36:39], v[128:143]
    s_waitcnt lgkmcnt(4)
    v_mfma_f32_32x32x16_bf16 v[80:95], v[64:67], v[40:43], v[80:95]
    ds_read_b128 v[32:35], v9 offset:1024
    ds_read_b128 v[36:39], v9 offset:3072
    ds_read_b128 v[56:59], v13 offset:4096
    ds_read_b128 v[60:63], v13 offset:5120
    v_mfma_f32_32x32x16_bf16 v[96:111], v[64:67], v[44:47], v[96:111]
    v_mfma_f32_32x32x16_bf16 v[112:127], v[68:71], v[40:43], v[112:127]
    v_mfma_f32_32x32x16_bf16 v[128:143], v[68:71], v[44:47], v[128:143]
    s_waitcnt lgkmcnt(4)
    s_barrier
    v_mfma_f32_32x32x16_bf16 v[80:95], v[72:75], v[48:51], v[80:95]
    ds_read_b128 v[40:43], v9 offset:16384
    ds_read_b128 v[44:47], v9 offset:18432
    ds_read_b128 v[64:67], v13 offset:16384
    ds_read_b128 v[68:71], v13 offset:17408
    v_mfma_f32_32x32x16_bf16 v[96:111], v[72:75], v[52:55], v[96:111]
    v_mfma_f32_32x32x16_bf16 v[112:127], v[76:79], v[48:51], v[112:127]
    v_mfma_f32_32x32x16_bf16 v[128:143], v[76:79], v[52:55], v[128:143]
    s_waitcnt lgkmcnt(4)
    v_mfma_f32_32x32x16_bf16 v[80:95], v[56:59], v[32:35], v[80:95]
    ds_read_b128 v[48:51], v9 offset:17408
    ds_read_b128 v[52:55], v9 offset:19456
    ds_read_b128 v[72:75], v13 offset:20480
    ds_read_b128 v[76:79], v13 offset:21504
    v_mfma_f32_32x32x16_bf16 v[96:111], v[56:59], v[36:39], v[96:111]
    v_mfma_f32_32x32x16_bf16 v[112:127], v[60:63], v[32:35], v[112:127]
    v_mfma_f32_32x32x16_bf16 v[128:143], v[60:63], v[36:39], v[128:143]
    s_waitcnt lgkmcnt(4)
    s_barrier
    v_mfma_f32_32x32x16_bf16 v[80:95], v[64:67], v[40:43], v[80:95]
    ds_read_b128 v[32:35], v9 offset:32768
    ds_read_b128 v[36:39], v9 offset:34816
    ds_read_b128 v[56:59], v13 offset:32768
    ds_read_b128 v[60:63], v13 offset:33792
    v_mfma_f32_32x32x16_bf16 v[96:111], v[64:67], v[44:47], v[96:111]
    v_mfma_f32_32x32x16_bf16 v[112:127], v[68:71], v[40:43], v[112:127]
    v_mfma_f32_32x32x16_bf16 v[128:143], v[68:71], v[44:47], v[128:143]
    s_waitcnt lgkmcnt(4)
    v_mfma_f32_32x32x16_bf16 v[80:95], v[72:75], v[48:51], v[80:95]
    ds_read_b128 v[40:43], v9 offset:33792
    ds_read_b128 v[44:47], v9 offset:35840
    ds_read_b128 v[64:67], v13 offset:36864
    ds_read_b128 v[68:71], v13 offset:37888
    v_mfma_f32_32x32x16_bf16 v[96:111], v[72:75], v[52:55], v[96:111]
    v_mfma_f32_32x32x16_bf16 v[112:127], v[76:79], v[48:51], v[112:127]
    v_mfma_f32_32x32x16_bf16 v[128:143], v[76:79], v[52:55], v[128:143]
    s_waitcnt lgkmcnt(4)
    s_barrier
    v_mfma_f32_32x32x16_bf16 v[80:95], v[56:59], v[32:35], v[80:95]
    ds_read_b128 v[48:51], v9 offset:49152
    ds_read_b128 v[52:55], v9 offset:51200
    ds_read_b128 v[72:75], v13 offset:49152
    ds_read_b128 v[76:79], v13 offset:50176
    v_mfma_f32_32x32x16_bf16 v[96:111], v[56:59], v[36:39], v[96:111]
    v_mfma_f32_32x32x16_bf16 v[112:127], v[60:63], v[32:35], v[112:127]
    v_mfma_f32_32x32x16_bf16 v[128:143], v[60:63], v[36:39], v[128:143]
    s_waitcnt lgkmcnt(4)
    v_mfma_f32_32x32x16_bf16 v[80:95], v[64:67], v[40:43], v[80:95]
    ds_read_b128 v[32:35], v9 offset:50176
    ds_read_b128 v[36:39], v9 offset:52224
    ds_read_b128 v[56:59], v13 offset:53248
    ds_read_b128 v[60:63], v13 offset:54272
    v_mfma_f32_32x32x16_bf16 v[96:111], v[64:67], v[44:47], v[96:111]
    v_mfma_f32_32x32x16_bf16 v[112:127], v[68:71], v[40:43], v[112:127]
    v_mfma_f32_32x32x16_bf16 v[128:143], v[68:71], v[44:47], v[128:143]
    s_waitcnt lgkmcnt(4)
    s_barrier
    v_mfma_f32_32x32x16_bf16 v[80:95], v[72:75], v[48:51], v[80:95]
    ds_read_b128 v[40:43], v8 offset:0
    ds_read_b128 v[44:47], v8 offset:2048
    ds_read_b128 v[64:67], v12 offset:0
    ds_read_b128 v[68:71], v12 offset:1024
    v_mfma_f32_32x32x16_bf16 v[96:111], v[72:75], v[52:55], v[96:111]
    v_mfma_f32_32x32x16_bf16 v[112:127], v[76:79], v[48:51], v[112:127]
    v_mfma_f32_32x32x16_bf16 v[128:143], v[76:79], v[52:55], v[128:143]
    s_waitcnt lgkmcnt(4)
    v_mfma_f32_32x32x16_bf16 v[80:95], v[56:59], v[32:35], v[80:95]
    ds_read_b128 v[48:51], v8 offset:1024
    ds_read_b128 v[52:55], v8 offset:3072
    ds_read_b128 v[72:75], v12 offset:4096
    ds_read_b128 v[76:79], v12 offset:5120
    v_mfma_f32_32x32x16_bf16 v[96:111], v[56:59], v[36:39], v[96:111]
    v_mfma_f32_32x32x16_bf16 v[112:127], v[60:63], v[32:35], v[112:127]
    v_mfma_f32_32x32x16_bf16 v[128:143], v[60:63], v[36:39], v[128:143]
    s_waitcnt lgkmcnt(4)
    s_barrier
    v_mfma_f32_32x32x16_bf16 v[80:95], v[64:67], v[40:43], v[80:95]
    ds_read_b128 v[32:35], v8 offset:16384
    ds_read_b128 v[36:39], v8 offset:18432
    ds_read_b128 v[56:59], v12 offset:16384
    ds_read_b128 v[60:63], v12 offset:17408
    v_mfma_f32_32x32x16_bf16 v[96:111], v[64:67], v[44:47], v[96:111]
    v_mfma_f32_32x32x16_bf16 v[112:127], v[68:71], v[40:43], v[112:127]
    v_mfma_f32_32x32x16_bf16 v[128:143], v[68:71], v[44:47], v[128:143]
    s_waitcnt lgkmcnt(4)
    v_mfma_f32_32x32x16_bf16 v[80:95], v[72:75], v[48:51], v[80:95]
    ds_read_b128 v[40:43], v8 offset:17408
    ds_read_b128 v[44:47], v8 offset:19456
    ds_read_b128 v[64:67], v12 offset:20480
    ds_read_b128 v[68:71], v12 offset:21504
    v_mfma_f32_32x32x16_bf16 v[96:111], v[72:75], v[52:55], v[96:111]
    v_mfma_f32_32x32x16_bf16 v[112:127], v[76:79], v[48:51], v[112:127]
    v_mfma_f32_32x32x16_bf16 v[128:143], v[76:79], v[52:55], v[128:143]
    s_waitcnt lgkmcnt(4)
    s_barrier
    v_mfma_f32_32x32x16_bf16 v[80:95], v[56:59], v[32:35], v[80:95]
    ds_read_b128 v[48:51], v8 offset:32768
    ds_read_b128 v[52:55], v8 offset:34816
    ds_read_b128 v[72:75], v12 offset:32768
    ds_read_b128 v[76:79], v12 offset:33792
    v_mfma_f32_32x32x16_bf16 v[96:111], v[56:59], v[36:39], v[96:111]
    v_mfma_f32_32x32x16_bf16 v[112:127], v[60:63], v[32:35], v[112:127]
    v_mfma_f32_32x32x16_bf16 v[128:143], v[60:63], v[36:39], v[128:143]
    s_waitcnt lgkmcnt(4)
    v_mfma_f32_32x32x16_bf16 v[80:95], v[64:67], v[40:43], v[80:95]
    ds_read_b128 v[32:35], v8 offset:33792
    ds_read_b128 v[36:39], v8 offset:35840
    ds_read_b128 v[56:59], v12 offset:36864
    ds_read_b128 v[60:63], v12 offset:37888
    v_mfma_f32_32x32x16_bf16 v[96:111], v[64:67], v[44:47], v[96:111]
    v_mfma_f32_32x32x16_bf16 v[112:127], v[68:71], v[40:43], v[112:127]
    v_mfma_f32_32x32x16_bf16 v[128:143], v[68:71], v[44:47], v[128:143]
    s_waitcnt lgkmcnt(4)
    s_barrier
    v_mfma_f32_32x32x16_bf16 v[80:95], v[72:75], v[48:51], v[80:95]
    ds_read_b128 v[40:43], v8 offset:49152
    ds_read_b128 v[44:47], v8 offset:51200
    ds_read_b128 v[64:67], v12 offset:49152
    ds_read_b128 v[68:71], v12 offset:50176
    v_mfma_f32_32x32x16_bf16 v[96:111], v[72:75], v[52:55], v[96:111]
    v_mfma_f32_32x32x16_bf16 v[112:127], v[76:79], v[48:51], v[112:127]
    v_mfma_f32_32x32x16_bf16 v[128:143], v[76:79], v[52:55], v[128:143]
    s_waitcnt vmcnt(0)
    s_mov_b32 s10, 0x3acccccd
    v_pk_add_f32 v[152:153], v[152:153], v[154:155]
    v_pk_add_f32 v[156:157], v[156:157], v[158:159]
    v_pk_add_f32 v[152:153], v[152:153], v[156:157]

    v_mov_b32 v20, v152
    s_nop 1
    v_permlane32_swap_b32 v152, v20
    s_nop 1
    v_add_f32 v152, v152, v20
    v_mov_b32 v20, v153
    s_nop 1
    v_permlane32_swap_b32 v153, v20
    s_nop 1
    v_add_f32 v153, v153, v20
    v_mul_f32 v152, s10, v152
    v_mul_f32 v153, s10, v153
    v_fma_f32 v153, -v152, v152, v153
    v_max_f32 v153, 0, v153
    v_add_f32 v153, 0x3727c5ac, v153
    v_rsq_f32 v18, v153
    v_xor_b32 v152, 0x80000000, v152
    v_and_b32 v154, 0xffff0000, v152
    v_sub_f32 v152, v152, v154
    v_lshrrev_b32 v169, 16, v154
    v_cvt_pk_bf16_f32 v155, 0, v152
    v_or_b32 v168, v169, v155
    v_mov_b32 v171, v169
    v_mov_b32 v170, v168

    v_pk_add_f32 v[160:161], v[160:161], v[162:163]
    v_pk_add_f32 v[164:165], v[164:165], v[166:167]
    v_pk_add_f32 v[160:161], v[160:161], v[164:165]

    v_mov_b32 v20, v160
    s_nop 1
    v_permlane32_swap_b32 v160, v20
    s_nop 1
    v_add_f32 v160, v160, v20
    v_mov_b32 v20, v161
    s_nop 1
    v_permlane32_swap_b32 v161, v20
    s_nop 1
    v_add_f32 v161, v161, v20
    v_mul_f32 v160, s10, v160
    v_mul_f32 v161, s10, v161
    v_fma_f32 v161, -v160, v160, v161
    v_max_f32 v161, 0, v161
    v_add_f32 v161, 0x3727c5ac, v161
    v_rsq_f32 v19, v161
    v_xor_b32 v160, 0x80000000, v160
    v_and_b32 v162, 0xffff0000, v160
    v_sub_f32 v160, v160, v162
    v_lshrrev_b32 v173, 16, v162
    v_cvt_pk_bf16_f32 v163, 0, v160
    v_or_b32 v172, v173, v163
    v_mov_b32 v175, v173
    v_mov_b32 v174, v172

    s_nop 1
    v_mfma_f32_32x32x16_bf16 v[80:95], v[144:147], v[168:171], v[80:95]
    v_mfma_f32_32x32x16_bf16 v[96:111], v[144:147], v[172:175], v[96:111]
    v_mfma_f32_32x32x16_bf16 v[112:127], v[148:151], v[168:171], v[112:127]
    v_mfma_f32_32x32x16_bf16 v[128:143], v[148:151], v[172:175], v[128:143]
    s_waitcnt lgkmcnt(4)
    v_mfma_f32_32x32x16_bf16 v[80:95], v[56:59], v[32:35], v[80:95]
    ds_read_b128 v[48:51], v8 offset:50176
    ds_read_b128 v[52:55], v8 offset:52224
    ds_read_b128 v[72:75], v12 offset:53248
    ds_read_b128 v[76:79], v12 offset:54272
    v_mfma_f32_32x32x16_bf16 v[96:111], v[56:59], v[36:39], v[96:111]
    v_mfma_f32_32x32x16_bf16 v[112:127], v[60:63], v[32:35], v[112:127]
    v_mfma_f32_32x32x16_bf16 v[128:143], v[60:63], v[36:39], v[128:143]
    s_waitcnt lgkmcnt(4)
    s_barrier
    v_mfma_f32_32x32x16_bf16 v[80:95], v[64:67], v[40:43], v[80:95]
    ds_read_b128 v[32:35], v9 offset:0
    ds_read_b128 v[36:39], v9 offset:2048
    ds_read_b128 v[56:59], v13 offset:0
    ds_read_b128 v[60:63], v13 offset:1024
    v_mfma_f32_32x32x16_bf16 v[96:111], v[64:67], v[44:47], v[96:111]
    v_mfma_f32_32x32x16_bf16 v[112:127], v[68:71], v[40:43], v[112:127]
    v_mfma_f32_32x32x16_bf16 v[128:143], v[68:71], v[44:47], v[128:143]
    s_waitcnt lgkmcnt(4)
    v_mfma_f32_32x32x16_bf16 v[80:95], v[72:75], v[48:51], v[80:95]
    ds_read_b128 v[40:43], v9 offset:1024
    ds_read_b128 v[44:47], v9 offset:3072
    ds_read_b128 v[64:67], v13 offset:4096
    ds_read_b128 v[68:71], v13 offset:5120
    v_mfma_f32_32x32x16_bf16 v[96:111], v[72:75], v[52:55], v[96:111]
    v_mfma_f32_32x32x16_bf16 v[112:127], v[76:79], v[48:51], v[112:127]
    v_mfma_f32_32x32x16_bf16 v[128:143], v[76:79], v[52:55], v[128:143]
    s_waitcnt lgkmcnt(4)
    s_barrier
    v_mfma_f32_32x32x16_bf16 v[80:95], v[56:59], v[32:35], v[80:95]
    ds_read_b128 v[48:51], v9 offset:16384
    ds_read_b128 v[52:55], v9 offset:18432
    ds_read_b128 v[72:75], v13 offset:16384
    ds_read_b128 v[76:79], v13 offset:17408
    v_mfma_f32_32x32x16_bf16 v[96:111], v[56:59], v[36:39], v[96:111]
    v_mfma_f32_32x32x16_bf16 v[112:127], v[60:63], v[32:35], v[112:127]
    v_mfma_f32_32x32x16_bf16 v[128:143], v[60:63], v[36:39], v[128:143]
    s_waitcnt lgkmcnt(4)
    v_mfma_f32_32x32x16_bf16 v[80:95], v[64:67], v[40:43], v[80:95]
    ds_read_b128 v[32:35], v9 offset:17408
    ds_read_b128 v[36:39], v9 offset:19456
    ds_read_b128 v[56:59], v13 offset:20480
    ds_read_b128 v[60:63], v13 offset:21504
    v_mfma_f32_32x32x16_bf16 v[96:111], v[64:67], v[44:47], v[96:111]
    v_mfma_f32_32x32x16_bf16 v[112:127], v[68:71], v[40:43], v[112:127]
    v_mfma_f32_32x32x16_bf16 v[128:143], v[68:71], v[44:47], v[128:143]
    s_waitcnt lgkmcnt(4)
    s_barrier
    v_mfma_f32_32x32x16_bf16 v[80:95], v[72:75], v[48:51], v[80:95]
    ds_read_b128 v[40:43], v9 offset:32768
    ds_read_b128 v[44:47], v9 offset:34816
    ds_read_b128 v[64:67], v13 offset:32768
    ds_read_b128 v[68:71], v13 offset:33792
    v_mfma_f32_32x32x16_bf16 v[96:111], v[72:75], v[52:55], v[96:111]
    v_mfma_f32_32x32x16_bf16 v[112:127], v[76:79], v[48:51], v[112:127]
    v_mfma_f32_32x32x16_bf16 v[128:143], v[76:79], v[52:55], v[128:143]
    s_waitcnt lgkmcnt(4)
    v_mfma_f32_32x32x16_bf16 v[80:95], v[56:59], v[32:35], v[80:95]
    ds_read_b128 v[48:51], v9 offset:33792
    ds_read_b128 v[52:55], v9 offset:35840
    ds_read_b128 v[72:75], v13 offset:36864
    ds_read_b128 v[76:79], v13 offset:37888
    v_mfma_f32_32x32x16_bf16 v[96:111], v[56:59], v[36:39], v[96:111]
    v_mfma_f32_32x32x16_bf16 v[112:127], v[60:63], v[32:35], v[112:127]
    v_mfma_f32_32x32x16_bf16 v[128:143], v[60:63], v[36:39], v[128:143]
    s_waitcnt lgkmcnt(4)
    s_barrier
    v_mfma_f32_32x32x16_bf16 v[80:95], v[64:67], v[40:43], v[80:95]
    ds_read_b128 v[32:35], v9 offset:49152
    ds_read_b128 v[36:39], v9 offset:51200
    ds_read_b128 v[56:59], v13 offset:49152
    ds_read_b128 v[60:63], v13 offset:50176
    v_mfma_f32_32x32x16_bf16 v[96:111], v[64:67], v[44:47], v[96:111]
    v_mfma_f32_32x32x16_bf16 v[112:127], v[68:71], v[40:43], v[112:127]
    v_mfma_f32_32x32x16_bf16 v[128:143], v[68:71], v[44:47], v[128:143]
    s_waitcnt lgkmcnt(4)
    v_mfma_f32_32x32x16_bf16 v[80:95], v[72:75], v[48:51], v[80:95]
    ds_read_b128 v[40:43], v9 offset:50176
    ds_read_b128 v[44:47], v9 offset:52224
    ds_read_b128 v[64:67], v13 offset:53248
    ds_read_b128 v[68:71], v13 offset:54272
    v_mfma_f32_32x32x16_bf16 v[96:111], v[72:75], v[52:55], v[96:111]
    v_mfma_f32_32x32x16_bf16 v[112:127], v[76:79], v[48:51], v[112:127]
    v_mfma_f32_32x32x16_bf16 v[128:143], v[76:79], v[52:55], v[128:143]
    s_waitcnt lgkmcnt(4)
    s_barrier
    v_mfma_f32_32x32x16_bf16 v[80:95], v[56:59], v[32:35], v[80:95]
    ds_read_b128 v[48:51], v8 offset:0
    ds_read_b128 v[52:55], v8 offset:2048
    ds_read_b128 v[72:75], v12 offset:0
    ds_read_b128 v[76:79], v12 offset:1024
    v_mfma_f32_32x32x16_bf16 v[96:111], v[56:59], v[36:39], v[96:111]
    v_mfma_f32_32x32x16_bf16 v[112:127], v[60:63], v[32:35], v[112:127]
    v_mfma_f32_32x32x16_bf16 v[128:143], v[60:63], v[36:39], v[128:143]
    s_waitcnt lgkmcnt(4)
    v_mfma_f32_32x32x16_bf16 v[80:95], v[64:67], v[40:43], v[80:95]
    ds_read_b128 v[32:35], v8 offset:1024
    ds_read_b128 v[36:39], v8 offset:3072
    ds_read_b128 v[56:59], v12 offset:4096
    ds_read_b128 v[60:63], v12 offset:5120
    v_mfma_f32_32x32x16_bf16 v[96:111], v[64:67], v[44:47], v[96:111]
    v_mfma_f32_32x32x16_bf16 v[112:127], v[68:71], v[40:43], v[112:127]
    v_mfma_f32_32x32x16_bf16 v[128:143], v[68:71], v[44:47], v[128:143]
    s_waitcnt lgkmcnt(4)
    s_barrier
    v_mfma_f32_32x32x16_bf16 v[80:95], v[72:75], v[48:51], v[80:95]
    ds_read_b128 v[40:43], v8 offset:16384
    ds_read_b128 v[44:47], v8 offset:18432
    ds_read_b128 v[64:67], v12 offset:16384
    ds_read_b128 v[68:71], v12 offset:17408
    v_mfma_f32_32x32x16_bf16 v[96:111], v[72:75], v[52:55], v[96:111]
    v_mfma_f32_32x32x16_bf16 v[112:127], v[76:79], v[48:51], v[112:127]
    v_mfma_f32_32x32x16_bf16 v[128:143], v[76:79], v[52:55], v[128:143]
    s_waitcnt lgkmcnt(4)
    v_mfma_f32_32x32x16_bf16 v[80:95], v[56:59], v[32:35], v[80:95]
    ds_read_b128 v[48:51], v8 offset:17408
    ds_read_b128 v[52:55], v8 offset:19456
    ds_read_b128 v[72:75], v12 offset:20480
    ds_read_b128 v[76:79], v12 offset:21504
    v_mfma_f32_32x32x16_bf16 v[96:111], v[56:59], v[36:39], v[96:111]
    v_mfma_f32_32x32x16_bf16 v[112:127], v[60:63], v[32:35], v[112:127]
    v_mfma_f32_32x32x16_bf16 v[128:143], v[60:63], v[36:39], v[128:143]
    s_waitcnt lgkmcnt(4)
    s_barrier
    v_mfma_f32_32x32x16_bf16 v[80:95], v[64:67], v[40:43], v[80:95]
    ds_read_b128 v[32:35], v8 offset:32768
    ds_read_b128 v[36:39], v8 offset:34816
    ds_read_b128 v[56:59], v12 offset:32768
    ds_read_b128 v[60:63], v12 offset:33792
    v_mfma_f32_32x32x16_bf16 v[96:111], v[64:67], v[44:47], v[96:111]
    v_mfma_f32_32x32x16_bf16 v[112:127], v[68:71], v[40:43], v[112:127]
    v_mfma_f32_32x32x16_bf16 v[128:143], v[68:71], v[44:47], v[128:143]
    s_waitcnt lgkmcnt(4)
    v_mfma_f32_32x32x16_bf16 v[80:95], v[72:75], v[48:51], v[80:95]
    ds_read_b128 v[40:43], v8 offset:33792
    ds_read_b128 v[44:47], v8 offset:35840
    ds_read_b128 v[64:67], v12 offset:36864
    ds_read_b128 v[68:71], v12 offset:37888
    v_mfma_f32_32x32x16_bf16 v[96:111], v[72:75], v[52:55], v[96:111]
    v_mfma_f32_32x32x16_bf16 v[112:127], v[76:79], v[48:51], v[112:127]
    v_mfma_f32_32x32x16_bf16 v[128:143], v[76:79], v[52:55], v[128:143]
    s_waitcnt lgkmcnt(4)
    s_barrier
    v_mfma_f32_32x32x16_bf16 v[80:95], v[56:59], v[32:35], v[80:95]
    ds_read_b128 v[48:51], v8 offset:49152
    ds_read_b128 v[52:55], v8 offset:51200
    ds_read_b128 v[72:75], v12 offset:49152
    ds_read_b128 v[76:79], v12 offset:50176
    v_mfma_f32_32x32x16_bf16 v[96:111], v[56:59], v[36:39], v[96:111]
    v_mfma_f32_32x32x16_bf16 v[112:127], v[60:63], v[32:35], v[112:127]
    v_mfma_f32_32x32x16_bf16 v[128:143], v[60:63], v[36:39], v[128:143]
    s_waitcnt lgkmcnt(4)
    v_mfma_f32_32x32x16_bf16 v[80:95], v[64:67], v[40:43], v[80:95]
    ds_read_b128 v[32:35], v8 offset:50176
    ds_read_b128 v[36:39], v8 offset:52224
    ds_read_b128 v[56:59], v12 offset:53248
    ds_read_b128 v[60:63], v12 offset:54272
    v_mfma_f32_32x32x16_bf16 v[96:111], v[64:67], v[44:47], v[96:111]
    v_mfma_f32_32x32x16_bf16 v[112:127], v[68:71], v[40:43], v[112:127]
    v_mfma_f32_32x32x16_bf16 v[128:143], v[68:71], v[44:47], v[128:143]
    s_waitcnt lgkmcnt(4)
    v_mfma_f32_32x32x16_bf16 v[80:95], v[72:75], v[48:51], v[80:95]
    v_mfma_f32_32x32x16_bf16 v[96:111], v[72:75], v[52:55], v[96:111]
    v_mfma_f32_32x32x16_bf16 v[112:127], v[76:79], v[48:51], v[112:127]
    v_mfma_f32_32x32x16_bf16 v[128:143], v[76:79], v[52:55], v[128:143]
    s_waitcnt lgkmcnt(0)
    s_barrier
    v_mfma_f32_32x32x16_bf16 v[80:95], v[56:59], v[32:35], v[80:95]
    v_mfma_f32_32x32x16_bf16 v[96:111], v[56:59], v[36:39], v[96:111]
    v_mfma_f32_32x32x16_bf16 v[112:127], v[60:63], v[32:35], v[112:127]
    v_mfma_f32_32x32x16_bf16 v[128:143], v[60:63], v[36:39], v[128:143]
    v_mul_f32 v8, s12, v18
    v_mul_f32 v9, s12, v18
    v_mul_f32 v10, s13, v18
    v_mul_f32 v11, s13, v18
    v_mul_f32 v12, s14, v18
    v_mul_f32 v13, s14, v18
    v_mul_f32 v14, v21, v18
    v_mul_f32 v15, v21, v18
    v_mul_f32 v28, v22, v18
    v_mul_f32 v29, v22, v18
    s_nop 4
    v_pk_mul_f32 v[80:81], v[80:81], v[8:9]
    v_pk_mul_f32 v[82:83], v[82:83], v[8:9]
    v_cvt_pk_bf16_f32 v32, v80, v81
    v_cvt_pk_bf16_f32 v33, v82, v83
    v_pk_mul_f32 v[84:85], v[84:85], v[8:9]
    v_pk_mul_f32 v[86:87], v[86:87], v[8:9]
    v_cvt_pk_bf16_f32 v34, v84, v85
    v_cvt_pk_bf16_f32 v35, v86, v87
    buffer_store_dwordx4 v[32:35], v23, s[48:51], s61 offen offset:0 sc1
    v_pk_mul_f32 v[112:113], v[112:113], v[12:13]
    v_pk_mul_f32 v[114:115], v[114:115], v[12:13]
    v_cvt_pk_bf16_f32 v36, v112, v113
    v_cvt_pk_bf16_f32 v37, v114, v115
    v_pk_mul_f32 v[116:117], v[116:117], v[12:13]
    v_pk_mul_f32 v[118:119], v[118:119], v[12:13]
    v_cvt_pk_bf16_f32 v38, v116, v117
    v_cvt_pk_bf16_f32 v39, v118, v119
    buffer_store_dwordx4 v[36:39], v23, s[48:51], s63 offen offset:0 sc1
    v_pk_mul_f32 v[88:89], v[88:89], v[14:15]
    v_pk_mul_f32 v[90:91], v[90:91], v[14:15]
    v_cvt_pk_bf16_f32 v40, v88, v89
    v_cvt_pk_bf16_f32 v41, v90, v91
    v_pk_mul_f32 v[92:93], v[92:93], v[10:11]
    v_pk_mul_f32 v[94:95], v[94:95], v[10:11]
    v_cvt_pk_bf16_f32 v42, v92, v93
    v_cvt_pk_bf16_f32 v43, v94, v95
    s_mov_b64 exec, s[66:67]
    v_mov_b32 v42, s88
    v_mov_b32 v43, s89
    s_mov_b64 exec, -1
    buffer_store_dwordx4 v[40:43], v24, s[48:51], s61 offen offset:0 sc1

    v_pk_mul_f32 v[120:121], v[120:121], v[10:11]
    v_pk_mul_f32 v[122:123], v[122:123], v[10:11]
    v_cvt_pk_bf16_f32 v44, v120, v121
    v_cvt_pk_bf16_f32 v45, v122, v123
    v_pk_mul_f32 v[124:125], v[124:125], v[28:29]
    v_pk_mul_f32 v[126:127], v[126:127], v[28:29]
    v_cvt_pk_bf16_f32 v46, v124, v125
    v_cvt_pk_bf16_f32 v47, v126, v127
    s_mov_b64 exec, s[64:65]
    v_mov_b32 v64, v46
    v_mov_b32 v65, v47
    v_mov_b32 v66, s92
    v_mov_b32 v67, s93
    v_mov_b32 v46, s90
    v_mov_b32 v47, s91
    buffer_store_dwordx4 v[64:67], v25, s[48:51], s63 offen offset:0 sc1
    s_mov_b64 exec, -1
    buffer_store_dwordx4 v[44:47], v25, s[48:51], s62 offen offset:0 sc1

    v_mul_f32 v8, s12, v19
    v_mul_f32 v9, s12, v19
    v_mul_f32 v10, s13, v19
    v_mul_f32 v11, s13, v19
    v_mul_f32 v12, s14, v19
    v_mul_f32 v13, s14, v19
    v_mul_f32 v14, v21, v19
    v_mul_f32 v15, v21, v19
    v_mul_f32 v28, v22, v19
    v_mul_f32 v29, v22, v19
    v_pk_mul_f32 v[96:97], v[96:97], v[8:9]
    v_pk_mul_f32 v[98:99], v[98:99], v[8:9]
    v_cvt_pk_bf16_f32 v48, v96, v97
    v_cvt_pk_bf16_f32 v49, v98, v99
    v_pk_mul_f32 v[100:101], v[100:101], v[8:9]
    v_pk_mul_f32 v[102:103], v[102:103], v[8:9]
    v_cvt_pk_bf16_f32 v50, v100, v101
    v_cvt_pk_bf16_f32 v51, v102, v103
    buffer_store_dwordx4 v[48:51], v23, s[48:51], s61 offen offset:1536 sc1
    v_pk_mul_f32 v[128:129], v[128:129], v[12:13]
    v_pk_mul_f32 v[130:131], v[130:131], v[12:13]
    v_cvt_pk_bf16_f32 v52, v128, v129
    v_cvt_pk_bf16_f32 v53, v130, v131
    v_pk_mul_f32 v[132:133], v[132:133], v[12:13]
    v_pk_mul_f32 v[134:135], v[134:135], v[12:13]
    v_cvt_pk_bf16_f32 v54, v132, v133
    v_cvt_pk_bf16_f32 v55, v134, v135
    buffer_store_dwordx4 v[52:55], v23, s[48:51], s63 offen offset:1536 sc1
    v_pk_mul_f32 v[104:105], v[104:105], v[14:15]
    v_pk_mul_f32 v[106:107], v[106:107], v[14:15]
    v_cvt_pk_bf16_f32 v56, v104, v105
    v_cvt_pk_bf16_f32 v57, v106, v107
    v_pk_mul_f32 v[108:109], v[108:109], v[10:11]
    v_pk_mul_f32 v[110:111], v[110:111], v[10:11]
    v_cvt_pk_bf16_f32 v58, v108, v109
    v_cvt_pk_bf16_f32 v59, v110, v111
    s_mov_b64 exec, s[66:67]
    v_mov_b32 v58, s88
    v_mov_b32 v59, s89
    s_mov_b64 exec, -1
    buffer_store_dwordx4 v[56:59], v24, s[48:51], s61 offen offset:1536 sc1

    v_pk_mul_f32 v[136:137], v[136:137], v[10:11]
    v_pk_mul_f32 v[138:139], v[138:139], v[10:11]
    v_cvt_pk_bf16_f32 v60, v136, v137
    v_cvt_pk_bf16_f32 v61, v138, v139
    v_pk_mul_f32 v[140:141], v[140:141], v[28:29]
    v_pk_mul_f32 v[142:143], v[142:143], v[28:29]
    v_cvt_pk_bf16_f32 v62, v140, v141
    v_cvt_pk_bf16_f32 v63, v142, v143
    s_mov_b64 exec, s[64:65]
    v_mov_b32 v68, v62
    v_mov_b32 v69, v63
    v_mov_b32 v70, s92
    v_mov_b32 v71, s93
    v_mov_b32 v62, s90
    v_mov_b32 v63, s91
    buffer_store_dwordx4 v[68:71], v25, s[48:51], s63 offen offset:1536 sc1
    s_mov_b64 exec, -1
    buffer_store_dwordx4 v[60:63], v25, s[48:51], s62 offen offset:1536 sc1

    s_lshl_b32 s12, s37, 1
    s_add_u32 s12, s12, s9
    s_lshl_b32 s12, s12, 7
    s_lshl_b32 s13, s36, 1
    s_add_u32 s13, s13, s8
    s_lshl_b32 s13, s13, 2
    s_add_u32 s12, s12, s13
    s_add_u32 s12, s12, 24576

    s_add_u32 s44, s34, 44564480
    s_addc_u32 s45, s35, 0
    s_mov_b32 s46, 46080
    s_mov_b32 s47, 0x00020000
    v_mov_b32 v1, 1
    s_mov_b64 exec, 1
    s_waitcnt vmcnt(0)
    buffer_store_dword v1, off, s[44:47], s12 sc1
    s_mov_b64 exec, -1

L_ch_att:
    s_mov_b32 s98, 1
    s_add_u32 s94, s34, 3145728
    s_addc_u32 s95, s35, 0
    s_mov_b32 s96, s30
    s_mov_b32 s97, s31
    s_mov_b32 s62, 0
L_ch_att0:
    s_and_b32 s3, s2, 7
    s_lshl_b32 s5, s3, 2
    s_bfe_u32 s4, s2, 0x20003
    s_add_u32 s5, s5, s4
    s_lshr_b32 s6, s2, 5
    v_and_b32 v3, 31, v2
    v_lshrrev_b32 v4, 5, v2
    v_lshlrev_b32 v14, 2, v4
    v_xor_b32 v14, v14, v3
    v_lshlrev_b32 v14, 4, v14
    v_lshl_add_u32 v6, v4, 9, v14
    v_xor_b32 v14, 8, v3
    v_lshlrev_b32 v14, 4, v14
    v_lshl_add_u32 v14, v4, 3, v14
    v_add_u32 v7, 1024, v14
    v_bfe_u32 v15, v2, 4, 1
    v_and_b32 v140, 3, v2
    v_lshlrev_b32 v141, 1, v15
    v_sub_u32 v141, 3, v141
    v_min_u32 v140, v140, v141
    v_lshl_add_u32 v140, v15, 2, v140
    v_lshrrev_b32 v141, 1, v140
    v_and_b32 v140, 1, v140
    v_bfe_u32 v14, v2, 2, 2
    v_lshl_add_u32 v14, v4, 2, v14
    v_lshlrev_b32 v142, 2, v141
    v_xor_b32 v14, v14, v142
    v_lshlrev_b32 v14, 4, v14
    v_lshl_add_u32 v14, v141, 9, v14
    v_lshl_add_u32 v14, v140, 3, v14
    v_add_u32 v8, 12288, v14
    v_xor_b32 v9, 128, v8
    s_and_b32 s8, s7, 3
    s_lshr_b32 s9, s7, 2
    s_mul_i32 s59, s9, 24576
    s_bfe_u32 s10, s7, 0x10001
    s_lshl_b32 s10, s10, 5
    s_add_u32 s10, s10, 32
    s_add_u32 s10, s10, s5
    s_mul_i32 s10, s10, 98304
    s_mul_i32 s11, s9, 49152
    s_add_u32 s10, s10, s11
    s_and_b32 s11, s7, 1
    s_mul_i32 s11, s11, 6144
    s_add_u32 s10, s10, s11
    v_lshl_add_u32 v5, v2, 4, s10
    v_add_u32 v15, 3072, v5
    s_mul_i32 s53, s7, 6144
    s_lshl_b32 s10, s6, 3
    s_lshl_b32 s11, s8, 1
    s_add_u32 s10, s10, s11
    s_lshl_b32 s54, s10, 5
    s_mul_i32 s10, s10, 1536
    s_mul_i32 s11, s5, 98304
    s_add_u32 s55, s10, s11
    s_mov_b32 s64, -1
    s_mov_b32 s65, 0
    s_mov_b32 s66, 0
    s_mov_b32 s67, -1
    s_mov_b32 s56, 0
    v_mov_b32 v140, 0
    v_mov_b32 v141, 147456
    ds_write_b32 v141, v140
    s_waitcnt lgkmcnt(0)

    s_add_u32 s40, s34, 6291456
    s_addc_u32 s41, s35, 0
    s_mov_b32 s42, 9437184
    s_mov_b32 s43, 0x00020000
    s_lshl_b32 s43, s98, 26
    s_add_u32 s40, s40, s43
    s_addc_u32 s41, s41, 0
    s_mov_b32 s43, 0x00020000
    s_add_u32 s48, s34, 16777216
    s_addc_u32 s49, s35, 0
    s_mov_b32 s50, 2621440
    s_mov_b32 s51, 0x00020000
    s_lshl_b32 s51, s98, 26
    s_add_u32 s48, s48, s51
    s_addc_u32 s49, s49, 0
    s_mov_b32 s51, 0x00020000
    s_cmp_eq_u32 s98, 0
    s_cbranch_scc1 L_nowait_112
    s_barrier
    s_cmp_lg_u32 s7, 7
    s_cbranch_scc1 L_nopoll_111
    s_add_u32 s44, s34, 44564480
    s_addc_u32 s45, s35, 0
    s_mov_b32 s46, 46080
    s_mov_b32 s47, 0x00020000
    s_mul_i32 s12, s5, 21846
    s_lshr_b32 s12, s12, 16
    s_add_u32 s10, s5, 32
    s_mul_i32 s10, s10, 21846
    s_lshr_b32 s10, s10, 16
    s_add_u32 s11, s5, 64
    s_mul_i32 s11, s11, 21846
    s_lshr_b32 s11, s11, 16
    s_lshl_b32 s12, s12, 7
    s_lshl_b32 s10, s10, 7
    s_lshl_b32 s11, s11, 7
    v_lshlrev_b32 v150, 2, v3
    v_add_u32 v150, 24576, v150
    v_add_u32 v151, s12, v150
    v_add_u32 v152, s10, v150
    s_mov_b64 exec, s[66:67]
    v_add_u32 v152, s11, v150
    s_mov_b64 exec, -1

    s_mov_b32 s13, 200000
L_poll_113:
    buffer_load_dword v148, v151, s[44:47], 0 offen sc1
    buffer_load_dword v149, v152, s[44:47], 0 offen sc1
    s_waitcnt vmcnt(0)
    v_and_b32 v148, v148, v149
    v_cmp_eq_u32 vcc, 1, v148
    s_nop 3
    s_cmp_eq_u64 vcc, -1
    s_cbranch_scc1 L_polled_114
    s_sleep 2
    s_sub_u32 s13, s13, 1
    s_cmp_lg_u32 s13, 0
    s_cbranch_scc1 L_poll_113

L_polled_114:
L_nopoll_111:
    s_barrier
L_nowait_112:
    buffer_load_dwordx4 v[16:19], v6, s[40:43], s55 offen offset:0 sc1
    buffer_load_dwordx2 v[20:21], v7, s[40:43], s55 offen offset:0 sc1
    buffer_load_dwordx4 v[24:27], v6, s[40:43], s55 offen offset:1536 sc1
    buffer_load_dwordx2 v[28:29], v7, s[40:43], s55 offen offset:1536 sc1
L_m8_restart:
    s_bitcmp1_b32 s7, 0
    s_cbranch_scc1 L_m8_late
    s_add_u32 m0, s53, 0
    s_nop 0
    buffer_load_dwordx4 v5, s[40:43], 0 offen offset:0 sc1 lds
    s_add_u32 m0, s53, 0
    s_nop 0
    buffer_load_dwordx4 v5, s[40:43], 0 offen offset:1024 sc1 lds
    s_add_u32 m0, s53, 0
    s_nop 0
    buffer_load_dwordx4 v5, s[40:43], 0 offen offset:2048 sc1 lds
    s_add_u32 m0, s53, 3072
    s_nop 0
    buffer_load_dwordx4 v15, s[40:43], 0 offen offset:0 sc1 lds
    s_add_u32 m0, s53, 3072
    s_nop 0
    buffer_load_dwordx4 v15, s[40:43], 0 offen offset:1024 sc1 lds
    s_add_u32 m0, s53, 3072
    s_nop 0
    buffer_load_dwordx4 v15, s[40:43], 0 offen offset:2048 sc1 lds
L_m8_late:
    v_mov_b32 v76, 0
    v_mov_b32 v77, 0
    v_mov_b32 v78, 0
    v_mov_b32 v79, 0
    v_mov_b32 v80, 0
    v_mov_b32 v81, 0
    v_mov_b32 v82, 0
    v_mov_b32 v83, 0
    v_mov_b32 v84, 0
    v_mov_b32 v85, 0
    v_mov_b32 v86, 0
    v_mov_b32 v87, 0
    v_mov_b32 v88, 0
    v_mov_b32 v89, 0
    v_mov_b32 v90, 0
    v_mov_b32 v91, 0
    v_mov_b32 v92, 0
    v_mov_b32 v93, 0
    v_mov_b32 v94, 0
    v_mov_b32 v95, 0
    v_mov_b32 v96, 0
    v_mov_b32 v97, 0
    v_mov_b32 v98, 0
    v_mov_b32 v99, 0
    v_mov_b32 v100, 0
    v_mov_b32 v101, 0
    v_mov_b32 v102, 0
    v_mov_b32 v103, 0
    v_mov_b32 v104, 0
    v_mov_b32 v105, 0
    v_mov_b32 v106, 0
    v_mov_b32 v107, 0
    v_mov_b32 v68, 0
    v_mov_b32 v52, 0
    v_mov_b32 v69, 0
    v_mov_b32 v53, 0
    v_mov_b32 v70, 0
    v_mov_b32 v54, 0
    v_mov_b32 v71, 0
    v_mov_b32 v55, 0
    v_mov_b32 v72, 0
    v_mov_b32 v56, 0
    v_mov_b32 v73, 0
    v_mov_b32 v57, 0
    v_mov_b32 v74, 0
    v_mov_b32 v58, 0
    v_mov_b32 v75, 0
    v_mov_b32 v59, 0
    v_add_u32 v10, s59, v6
    v_add_u32 v11, s59, v7
    s_mov_b32 s52, 0
    s_mov_b32 s58, s59
    s_mov_b32 s60, 12288
    s_add_u32 s61, s53, 49152
    s_waitcnt vmcnt(0)

    s_barrier
    ds_read_b128 v[32:35], v10
    ds_read_b64 v[40:41], v11
    s_cmp_lg_u32 s56, 0
    s_cbranch_scc1 L_m8_have_m
    ds_read_b128 v[36:39], v6
    ds_read_b64 v[42:43], v7
    s_mov_b64 exec, s[66:67]
    v_mov_b32 v20, 0
    v_mov_b32 v21, 0
    v_mov_b32 v28, 0
    v_mov_b32 v29, 0
    s_mov_b64 exec, -1
    s_waitcnt lgkmcnt(0)
    s_nop 1

    v_mfma_f32_32x32x16_bf16 v[108:123], v[36:39], v[16:19], 0
    v_mfma_f32_32x32x8_bf16 v[108:123], v[42:43], v[20:21], v[108:123]
    v_mfma_f32_32x32x16_bf16 v[124:139], v[36:39], v[24:27], 0
    v_mfma_f32_32x32x8_bf16 v[124:139], v[42:43], v[28:29], v[124:139]
    s_nop 9
    v_max3_f32 v140, v108, v109, v110
    v_max3_f32 v140, v140, v111, v112
    v_max3_f32 v140, v140, v113, v114
    v_max3_f32 v140, v140, v115, v116
    v_max3_f32 v140, v140, v117, v118
    v_max3_f32 v140, v140, v119, v120
    v_max3_f32 v140, v140, v121, v122
    v_max_f32 v140, v140, v123
    v_max3_f32 v144, v124, v125, v126
    v_max3_f32 v144, v144, v127, v128
    v_max3_f32 v144, v144, v129, v130
    v_max3_f32 v144, v144, v131, v132
    v_max3_f32 v144, v144, v133, v134
    v_max3_f32 v144, v144, v135, v136
    v_max3_f32 v144, v144, v137, v138
    v_max_f32 v144, v144, v139
L_m8_set_m:
    v_mov_b32 v141, v140
    s_nop 1
    v_permlane32_swap_b32 v140, v141
    s_nop 1
    v_max_f32 v140, v140, v141
    v_xor_b32 v140, 0x80000000, v140
    v_and_b32 v141, 0xffff0000, v140
    v_sub_f32 v140, v140, v141
    v_and_b32 v142, 0xffff0000, v140
    v_sub_f32 v140, v140, v142
    v_lshrrev_b32 v141, 16, v141
    s_mov_b64 exec, s[66:67]
    v_or_b32 v20, v141, v142
    v_lshrrev_b32 v21, 16, v140
    s_mov_b64 exec, -1

    v_mov_b32 v145, v144
    s_nop 1
    v_permlane32_swap_b32 v144, v145
    s_nop 1
    v_max_f32 v144, v144, v145
    v_xor_b32 v144, 0x80000000, v144
    v_and_b32 v145, 0xffff0000, v144
    v_sub_f32 v144, v144, v145
    v_and_b32 v146, 0xffff0000, v144
    v_sub_f32 v144, v144, v146
    v_lshrrev_b32 v145, 16, v145
    s_mov_b64 exec, s[66:67]
    v_or_b32 v28, v145, v146
    v_lshrrev_b32 v29, 16, v144
    s_mov_b64 exec, -1

    s_cmp_lg_u32 s56, 0
    s_cbranch_scc1 L_m8_restart

L_m8_have_m:
    v_mov_b32 v138, 0
    v_mov_b32 v139, 0
    s_waitcnt lgkmcnt(0)
    v_mfma_f32_32x32x16_bf16 v[108:123], v[32:35], v[16:19], 0
    v_mfma_f32_32x32x8_bf16 v[108:123], v[40:41], v[20:21], v[108:123]
    s_nop 13
    s_bitcmp0_b32 s7, 0
    s_cbranch_scc1 L_m8_early

    s_add_u32 m0, s53, 0
    s_nop 0
    buffer_load_dwordx4 v5, s[40:43], 0 offen offset:0 sc1 lds
    s_add_u32 m0, s53, 0
    s_nop 0
    buffer_load_dwordx4 v5, s[40:43], 0 offen offset:1024 sc1 lds
    s_add_u32 m0, s53, 0
    s_nop 0
    buffer_load_dwordx4 v5, s[40:43], 0 offen offset:2048 sc1 lds
    s_add_u32 m0, s53, 3072
    s_nop 0
    buffer_load_dwordx4 v15, s[40:43], 0 offen offset:0 sc1 lds
    s_add_u32 m0, s53, 3072
    s_nop 0
    buffer_load_dwordx4 v15, s[40:43], 0 offen offset:1024 sc1 lds
    s_add_u32 m0, s53, 3072
    s_nop 0
    buffer_load_dwordx4 v15, s[40:43], 0 offen offset:2048 sc1 lds
L_m8_early:
.p2align 6
L_m8_loop:
    v_exp_f32 v108, v108
    v_cvt_pk_bf16_f32 v75, v138, v139
    v_exp_f32 v109, v109
    s_setprio 2
    v_add_u32 v12, s58, v8
    v_add_u32 v13, s58, v9
    v_mfma_f32_32x32x16_bf16 v[124:139], v[32:35], v[24:27], 0
    s_cmp_eq_u32 s52, 3
    s_cbranch_scc1 L_nodma_115
    s_add_u32 m0, s61, 0
    s_nop 0
    buffer_load_dwordx4 v5, s[40:43], s60 offen offset:0 sc1 lds
L_nodma_115:
    ds_read_b128 v[36:39], v10 offset:1536
    ds_read_b64 v[42:43], v11 offset:1536
    ds_read_b64_tr_b16 v[44:45], v12 offset:0
    ds_read_b64_tr_b16 v[46:47], v13 offset:0
    ds_read_b64_tr_b16 v[48:49], v12 offset:256
    ds_read_b64_tr_b16 v[50:51], v13 offset:256
    v_exp_f32 v110, v110
    v_cvt_pk_bf16_f32 v60, v108, v109
    v_exp_f32 v111, v111
    v_exp_f32 v112, v112
    v_cvt_pk_bf16_f32 v61, v110, v111
    v_mfma_f32_32x32x8_bf16 v[124:139], v[40:41], v[28:29], v[124:139]
    v_exp_f32 v113, v113
    v_exp_f32 v114, v114
    v_cvt_pk_bf16_f32 v62, v112, v113
    v_exp_f32 v115, v115
    v_exp_f32 v116, v116
    v_mfma_f32_32x32x16_bf16 v[92:107], v[52:55], v[68:71], v[92:107]
    v_cvt_pk_bf16_f32 v63, v114, v115
    v_exp_f32 v117, v117
    v_exp_f32 v118, v118
    v_cvt_pk_bf16_f32 v64, v116, v117
    v_exp_f32 v119, v119
    v_exp_f32 v120, v120
    v_mfma_f32_32x32x16_bf16 v[92:107], v[56:59], v[72:75], v[92:107]
    v_cvt_pk_bf16_f32 v65, v118, v119
    v_exp_f32 v121, v121
    v_exp_f32 v122, v122
    v_cvt_pk_bf16_f32 v66, v120, v121
    v_exp_f32 v123, v123
    v_exp_f32 v124, v124
    v_cvt_pk_bf16_f32 v67, v122, v123
    v_exp_f32 v125, v125
    s_waitcnt lgkmcnt(4)
    v_mfma_f32_32x32x16_bf16 v[108:123], v[36:39], v[16:19], 0
    v_exp_f32 v126, v126
    v_cvt_pk_bf16_f32 v68, v124, v125
    v_exp_f32 v127, v127
    v_exp_f32 v128, v128
    v_cvt_pk_bf16_f32 v69, v126, v127
    v_mfma_f32_32x32x8_bf16 v[108:123], v[42:43], v[20:21], v[108:123]
    v_exp_f32 v129, v129
    v_exp_f32 v130, v130
    v_cvt_pk_bf16_f32 v70, v128, v129
    v_exp_f32 v131, v131
    v_exp_f32 v132, v132
    s_waitcnt lgkmcnt(0)
    v_mfma_f32_32x32x16_bf16 v[76:91], v[44:47], v[60:63], v[76:91]
    v_cvt_pk_bf16_f32 v71, v130, v131
    v_exp_f32 v133, v133
    v_exp_f32 v134, v134
    v_cvt_pk_bf16_f32 v72, v132, v133
    v_exp_f32 v135, v135
    v_exp_f32 v136, v136
    v_mfma_f32_32x32x16_bf16 v[76:91], v[48:51], v[64:67], v[76:91]
    v_cvt_pk_bf16_f32 v73, v134, v135
    v_exp_f32 v137, v137
    v_exp_f32 v138, v138
    v_cvt_pk_bf16_f32 v74, v136, v137
    v_exp_f32 v139, v139
    v_exp_f32 v108, v108
    v_cvt_pk_bf16_f32 v75, v138, v139
    v_exp_f32 v109, v109
    v_mfma_f32_32x32x16_bf16 v[124:139], v[36:39], v[24:27], 0
    s_cmp_eq_u32 s52, 3
    s_cbranch_scc1 L_nodma_116
    s_add_u32 m0, s61, 0
    s_nop 0
    buffer_load_dwordx4 v5, s[40:43], s60 offen offset:1024 sc1 lds
L_nodma_116:
    ds_read_b128 v[32:35], v10 offset:3072
    ds_read_b64 v[40:41], v11 offset:3072
    ds_read_b64_tr_b16 v[52:53], v12 offset:1536
    ds_read_b64_tr_b16 v[54:55], v13 offset:1536
    ds_read_b64_tr_b16 v[56:57], v12 offset:1792
    ds_read_b64_tr_b16 v[58:59], v13 offset:1792
    v_exp_f32 v110, v110
    v_cvt_pk_bf16_f32 v60, v108, v109
    v_exp_f32 v111, v111
    v_exp_f32 v112, v112
    v_cvt_pk_bf16_f32 v61, v110, v111
    v_mfma_f32_32x32x8_bf16 v[124:139], v[42:43], v[28:29], v[124:139]
    v_exp_f32 v113, v113
    v_exp_f32 v114, v114
    v_cvt_pk_bf16_f32 v62, v112, v113
    v_exp_f32 v115, v115
    v_exp_f32 v116, v116
    v_mfma_f32_32x32x16_bf16 v[92:107], v[44:47], v[68:71], v[92:107]
    v_cvt_pk_bf16_f32 v63, v114, v115
    v_exp_f32 v117, v117
    v_exp_f32 v118, v118
    v_cvt_pk_bf16_f32 v64, v116, v117
    v_exp_f32 v119, v119
    v_exp_f32 v120, v120
    v_mfma_f32_32x32x16_bf16 v[92:107], v[48:51], v[72:75], v[92:107]
    v_cvt_pk_bf16_f32 v65, v118, v119
    v_exp_f32 v121, v121
    v_exp_f32 v122, v122
    v_cvt_pk_bf16_f32 v66, v120, v121
    v_exp_f32 v123, v123
    v_exp_f32 v124, v124
    v_cvt_pk_bf16_f32 v67, v122, v123
    v_exp_f32 v125, v125
    s_waitcnt lgkmcnt(4)
    v_mfma_f32_32x32x16_bf16 v[108:123], v[32:35], v[16:19], 0
    v_exp_f32 v126, v126
    v_cvt_pk_bf16_f32 v68, v124, v125
    v_exp_f32 v127, v127
    v_exp_f32 v128, v128
    v_cvt_pk_bf16_f32 v69, v126, v127
    v_mfma_f32_32x32x8_bf16 v[108:123], v[40:41], v[20:21], v[108:123]
    v_exp_f32 v129, v129
    v_exp_f32 v130, v130
    v_cvt_pk_bf16_f32 v70, v128, v129
    v_exp_f32 v131, v131
    v_exp_f32 v132, v132
    s_waitcnt lgkmcnt(0)
    v_mfma_f32_32x32x16_bf16 v[76:91], v[52:55], v[60:63], v[76:91]
    v_cvt_pk_bf16_f32 v71, v130, v131
    v_exp_f32 v133, v133
    v_exp_f32 v134, v134
    v_cvt_pk_bf16_f32 v72, v132, v133
    v_exp_f32 v135, v135
    v_exp_f32 v136, v136
    v_mfma_f32_32x32x16_bf16 v[76:91], v[56:59], v[64:67], v[76:91]
    v_cvt_pk_bf16_f32 v73, v134, v135
    v_exp_f32 v137, v137
    v_exp_f32 v138, v138
    v_cvt_pk_bf16_f32 v74, v136, v137
    v_exp_f32 v139, v139
    v_exp_f32 v108, v108
    v_cvt_pk_bf16_f32 v75, v138, v139
    v_exp_f32 v109, v109
    s_setprio 1
    v_mfma_f32_32x32x16_bf16 v[124:139], v[32:35], v[24:27], 0
    s_cmp_eq_u32 s52, 3
    s_cbranch_scc1 L_nodma_117
    s_add_u32 m0, s61, 0
    s_nop 0
    buffer_load_dwordx4 v5, s[40:43], s60 offen offset:2048 sc1 lds
L_nodma_117:
    ds_read_b128 v[36:39], v10 offset:4608
    ds_read_b64 v[42:43], v11 offset:4608
    ds_read_b64_tr_b16 v[44:45], v12 offset:3072
    ds_read_b64_tr_b16 v[46:47], v13 offset:3072
    ds_read_b64_tr_b16 v[48:49], v12 offset:3328
    ds_read_b64_tr_b16 v[50:51], v13 offset:3328
    v_exp_f32 v110, v110
    v_cvt_pk_bf16_f32 v60, v108, v109
    v_exp_f32 v111, v111
    v_exp_f32 v112, v112
    v_cvt_pk_bf16_f32 v61, v110, v111
    v_mfma_f32_32x32x8_bf16 v[124:139], v[40:41], v[28:29], v[124:139]
    v_exp_f32 v113, v113
    v_exp_f32 v114, v114
    v_cvt_pk_bf16_f32 v62, v112, v113
    v_exp_f32 v115, v115
    v_exp_f32 v116, v116
    v_mfma_f32_32x32x16_bf16 v[92:107], v[52:55], v[68:71], v[92:107]
    v_cvt_pk_bf16_f32 v63, v114, v115
    v_exp_f32 v117, v117
    v_exp_f32 v118, v118
    v_cvt_pk_bf16_f32 v64, v116, v117
    v_exp_f32 v119, v119
    v_exp_f32 v120, v120
    v_mfma_f32_32x32x16_bf16 v[92:107], v[56:59], v[72:75], v[92:107]
    v_cvt_pk_bf16_f32 v65, v118, v119
    v_exp_f32 v121, v121
    v_exp_f32 v122, v122
    v_cvt_pk_bf16_f32 v66, v120, v121
    v_exp_f32 v123, v123
    v_exp_f32 v124, v124
    v_cvt_pk_bf16_f32 v67, v122, v123
    v_exp_f32 v125, v125
    s_waitcnt lgkmcnt(4)
    v_mfma_f32_32x32x16_bf16 v[108:123], v[36:39], v[16:19], 0
    v_exp_f32 v126, v126
    v_cvt_pk_bf16_f32 v68, v124, v125
    v_exp_f32 v127, v127
    v_exp_f32 v128, v128
    v_cvt_pk_bf16_f32 v69, v126, v127
    v_mfma_f32_32x32x8_bf16 v[108:123], v[42:43], v[20:21], v[108:123]
    v_exp_f32 v129, v129
    v_exp_f32 v130, v130
    v_cvt_pk_bf16_f32 v70, v128, v129
    v_exp_f32 v131, v131
    v_exp_f32 v132, v132
    s_waitcnt lgkmcnt(0)
    v_mfma_f32_32x32x16_bf16 v[76:91], v[44:47], v[60:63], v[76:91]
    v_cvt_pk_bf16_f32 v71, v130, v131
    v_exp_f32 v133, v133
    v_exp_f32 v134, v134
    v_cvt_pk_bf16_f32 v72, v132, v133
    v_exp_f32 v135, v135
    v_exp_f32 v136, v136
    v_mfma_f32_32x32x16_bf16 v[76:91], v[48:51], v[64:67], v[76:91]
    v_cvt_pk_bf16_f32 v73, v134, v135
    v_exp_f32 v137, v137
    v_exp_f32 v138, v138
    v_cvt_pk_bf16_f32 v74, v136, v137
    v_exp_f32 v139, v139
    v_exp_f32 v108, v108
    v_cvt_pk_bf16_f32 v75, v138, v139
    v_exp_f32 v109, v109
    v_mfma_f32_32x32x16_bf16 v[124:139], v[36:39], v[24:27], 0
    s_cmp_lg_u32 s52, 0
    s_cbranch_scc1 L_nobar_118
    s_waitcnt vmcnt(3)
    s_barrier

L_nobar_118:
    s_cmp_eq_u32 s52, 3
    s_cbranch_scc1 L_nodma_119
    s_add_u32 m0, s61, 3072
    s_nop 0
    buffer_load_dwordx4 v15, s[40:43], s60 offen offset:0 sc1 lds
L_nodma_119:
    ds_read_b128 v[32:35], v10 offset:6144
    ds_read_b64 v[40:41], v11 offset:6144
    ds_read_b64_tr_b16 v[52:53], v12 offset:4608
    ds_read_b64_tr_b16 v[54:55], v13 offset:4608
    ds_read_b64_tr_b16 v[56:57], v12 offset:4864
    ds_read_b64_tr_b16 v[58:59], v13 offset:4864
    v_exp_f32 v110, v110
    v_cvt_pk_bf16_f32 v60, v108, v109
    v_exp_f32 v111, v111
    v_exp_f32 v112, v112
    v_cvt_pk_bf16_f32 v61, v110, v111
    v_mfma_f32_32x32x8_bf16 v[124:139], v[42:43], v[28:29], v[124:139]
    v_exp_f32 v113, v113
    v_exp_f32 v114, v114
    v_cvt_pk_bf16_f32 v62, v112, v113
    v_exp_f32 v115, v115
    v_exp_f32 v116, v116
    v_mfma_f32_32x32x16_bf16 v[92:107], v[44:47], v[68:71], v[92:107]
    v_cvt_pk_bf16_f32 v63, v114, v115
    v_exp_f32 v117, v117
    v_exp_f32 v118, v118
    v_cvt_pk_bf16_f32 v64, v116, v117
    v_exp_f32 v119, v119
    v_exp_f32 v120, v120
    v_mfma_f32_32x32x16_bf16 v[92:107], v[48:51], v[72:75], v[92:107]
    v_cvt_pk_bf16_f32 v65, v118, v119
    v_exp_f32 v121, v121
    v_exp_f32 v122, v122
    v_cvt_pk_bf16_f32 v66, v120, v121
    v_exp_f32 v123, v123
    v_exp_f32 v124, v124
    v_cvt_pk_bf16_f32 v67, v122, v123
    v_exp_f32 v125, v125
    s_waitcnt lgkmcnt(4)
    v_mfma_f32_32x32x16_bf16 v[108:123], v[32:35], v[16:19], 0
    v_exp_f32 v126, v126
    v_cvt_pk_bf16_f32 v68, v124, v125
    v_exp_f32 v127, v127
    v_exp_f32 v128, v128
    v_cvt_pk_bf16_f32 v69, v126, v127
    v_mfma_f32_32x32x8_bf16 v[108:123], v[40:41], v[20:21], v[108:123]
    v_exp_f32 v129, v129
    v_exp_f32 v130, v130
    v_cvt_pk_bf16_f32 v70, v128, v129
    v_exp_f32 v131, v131
    v_exp_f32 v132, v132
    s_waitcnt lgkmcnt(0)
    v_mfma_f32_32x32x16_bf16 v[76:91], v[52:55], v[60:63], v[76:91]
    v_cvt_pk_bf16_f32 v71, v130, v131
    v_exp_f32 v133, v133
    v_exp_f32 v134, v134
    v_cvt_pk_bf16_f32 v72, v132, v133
    v_exp_f32 v135, v135
    v_exp_f32 v136, v136
    v_mfma_f32_32x32x16_bf16 v[76:91], v[56:59], v[64:67], v[76:91]
    v_cvt_pk_bf16_f32 v73, v134, v135
    v_exp_f32 v137, v137
    v_exp_f32 v138, v138
    v_cvt_pk_bf16_f32 v74, v136, v137
    v_exp_f32 v139, v139
    v_exp_f32 v108, v108
    v_cvt_pk_bf16_f32 v75, v138, v139
    v_exp_f32 v109, v109
    s_setprio 0
    v_mfma_f32_32x32x16_bf16 v[124:139], v[32:35], v[24:27], 0
    s_cmp_eq_u32 s52, 3
    s_cbranch_scc1 L_nodma_120
    s_add_u32 m0, s61, 3072
    s_nop 0
    buffer_load_dwordx4 v15, s[40:43], s60 offen offset:1024 sc1 lds
L_nodma_120:
    ds_read_b128 v[36:39], v10 offset:7680
    ds_read_b64 v[42:43], v11 offset:7680
    ds_read_b64_tr_b16 v[44:45], v12 offset:6144
    ds_read_b64_tr_b16 v[46:47], v13 offset:6144
    ds_read_b64_tr_b16 v[48:49], v12 offset:6400
    ds_read_b64_tr_b16 v[50:51], v13 offset:6400
    v_exp_f32 v110, v110
    v_cvt_pk_bf16_f32 v60, v108, v109
    v_exp_f32 v111, v111
    v_exp_f32 v112, v112
    v_cvt_pk_bf16_f32 v61, v110, v111
    v_mfma_f32_32x32x8_bf16 v[124:139], v[40:41], v[28:29], v[124:139]
    v_exp_f32 v113, v113
    v_exp_f32 v114, v114
    v_cvt_pk_bf16_f32 v62, v112, v113
    v_exp_f32 v115, v115
    v_exp_f32 v116, v116
    v_mfma_f32_32x32x16_bf16 v[92:107], v[52:55], v[68:71], v[92:107]
    v_cvt_pk_bf16_f32 v63, v114, v115
    v_exp_f32 v117, v117
    v_exp_f32 v118, v118
    v_cvt_pk_bf16_f32 v64, v116, v117
    v_exp_f32 v119, v119
    v_exp_f32 v120, v120
    v_mfma_f32_32x32x16_bf16 v[92:107], v[56:59], v[72:75], v[92:107]
    v_cvt_pk_bf16_f32 v65, v118, v119
    v_exp_f32 v121, v121
    v_exp_f32 v122, v122
    v_cvt_pk_bf16_f32 v66, v120, v121
    v_exp_f32 v123, v123
    v_exp_f32 v124, v124
    v_cvt_pk_bf16_f32 v67, v122, v123
    v_exp_f32 v125, v125
    s_waitcnt lgkmcnt(4)
    v_mfma_f32_32x32x16_bf16 v[108:123], v[36:39], v[16:19], 0
    v_exp_f32 v126, v126
    v_cvt_pk_bf16_f32 v68, v124, v125
    v_exp_f32 v127, v127
    v_exp_f32 v128, v128
    v_cvt_pk_bf16_f32 v69, v126, v127
    v_mfma_f32_32x32x8_bf16 v[108:123], v[42:43], v[20:21], v[108:123]
    v_exp_f32 v129, v129
    v_exp_f32 v130, v130
    v_cvt_pk_bf16_f32 v70, v128, v129
    v_exp_f32 v131, v131
    v_exp_f32 v132, v132
    s_waitcnt lgkmcnt(0)
    v_mfma_f32_32x32x16_bf16 v[76:91], v[44:47], v[60:63], v[76:91]
    v_cvt_pk_bf16_f32 v71, v130, v131
    v_exp_f32 v133, v133
    v_exp_f32 v134, v134
    v_cvt_pk_bf16_f32 v72, v132, v133
    v_exp_f32 v135, v135
    v_exp_f32 v136, v136
    v_mfma_f32_32x32x16_bf16 v[76:91], v[48:51], v[64:67], v[76:91]
    v_cvt_pk_bf16_f32 v73, v134, v135
    v_exp_f32 v137, v137
    v_exp_f32 v138, v138
    v_cvt_pk_bf16_f32 v74, v136, v137
    v_exp_f32 v139, v139
    v_exp_f32 v108, v108
    v_cvt_pk_bf16_f32 v75, v138, v139
    v_exp_f32 v109, v109
    v_mfma_f32_32x32x16_bf16 v[124:139], v[36:39], v[24:27], 0
    s_cmp_eq_u32 s52, 3
    s_cbranch_scc1 L_nodma_121
    s_add_u32 m0, s61, 3072
    s_nop 0
    buffer_load_dwordx4 v15, s[40:43], s60 offen offset:2048 sc1 lds
L_nodma_121:
    ds_read_b128 v[32:35], v10 offset:9216
    ds_read_b64 v[40:41], v11 offset:9216
    ds_read_b64_tr_b16 v[52:53], v12 offset:7680
    ds_read_b64_tr_b16 v[54:55], v13 offset:7680
    ds_read_b64_tr_b16 v[56:57], v12 offset:7936
    ds_read_b64_tr_b16 v[58:59], v13 offset:7936
    v_exp_f32 v110, v110
    v_cvt_pk_bf16_f32 v60, v108, v109
    v_exp_f32 v111, v111
    v_exp_f32 v112, v112
    v_cvt_pk_bf16_f32 v61, v110, v111
    v_mfma_f32_32x32x8_bf16 v[124:139], v[42:43], v[28:29], v[124:139]
    v_exp_f32 v113, v113
    v_exp_f32 v114, v114
    v_cvt_pk_bf16_f32 v62, v112, v113
    v_exp_f32 v115, v115
    v_exp_f32 v116, v116
    v_mfma_f32_32x32x16_bf16 v[92:107], v[44:47], v[68:71], v[92:107]
    v_cvt_pk_bf16_f32 v63, v114, v115
    v_exp_f32 v117, v117
    v_exp_f32 v118, v118
    v_cvt_pk_bf16_f32 v64, v116, v117
    v_exp_f32 v119, v119
    v_exp_f32 v120, v120
    v_mfma_f32_32x32x16_bf16 v[92:107], v[48:51], v[72:75], v[92:107]
    v_cvt_pk_bf16_f32 v65, v118, v119
    v_exp_f32 v121, v121
    v_exp_f32 v122, v122
    v_cvt_pk_bf16_f32 v66, v120, v121
    v_exp_f32 v123, v123
    v_exp_f32 v124, v124
    v_cvt_pk_bf16_f32 v67, v122, v123
    v_exp_f32 v125, v125
    s_waitcnt lgkmcnt(4)
    v_mfma_f32_32x32x16_bf16 v[108:123], v[32:35], v[16:19], 0
    v_exp_f32 v126, v126
    v_cvt_pk_bf16_f32 v68, v124, v125
    v_exp_f32 v127, v127
    v_exp_f32 v128, v128
    v_cvt_pk_bf16_f32 v69, v126, v127
    v_mfma_f32_32x32x8_bf16 v[108:123], v[40:41], v[20:21], v[108:123]
    v_exp_f32 v129, v129
    v_exp_f32 v130, v130
    v_cvt_pk_bf16_f32 v70, v128, v129
    v_exp_f32 v131, v131
    v_exp_f32 v132, v132
    s_waitcnt lgkmcnt(0)
    v_mfma_f32_32x32x16_bf16 v[76:91], v[52:55], v[60:63], v[76:91]
    v_cvt_pk_bf16_f32 v71, v130, v131
    v_exp_f32 v133, v133
    v_exp_f32 v134, v134
    v_cvt_pk_bf16_f32 v72, v132, v133
    v_exp_f32 v135, v135
    v_exp_f32 v136, v136
    v_mfma_f32_32x32x16_bf16 v[76:91], v[56:59], v[64:67], v[76:91]
    v_cvt_pk_bf16_f32 v73, v134, v135
    v_exp_f32 v137, v137
    v_exp_f32 v138, v138
    v_cvt_pk_bf16_f32 v74, v136, v137
    v_exp_f32 v139, v139
    v_exp_f32 v108, v108
    v_cvt_pk_bf16_f32 v75, v138, v139
    v_exp_f32 v109, v109
    s_setprio 0
    v_mfma_f32_32x32x16_bf16 v[124:139], v[32:35], v[24:27], 0
    ds_read_b128 v[36:39], v10 offset:10752
    ds_read_b64 v[42:43], v11 offset:10752
    ds_read_b64_tr_b16 v[44:45], v12 offset:9216
    ds_read_b64_tr_b16 v[46:47], v13 offset:9216
    ds_read_b64_tr_b16 v[48:49], v12 offset:9472
    ds_read_b64_tr_b16 v[50:51], v13 offset:9472
    v_exp_f32 v110, v110
    v_cvt_pk_bf16_f32 v60, v108, v109
    v_exp_f32 v111, v111
    v_exp_f32 v112, v112
    v_cvt_pk_bf16_f32 v61, v110, v111
    v_mfma_f32_32x32x8_bf16 v[124:139], v[40:41], v[28:29], v[124:139]
    v_exp_f32 v113, v113
    v_exp_f32 v114, v114
    v_cvt_pk_bf16_f32 v62, v112, v113
    v_exp_f32 v115, v115
    v_exp_f32 v116, v116
    v_mfma_f32_32x32x16_bf16 v[92:107], v[52:55], v[68:71], v[92:107]
    v_cvt_pk_bf16_f32 v63, v114, v115
    v_exp_f32 v117, v117
    v_exp_f32 v118, v118
    v_cvt_pk_bf16_f32 v64, v116, v117
    v_exp_f32 v119, v119
    v_exp_f32 v120, v120
    v_mfma_f32_32x32x16_bf16 v[92:107], v[56:59], v[72:75], v[92:107]
    v_cvt_pk_bf16_f32 v65, v118, v119
    v_exp_f32 v121, v121
    v_exp_f32 v122, v122
    v_cvt_pk_bf16_f32 v66, v120, v121
    v_exp_f32 v123, v123
    v_exp_f32 v124, v124
    v_cvt_pk_bf16_f32 v67, v122, v123
    v_exp_f32 v125, v125
    s_waitcnt lgkmcnt(4)
    v_mfma_f32_32x32x16_bf16 v[108:123], v[36:39], v[16:19], 0
    v_exp_f32 v126, v126
    v_cvt_pk_bf16_f32 v68, v124, v125
    v_exp_f32 v127, v127
    v_exp_f32 v128, v128
    v_cvt_pk_bf16_f32 v69, v126, v127
    v_mfma_f32_32x32x8_bf16 v[108:123], v[42:43], v[20:21], v[108:123]
    v_exp_f32 v129, v129
    v_exp_f32 v130, v130
    v_cvt_pk_bf16_f32 v70, v128, v129
    v_exp_f32 v131, v131
    v_exp_f32 v132, v132
    s_waitcnt lgkmcnt(0)
    v_mfma_f32_32x32x16_bf16 v[76:91], v[44:47], v[60:63], v[76:91]
    v_cvt_pk_bf16_f32 v71, v130, v131
    v_exp_f32 v133, v133
    v_exp_f32 v134, v134
    v_cvt_pk_bf16_f32 v72, v132, v133
    v_exp_f32 v135, v135
    v_exp_f32 v136, v136
    v_mfma_f32_32x32x16_bf16 v[76:91], v[48:51], v[64:67], v[76:91]
    v_cvt_pk_bf16_f32 v73, v134, v135
    v_exp_f32 v137, v137
    v_exp_f32 v138, v138
    v_cvt_pk_bf16_f32 v74, v136, v137
    v_exp_f32 v139, v139
    v_exp_f32 v108, v108
    v_cvt_pk_bf16_f32 v75, v138, v139
    v_exp_f32 v109, v109
    v_mfma_f32_32x32x16_bf16 v[124:139], v[36:39], v[24:27], 0
    s_add_u32 s58, s58, 49152
    s_cmp_ge_u32 s58, 147456
    s_cselect_b32 s58, s59, s58
    v_add_u32 v10, s58, v6
    v_add_u32 v11, s58, v7

    s_waitcnt vmcnt(0)
    s_barrier
    s_add_u32 s60, s60, 12288
    s_add_u32 s61, s61, 49152
    s_cmp_ge_u32 s61, 147456
    s_cselect_b32 s61, s53, s61

    s_setprio 3
    s_cmp_lg_u32 s52, 2
    s_cbranch_scc1 L_nopf_122
    s_nop 0
    s_nop 0
    s_lshr_b32 s12, s2, 3
    s_lshl_b32 s12, s12, 3
    s_add_u32 s12, s12, s7
    s_lshr_b32 s13, s3, 2

    s_add_u32 s44, s34, 40894464
    s_addc_u32 s45, s35, 0
    s_mov_b32 s46, 819200
    s_mov_b32 s47, 0x00020000
    s_mul_i32 s14, s13, 409600
    s_mul_i32 s15, s12, 1664
    s_add_u32 s14, s14, s15
    s_add_u32 s46, s14, 1664
    s_min_u32 s46, s46, 819200
    v_lshlrev_b32 v144, 7, v2
    buffer_load_dword v145, v144, s[44:47], s14 offen
    s_add_u32 s14, s14, 8192
    s_add_u32 s44, s34, 36700160
    s_addc_u32 s45, s35, 0
    s_mov_b32 s46, 4030464
    s_mov_b32 s47, 0x00020000
    s_mul_i32 s14, s13, 2015232
    s_mul_i32 s15, s12, 7936
    s_add_u32 s14, s14, s15
    s_add_u32 s46, s14, 7936
    s_min_u32 s46, s46, 4030464
    v_lshlrev_b32 v144, 7, v2
    buffer_load_dword v145, v144, s[44:47], s14 offen
    s_add_u32 s14, s14, 8192
L_nopf_122:
    ds_read_b128 v[32:35], v10 offset:0
    ds_read_b64 v[40:41], v11 offset:0
    ds_read_b64_tr_b16 v[52:53], v12 offset:10752
    ds_read_b64_tr_b16 v[54:55], v13 offset:10752
    ds_read_b64_tr_b16 v[56:57], v12 offset:11008
    ds_read_b64_tr_b16 v[58:59], v13 offset:11008
    v_exp_f32 v110, v110
    v_cvt_pk_bf16_f32 v60, v108, v109
    v_exp_f32 v111, v111
    v_exp_f32 v112, v112
    v_cvt_pk_bf16_f32 v61, v110, v111
    v_mfma_f32_32x32x8_bf16 v[124:139], v[42:43], v[28:29], v[124:139]
    v_exp_f32 v113, v113
    v_exp_f32 v114, v114
    v_cvt_pk_bf16_f32 v62, v112, v113
    v_exp_f32 v115, v115
    v_exp_f32 v116, v116
    v_mfma_f32_32x32x16_bf16 v[92:107], v[44:47], v[68:71], v[92:107]
    v_cvt_pk_bf16_f32 v63, v114, v115
    v_exp_f32 v117, v117
    v_exp_f32 v118, v118
    v_cvt_pk_bf16_f32 v64, v116, v117
    v_exp_f32 v119, v119
    v_exp_f32 v120, v120
    v_mfma_f32_32x32x16_bf16 v[92:107], v[48:51], v[72:75], v[92:107]
    v_cvt_pk_bf16_f32 v65, v118, v119
    v_exp_f32 v121, v121
    v_exp_f32 v122, v122
    v_cvt_pk_bf16_f32 v66, v120, v121
    v_exp_f32 v123, v123
    v_exp_f32 v124, v124
    v_cvt_pk_bf16_f32 v67, v122, v123
    v_exp_f32 v125, v125
    s_waitcnt lgkmcnt(4)
    v_mfma_f32_32x32x16_bf16 v[108:123], v[32:35], v[16:19], 0
    v_exp_f32 v126, v126
    v_cvt_pk_bf16_f32 v68, v124, v125
    v_exp_f32 v127, v127
    v_exp_f32 v128, v128
    v_cvt_pk_bf16_f32 v69, v126, v127
    v_mfma_f32_32x32x8_bf16 v[108:123], v[40:41], v[20:21], v[108:123]
    v_exp_f32 v129, v129
    v_exp_f32 v130, v130
    v_cvt_pk_bf16_f32 v70, v128, v129
    v_exp_f32 v131, v131
    v_exp_f32 v132, v132
    s_waitcnt lgkmcnt(0)
    v_mfma_f32_32x32x16_bf16 v[76:91], v[52:55], v[60:63], v[76:91]
    v_cvt_pk_bf16_f32 v71, v130, v131
    v_exp_f32 v133, v133
    v_exp_f32 v134, v134
    v_cvt_pk_bf16_f32 v72, v132, v133
    v_exp_f32 v135, v135
    v_exp_f32 v136, v136
    v_mfma_f32_32x32x16_bf16 v[76:91], v[56:59], v[64:67], v[76:91]
    v_cvt_pk_bf16_f32 v73, v134, v135
    v_exp_f32 v137, v137
    v_exp_f32 v138, v138
    v_cvt_pk_bf16_f32 v74, v136, v137
    v_exp_f32 v139, v139
    s_add_u32 s52, s52, 1
    s_cmp_lt_u32 s52, 4
    s_cbranch_scc1 L_m8_loop

    s_nop 0
    v_cvt_pk_bf16_f32 v75, v138, v139
    s_setprio 0
    s_nop 1
    v_mfma_f32_32x32x16_bf16 v[92:107], v[52:55], v[68:71], v[92:107]
    v_mfma_f32_32x32x16_bf16 v[92:107], v[56:59], v[72:75], v[92:107]
    s_mul_i32 s10, s8, 6144
    s_add_u32 s10, s10, 49152
    v_lshl_add_u32 v143, v2, 4, s10
    v_add_u32 v13, s54, v3
    v_lshrrev_b32 v14, 4, v13
    v_mul_u32_u24 v14, 20480, v14
    v_and_b32 v13, 15, v13
    v_lshl_add_u32 v14, v13, 4, v14
    v_lshl_add_u32 v13, v4, 8, v14
    s_lshl_b32 s10, s5, 9
    s_lshr_b32 s11, s5, 1
    s_lshl_b32 s11, s11, 8
    s_and_b32 s12, s5, 1
    s_lshl_b32 s12, s12, 3
    s_add_u32 s11, s11, s12
    s_add_u32 s11, s11, 16384
    s_nop 4

    s_cmp_eq_u32 s9, 0
    s_cbranch_scc1 L_m8_lo

    ds_write_b128 v143, v[76:79] offset:0
    ds_write_b128 v143, v[80:83] offset:1024
    ds_write_b128 v143, v[84:87] offset:2048
    v_mov_b32 v76, v92
    v_mov_b32 v77, v93
    v_mov_b32 v78, v94
    v_mov_b32 v79, v95
    v_mov_b32 v80, v96
    v_mov_b32 v81, v97
    v_mov_b32 v82, v98
    v_mov_b32 v83, v99
    v_mov_b32 v84, v100
    v_mov_b32 v85, v101
    v_mov_b32 v86, v102
    v_mov_b32 v87, v103
    v_add_u32 v143, 3072, v143
    v_add_u32 v13, 40960, v13
    v_add_u32 v14, 40960, v14
    s_branch L_m8_x

L_m8_lo:
    ds_write_b128 v143, v[92:95] offset:3072
    ds_write_b128 v143, v[96:99] offset:4096
    ds_write_b128 v143, v[100:103] offset:5120
L_m8_x:
    s_waitcnt lgkmcnt(0)
    s_barrier
    ds_read_b128 v[108:111], v143
    ds_read_b128 v[112:115], v143 offset:1024
    ds_read_b128 v[116:119], v143 offset:2048
    s_waitcnt lgkmcnt(0)

    v_pk_add_f32 v[76:77], v[76:77], v[108:109]
    v_pk_add_f32 v[78:79], v[78:79], v[110:111]
    v_pk_add_f32 v[80:81], v[80:81], v[112:113]
    v_pk_add_f32 v[82:83], v[82:83], v[114:115]
    v_pk_add_f32 v[84:85], v[84:85], v[116:117]
    v_pk_add_f32 v[86:87], v[86:87], v[118:119]
    v_mov_b32 v140, v84
    v_mov_b32 v141, v84
    v_mul_f32 v142, 0, v76
    s_nop 0
    v_permlane32_swap_b32 v140, v141

    v_fma_f32 v142, 0, v77, v142
    v_fma_f32 v142, 0, v78, v142
    v_fma_f32 v142, 0, v79, v142
    v_fma_f32 v142, 0, v80, v142
    v_fma_f32 v142, 0, v81, v142
    v_fma_f32 v142, 0, v82, v142
    v_fma_f32 v142, 0, v83, v142
    v_fma_f32 v142, 0, v84, v142
    v_fma_f32 v142, 0, v85, v142
    v_fma_f32 v142, 0, v86, v142
    v_fma_f32 v142, 0, v87, v142
    v_rcp_f32 v141, v141
    v_cmp_u_f32 vcc, v142, v142
    v_mul_f32 v76, v76, v141
    v_mul_f32 v77, v77, v141
    v_mul_f32 v78, v78, v141
    v_mul_f32 v79, v79, v141
    v_mul_f32 v80, v80, v141
    v_mul_f32 v81, v81, v141
    v_mul_f32 v82, v82, v141
    v_mul_f32 v83, v83, v141
    v_mul_f32 v84, v84, v141
    v_mul_f32 v85, v85, v141
    v_mul_f32 v86, v86, v141
    v_mul_f32 v87, v87, v141
    v_cvt_pk_bf16_f32 v60, v76, v77
    v_cvt_pk_bf16_f32 v61, v78, v79
    v_cvt_pk_bf16_f32 v62, v80, v81
    v_cvt_pk_bf16_f32 v63, v82, v83
    v_cvt_pk_bf16_f32 v64, v84, v85
    v_cvt_pk_bf16_f32 v65, v86, v87
    buffer_store_dwordx4 v[60:63], v13, s[48:51], s10 offen sc1
    s_mov_b64 exec, s[64:65]
    buffer_store_dwordx2 v[64:65], v14, s[48:51], s11 offen sc1
    s_mov_b64 exec, -1
    s_cmp_lg_u32 s56, 0
    s_cbranch_scc1 L_m8_done
    v_mov_b32 v141, 147456
    s_cbranch_vccz L_m8_ok
    v_mov_b32 v140, 1
    ds_write_b32 v141, v140

L_m8_ok:
    s_waitcnt lgkmcnt(0)
    s_barrier
    ds_read_b32 v140, v141
    s_waitcnt lgkmcnt(0)
    v_readfirstlane_b32 s10, v140
    s_nop 3
    s_cmp_eq_u32 s10, 0
    s_cbranch_scc1 L_m8_done
    s_mov_b32 s56, 1
    s_mov_b64 exec, s[66:67]
    v_mov_b32 v20, 0
    v_mov_b32 v21, 0
    v_mov_b32 v28, 0
    v_mov_b32 v29, 0
    s_mov_b64 exec, -1
    v_mov_b32 v140, 0xff800000
    v_mov_b32 v144, 0xff800000
    s_add_u32 s10, s5, 32
    s_mul_i32 s10, s10, 98304
    s_mov_b32 s11, 64

L_m8_maxloop:
    buffer_load_dwordx4 v[32:35], v6, s[40:43], s10 offen sc1
    buffer_load_dwordx2 v[40:41], v7, s[40:43], s10 offen sc1
    s_waitcnt vmcnt(0)

    v_mfma_f32_32x32x16_bf16 v[108:123], v[32:35], v[16:19], 0
    v_mfma_f32_32x32x8_bf16 v[108:123], v[40:41], v[20:21], v[108:123]
    v_mfma_f32_32x32x16_bf16 v[124:139], v[32:35], v[24:27], 0
    v_mfma_f32_32x32x8_bf16 v[124:139], v[40:41], v[28:29], v[124:139]
    s_nop 15
    v_max3_f32 v140, v140, v108, v109
    v_max3_f32 v140, v140, v110, v111
    v_max3_f32 v140, v140, v112, v113
    v_max3_f32 v140, v140, v114, v115
    v_max3_f32 v140, v140, v116, v117
    v_max3_f32 v140, v140, v118, v119
    v_max3_f32 v140, v140, v120, v121
    v_max3_f32 v140, v140, v122, v123
    v_max3_f32 v144, v144, v124, v125
    v_max3_f32 v144, v144, v126, v127
    v_max3_f32 v144, v144, v128, v129
    v_max3_f32 v144, v144, v130, v131
    v_max3_f32 v144, v144, v132, v133
    v_max3_f32 v144, v144, v134, v135
    v_max3_f32 v144, v144, v136, v137
    v_max3_f32 v144, v144, v138, v139
    s_add_u32 s10, s10, 1536
    s_sub_u32 s11, s11, 1
    s_cmp_lg_u32 s11, 0
    s_cbranch_scc1 L_m8_maxloop
    s_branch L_m8_set_m

L_m8_done:
    s_lshl_b32 s12, s6, 2
    s_add_u32 s12, s12, s8
    s_lshl_b32 s12, s12, 8
    s_lshl_b32 s13, s5, 3
    s_add_u32 s12, s12, s13
    s_lshl_b32 s13, s9, 2
    s_add_u32 s12, s12, s13
    s_add_u32 s12, s12, 28672
    s_lshl_b32 s13, s98, 13
    s_add_u32 s12, s12, s13

    s_add_u32 s44, s34, 44564480
    s_addc_u32 s45, s35, 0
    s_mov_b32 s46, 46080
    s_mov_b32 s47, 0x00020000
    v_mov_b32 v1, 1
    s_mov_b64 exec, 1
    s_waitcnt vmcnt(0)
    buffer_store_dword v1, off, s[44:47], s12 sc1
    s_mov_b64 exec, -1

    s_barrier
    s_branch L_ch_body
.section .rodata,"a"
.p2align 6
.amdhsa_kernel g1a_kernel
  .amdhsa_next_free_vgpr 164
  .amdhsa_next_free_sgpr 102
  .amdhsa_accum_offset 164
  .amdhsa_group_segment_fixed_size 0
  .amdhsa_kernarg_size 80
  .amdhsa_user_sgpr_count 2
  .amdhsa_user_sgpr_kernarg_segment_ptr 1
  .amdhsa_system_sgpr_workgroup_id_x 1
.end_amdhsa_kernel
.p2align 6
.amdhsa_kernel atta_kernel
  .amdhsa_next_free_vgpr 128
  .amdhsa_next_free_sgpr 102
  .amdhsa_accum_offset 128
  .amdhsa_group_segment_fixed_size 0
  .amdhsa_kernarg_size 80
  .amdhsa_user_sgpr_count 2
  .amdhsa_user_sgpr_kernarg_segment_ptr 1
  .amdhsa_system_sgpr_workgroup_id_x 1
.end_amdhsa_kernel
.p2align 6
.amdhsa_kernel cha_kernel
  .amdhsa_next_free_vgpr 216
  .amdhsa_next_free_sgpr 102
  .amdhsa_accum_offset 216
  .amdhsa_group_segment_fixed_size 0
  .amdhsa_kernarg_size 80
  .amdhsa_user_sgpr_count 2
  .amdhsa_user_sgpr_kernarg_segment_ptr 1
  .amdhsa_system_sgpr_workgroup_id_x 1
.end_amdhsa_kernel
```
